```python
import torch

def _softmax(x, axis=-1):
    return torch.softmax(x, dim=axis)
def _gelu(x):
    return torch.nn.functional.gelu(x, approximate="tanh")
def _silu(x):
    return torch.nn.functional.silu(x)
def _sigmoid(x):
    return torch.sigmoid(x)
def _layernorm(x, axis=-1, eps=1e-5):
    m = x.mean(dim=axis, keepdim=True)
    v = x.var(dim=axis, keepdim=True, unbiased=False)
    return (x - m) / torch.sqrt(v + eps)
def _scatter_add(tgt, idx, src, axis=0):
    return tgt.clone().index_add_(axis, idx, src)
def _segment_sum(src, seg, n):
    out = torch.zeros((n,) + src.shape[1:], dtype=src.dtype)
    return out.index_add_(0, seg, src)
def _pad(x, pw):
    flat = tuple(v for pair in reversed(pw) for v in pair)
    return torch.nn.functional.pad(x, flat)

kernel_name = 'recurrent_scan__linear_kernel_hedgehog__dense_activation_mish__prompt'

def setup_inputs():

    _w = (lambda a: (lambda t: t.to(torch.bfloat16) if t.is_floating_point() else t)(torch.as_tensor(a)))
    def _A_setup():
        B, S, D, H = 1, 2048, 1024, 32
        Dh = D // H
        return {
            "x": _w((lambda *s: torch.randn(*s, dtype=torch.bfloat16) * 0.05)(B, S, D)),
            "wqkv": _w((lambda *s: torch.randn(*s, dtype=torch.bfloat16) * 0.2)(D, 3 * D)),
            "w_phi": _w((lambda *s: torch.randn(*s, dtype=torch.bfloat16) * 0.2)(H, Dh, Dh) * (Dh ** -0.5)),
            "wo": _w((lambda *s: torch.randn(*s, dtype=torch.bfloat16) * 0.2)(D, D)),
        }
    _A_in = _A_setup()

    def _B_setup():
        B, S, D, F = 1, 2048, 1024, 3584
        return {
            "x": _w((lambda *s: torch.randn(*s, dtype=torch.bfloat16) * 0.05)(B, S, D)),
            "w1": _w((lambda *s: torch.randn(*s, dtype=torch.bfloat16) * 0.4)(D, F) * (D ** -0.5)),
            "b1": _w((lambda *s: torch.randn(*s, dtype=torch.bfloat16) * 0.2)(F)),
            "w2": _w((lambda *s: torch.randn(*s, dtype=torch.bfloat16) * 0.1)(F, D) * (F ** -0.5)),
        }
    _B_in = _B_setup()

    return {
        "A_x": _A_in["x"],
        "A_wqkv": _A_in["wqkv"],
        "A_w_phi": _A_in["w_phi"],
        "A_wo": _A_in["wo"],
        "B_x": _B_in["x"],
        "B_w1": _B_in["w1"],
        "B_b1": _B_in["b1"],
        "B_w2": _B_in["w2"],
    }

def reference(A_x, A_wqkv, A_w_phi, A_wo, B_x, B_w1, B_b1, B_w2):
    def _A_ref(x, wqkv, w_phi, wo):
        B, S, D = x.shape
        H = 32; Dh = D // H
        qkv = (lambda x, *d: x.permute(*d))((x @ wqkv).reshape(B, S, 3, H, Dh), 2, 0, 3, 1, 4)
        q, k, v = qkv[0], qkv[1], qkv[2]
        pq = torch.einsum("bhsd,hdf->bhsf", q, w_phi)
        pk = torch.einsum("bhsd,hdf->bhsf", k, w_phi)
        phi_q = torch.concatenate([_softmax(pq, axis=-1), _softmax(-pq, axis=-1)], axis=-1)
        phi_k = torch.concatenate([_softmax(pk, axis=-1), _softmax(-pk, axis=-1)], axis=-1)
        kv = torch.einsum("bhsf,bhsd->bhfd", phi_k, v)
        z  = torch.einsum("bhsf->bhf", phi_k)
        num = torch.einsum("bhqf,bhfd->bhqd", phi_q, kv)
        den = torch.einsum("bhqf,bhf->bhq", phi_q, z)[..., None] + 1e-6
        o = num / den
        return (lambda x, *d: x.permute(*d))(o, 0, 2, 1, 3).reshape(B, S, D) @ wo

    def _B_ref(x, w1, b1, w2):
        h = torch.einsum("bsd,df->bsf", x, w1) + b1
        sp = torch.log1p(torch.exp(-torch.abs(h))) + torch.where(h > 0, h, torch.zeros_like(h))
        act = h * torch.tanh(sp)
        return torch.einsum("bsf,fd->bsd", act, w2)

    x = A_x
    xn = _layernorm(x, axis=-1)
    s = _A_ref(xn, A_wqkv, A_w_phi, A_wo)
    g = _silu(_B_ref(xn, B_w1, B_b1, B_w2))
    return x + s * g
```

```asm
; @launch grid=(256,1,1) block=(256,1,1) lds=163840
.amdgcn_target "amdgcn-amd-amdhsa--gfx950"
.text
.globl recurrent_scan__linear_kernel_hedgehog__dense_activation_mish__prompt_kernel
.p2align 8
.type recurrent_scan__linear_kernel_hedgehog__dense_activation_mish__prompt_kernel,@function
recurrent_scan__linear_kernel_hedgehog__dense_activation_mish__prompt_kernel:
    s_cmp_ge_u32 s2, 256
    s_cbranch_scc1 K_done
    s_load_dwordx8 s[48:55], s[0:1], 0
    s_load_dwordx8 s[56:63], s[0:1], 40
    s_load_dwordx4 s[64:67], s[0:1], 72
    s_getpc_b64 s[88:89]
K_pc:
    s_and_b32 s89, s89, 0xffff
    s_mov_b32 s90, K_end-K_pc
    s_mov_b32 s91, 0x20000
    s_lshr_b32 s40, s2, 3
    v_lshrrev_b32 v26, 4, v0
    v_lshl_add_u32 v26, v26, 5, s40
    v_lshlrev_b32 v26, 7, v26
    buffer_load_dword v27, v26, s[88:91], 0 offen
    v_lshrrev_b32 v2, 6, v0
    v_and_b32 v1, 63, v0
    v_readfirstlane_b32 s18, v2
    s_lshr_b32 s23, s2, 7
    s_bfe_u32 s42, s2, 0x20003
    s_bfe_u32 s41, s2, 0x20005
    s_and_b32 s3, s2, 1
    s_lshl_b32 s21, s3, 2
    s_add_u32 s21, s21, s42
    s_bfe_u32 s22, s2, 0x20001
    s_lshl_b32 s22, s22, 2
    s_add_u32 s22, s22, s41
    s_bfe_u32 s100, s2, 0x10001
    s_lshl_b32 s100, s100, 2
    s_add_u32 s100, s100, s42
    s_bfe_u32 s101, s2, 0x10002
    s_lshl_b32 s101, s101, 2
    s_add_u32 s101, s101, s41
    s_and_b32 s19, s18, 1
    s_lshr_b32 s20, s18, 1
    s_lshl_b32 s44, s23, 4
    s_add_u32 s44, s44, s22
    s_lshl_b32 s44, s44, 2
    s_add_u32 s44, s44, s18
    s_lshl_b32 s44, s44, 1
    s_lshl_b32 s45, s21, 8
    s_add_u32 s44, s44, s45
    s_lshl_b32 s45, s44, 11
    v_lshrrev_b32 v9, 5, v1
    v_and_b32 v8, 31, v1
    v_lshlrev_b32 v8, 4, v8
    v_lshl_add_u32 v8, v9, 11, v8
    v_lshrrev_b32 v10, 3, v1
    v_lshlrev_b32 v10, 11, v10
    v_lshrrev_b32 v11, 4, v1
    v_and_b32 v12, 7, v1
    v_xor_b32 v12, v12, v11
    v_lshl_add_u32 v2, v12, 4, v10
    v_xor_b32 v12, 4, v12
    v_lshl_add_u32 v3, v12, 4, v10
    s_lshl_b32 s40, s21, 19
    s_lshl_b32 s41, s18, 17
    s_add_u32 s40, s40, s41
    v_add_u32 v2, s40, v2
    s_add_u32 s40, s40, 15360
    v_add_u32 v3, s40, v3
    s_mov_b32 s30, 57856
    s_mov_b32 s31, 90624
    s_mov_b32 s32, 123392
    s_mov_b32 s33, 0
    s_mov_b32 s34, 28928
    s_lshl_b32 s38, s18, 13
    s_mul_i32 s39, s18, 3616
    s_mov_b32 s37, 0
    s_mov_b32 s36, 256
    s_mov_b32 s35, 0
    s_add_u32 s42, s38, 4096
    s_add_u32 s43, s39, 14464
    v_and_b32 v13, 15, v1
    v_lshrrev_b32 v15, 2, v13
    v_and_b32 v12, 3, v1
    v_mul_u32_u24 v7, 3616, v11
    v_lshl_add_u32 v7, v12, 3, v7
    s_cmp_eq_u32 s23, 0
    s_cbranch_scc1 P1_qkv_setup
    s_mov_b32 s24, 14336
    s_mov_b32 s25, 186368
    s_mov_b32 s26, 896
    s_mov_b32 s27, 912
    s_mov_b32 s28, -1
    s_mov_b32 s29, 0x00ffffff
    v_cmp_le_u32 vcc, 28, v1
    s_nop 1
    v_cndmask_b32 v12, 0, 1, vcc
    v_mul_u32_u24 v14, 28, v12
    v_sub_u32 v14, v1, v14
    v_add_u32 v16, 2, v14
    v_cmp_gt_u32 vcc, 14, v14
    s_nop 1
    v_cndmask_b32 v16, v16, v14, vcc
    v_subrev_u32 v17, 12, v14
    v_cmp_gt_u32 vcc, 26, v14
    s_nop 1
    v_cndmask_b32 v14, v17, v16, vcc
    s_lshl_b32 s40, s18, 3
    v_add_u32 v12, s40, v12
    v_mul_u32_u24 v12, 7168, v12
    v_lshl_add_u32 v4, v14, 4, v12
    s_mul_i32 s40, s22, 448
    v_add_u32 v4, s40, v4
    v_mul_u32_u24 v12, 448, v15
    v_add_u32 v7, v7, v12
    s_mul_i32 s41, s20, 224
    v_add_u32 v7, s41, v7
    s_branch P1_issue
P1_qkv_setup:
    s_mov_b32 s24, 12288
    s_mov_b32 s25, 159744
    s_mov_b32 s26, 832
    s_mov_b32 s27, 976
    s_mov_b32 s28, -1
    s_mov_b32 s29, 0x0000ffff
    v_cmp_le_u32 vcc, 24, v1
    s_nop 1
    v_cndmask_b32 v12, 0, 1, vcc
    v_mul_u32_u24 v14, 24, v12
    v_sub_u32 v14, v1, v14
    s_lshl_b32 s40, s18, 3
    v_add_u32 v12, s40, v12
    v_mul_u32_u24 v12, 6144, v12
    v_cmp_le_u32 vcc, 12, v14
    s_nop 1
    v_cndmask_b32 v16, 0, 1, vcc
    v_mul_u32_u24 v17, 12, v16
    v_sub_u32 v14, v14, v17
    v_lshl_add_u32 v12, v16, 6, v12
    v_lshrrev_b32 v17, 2, v14
    v_lshl_add_u32 v12, v17, 11, v12
    v_and_b32 v14, 3, v14
    v_lshl_add_u32 v4, v14, 4, v12
    s_lshl_b32 s40, s22, 7
    v_add_u32 v4, s40, v4
    v_and_b32 v12, 1, v15
    v_mul_u32_u24 v12, 384, v12
    v_lshrrev_b32 v14, 1, v15
    v_mul_u32_u24 v14, 832, v14
    v_add3_u32 v7, v7, v12, v14
    s_mul_i32 s41, s20, 192
    v_add_u32 v7, s41, v7
P1_issue:
    s_lshl_b32 s40, s21, 4
    s_add_u32 s40, s40, s22
    s_lshr_b32 s41, s24, 1
    s_mul_i32 s40, s40, s41
    s_lshl_b32 s46, s41, 7
    s_lshl_b32 s47, s18, 11
    v_lshl_add_u32 v10, v1, 7, s47
    v_cmp_gt_u32 vcc, s41, v10
    v_add_u32 v10, s40, v10
    v_bfrev_b32 v12, 1
    v_cndmask_b32 v10, v12, v10, vcc
    v_cmp_gt_u32 vcc, 16, v1
    s_nop 1
    v_cndmask_b32 v10, v12, v10, vcc
    s_waitcnt lgkmcnt(0)
    s_cmp_eq_u32 s23, 0
    s_cselect_b32 s8, s50, s56
    s_cselect_b32 s9, s51, s57
    s_and_b32 s9, s9, 0xffff
    s_lshl_b32 s10, s24, 9
    s_mov_b32 s11, 0x20000
    s_mov_b32 s4, s48
    s_and_b32 s5, s49, 0xffff
    s_mov_b32 s6, 4194304
    s_mov_b32 s7, 0x20000
    buffer_load_dwordx4 v[64:67], v8, s[4:7], s45 offen offset:0
    buffer_load_dwordx4 v[68:71], v8, s[4:7], s45 offen offset:512
    buffer_load_dwordx4 v[72:75], v8, s[4:7], s45 offen offset:1024
    buffer_load_dwordx4 v[76:79], v8, s[4:7], s45 offen offset:1536
    s_add_u32 m0, s30, s38
    s_mov_b32 s40, 0
    buffer_load_dwordx4 v2, s[4:7], s40 offen lds
    buffer_load_dwordx4 v3, s[4:7], s40 offen offset:1024 lds
    s_add_u32 s40, s40, 30720
    buffer_load_dwordx4 v2, s[4:7], s40 offen offset:2048 lds
    buffer_load_dwordx4 v3, s[4:7], s40 offen offset:3072 lds
    v_mov_b32 v18, 0x3f803f80
    v_accvgpr_write_b32 a148, v18
    v_accvgpr_write_b32 a149, v18
    v_accvgpr_write_b32 a150, v18
    v_accvgpr_write_b32 a151, v18
    v_accvgpr_write_b32 a120, 0
    v_accvgpr_write_b32 a121, 0
    v_accvgpr_write_b32 a122, 0
    v_accvgpr_write_b32 a123, 0
    v_accvgpr_write_b32 a124, 0
    v_accvgpr_write_b32 a125, 0
    v_accvgpr_write_b32 a126, 0
    v_accvgpr_write_b32 a127, 0
    v_accvgpr_write_b32 a128, 0
    v_accvgpr_write_b32 a129, 0
    v_accvgpr_write_b32 a130, 0
    v_accvgpr_write_b32 a131, 0
    v_accvgpr_write_b32 a132, 0
    v_accvgpr_write_b32 a133, 0
    v_accvgpr_write_b32 a134, 0
    v_accvgpr_write_b32 a135, 0
    v_accvgpr_write_b32 a136, 0
    v_accvgpr_write_b32 a137, 0
    v_accvgpr_write_b32 a138, 0
    v_accvgpr_write_b32 a139, 0
    v_accvgpr_write_b32 a140, 0
    v_accvgpr_write_b32 a141, 0
    v_accvgpr_write_b32 a142, 0
    v_accvgpr_write_b32 a143, 0
    v_accvgpr_write_b32 a144, 0
    v_accvgpr_write_b32 a145, 0
    v_accvgpr_write_b32 a146, 0
    v_accvgpr_write_b32 a147, 0
    v_accvgpr_write_b32 a152, 0
    v_accvgpr_write_b32 a153, 0
    v_accvgpr_write_b32 a154, 0
    v_accvgpr_write_b32 a155, 0
    v_accvgpr_write_b32 a156, 0
    v_accvgpr_write_b32 a157, 0
    v_accvgpr_write_b32 a158, 0
    v_accvgpr_write_b32 a159, 0
    v_accvgpr_write_b32 a160, 0
    v_accvgpr_write_b32 a161, 0
    v_accvgpr_write_b32 a162, 0
    v_accvgpr_write_b32 a163, 0
    v_accvgpr_write_b32 a164, 0
    v_accvgpr_write_b32 a165, 0
    v_accvgpr_write_b32 a166, 0
    v_accvgpr_write_b32 a167, 0
    v_accvgpr_write_b32 a168, 0
    v_accvgpr_write_b32 a169, 0
    v_accvgpr_write_b32 a170, 0
    v_accvgpr_write_b32 a171, 0
    v_accvgpr_write_b32 a172, 0
    v_accvgpr_write_b32 a173, 0
    v_accvgpr_write_b32 a174, 0
    v_accvgpr_write_b32 a175, 0
    v_accvgpr_write_b32 a176, 0
    v_accvgpr_write_b32 a177, 0
    v_accvgpr_write_b32 a178, 0
    v_accvgpr_write_b32 a179, 0
    v_accvgpr_write_b32 a180, 0
    v_accvgpr_write_b32 a181, 0
    v_accvgpr_write_b32 a182, 0
    v_accvgpr_write_b32 a183, 0
    v_mov_b64 v[80:81], 0
    v_mov_b64 v[82:83], 0
    v_mov_b64 v[84:85], 0
    v_mov_b64 v[86:87], 0
    v_mov_b64 v[88:89], 0
    v_mov_b64 v[90:91], 0
    v_mov_b64 v[92:93], 0
    v_mov_b64 v[94:95], 0
    v_mov_b64 v[96:97], 0
    v_mov_b64 v[98:99], 0
    v_mov_b64 v[100:101], 0
    v_mov_b64 v[102:103], 0
    v_mov_b64 v[104:105], 0
    v_mov_b64 v[106:107], 0
    v_mov_b64 v[108:109], 0
    v_mov_b64 v[110:111], 0
    v_mov_b64 v[112:113], 0
    v_mov_b64 v[114:115], 0
    v_mov_b64 v[116:117], 0
    v_mov_b64 v[118:119], 0
    v_mov_b64 v[120:121], 0
    v_mov_b64 v[122:123], 0
    v_mov_b64 v[124:125], 0
    v_mov_b64 v[126:127], 0
    v_mov_b64 v[128:129], 0
    v_mov_b64 v[130:131], 0
    v_mov_b64 v[132:133], 0
    v_mov_b64 v[134:135], 0
    v_mov_b64 v[136:137], 0
    v_mov_b64 v[138:139], 0
    v_mov_b64 v[140:141], 0
    v_mov_b64 v[142:143], 0
    v_mov_b64 v[144:145], 0
    v_mov_b64 v[146:147], 0
    v_mov_b64 v[148:149], 0
    v_mov_b64 v[150:151], 0
    v_mov_b64 v[152:153], 0
    v_mov_b64 v[154:155], 0
    v_mov_b64 v[156:157], 0
    v_mov_b64 v[158:159], 0
    v_mov_b64 v[160:161], 0
    v_mov_b64 v[162:163], 0
    v_mov_b64 v[164:165], 0
    v_mov_b64 v[166:167], 0
    v_mov_b64 v[168:169], 0
    v_mov_b64 v[170:171], 0
    v_mov_b64 v[172:173], 0
    v_mov_b64 v[174:175], 0
    v_mov_b64 v[176:177], 0
    v_mov_b64 v[178:179], 0
    v_mov_b64 v[180:181], 0
    v_mov_b64 v[182:183], 0
    v_mov_b64 v[184:185], 0
    v_mov_b64 v[186:187], 0
    v_mov_b64 v[188:189], 0
    v_mov_b64 v[190:191], 0
    v_mov_b64 v[192:193], 0
    v_mov_b64 v[194:195], 0
    v_mov_b64 v[196:197], 0
    v_mov_b64 v[198:199], 0
    v_mov_b64 v[200:201], 0
    v_mov_b64 v[202:203], 0
    v_mov_b64 v[204:205], 0
    v_mov_b64 v[206:207], 0
    v_mov_b64 v[208:209], 0
    v_mov_b64 v[210:211], 0
    v_mov_b64 v[212:213], 0
    v_mov_b64 v[214:215], 0
    v_mov_b64 v[216:217], 0
    v_mov_b64 v[218:219], 0
    v_mov_b64 v[220:221], 0
    v_mov_b64 v[222:223], 0
    s_add_u32 m0, s30, s42
    s_mov_b32 s40, 65536
    buffer_load_dwordx4 v2, s[4:7], s40 offen lds
    buffer_load_dwordx4 v3, s[4:7], s40 offen offset:1024 lds
    s_add_u32 s40, s40, 30720
    buffer_load_dwordx4 v2, s[4:7], s40 offen offset:2048 lds
    buffer_load_dwordx4 v3, s[4:7], s40 offen offset:3072 lds
    s_add_u32 m0, s39, 0
    s_mov_b64 exec, s[28:29]
    buffer_load_dwordx4 v4, s[8:11], s35 offen lds
    s_add_u32 m0, m0, s26
    s_add_u32 s35, s35, s24
    buffer_load_dwordx4 v4, s[8:11], s35 offen lds
    s_add_u32 m0, m0, s27
    s_add_u32 s35, s35, s24
    buffer_load_dwordx4 v4, s[8:11], s35 offen lds
    s_add_u32 m0, m0, s26
    s_add_u32 s35, s35, s24
    buffer_load_dwordx4 v4, s[8:11], s35 offen lds
    s_mov_b64 exec, -1
    s_add_u32 s35, s35, s25
    s_cmp_eq_u32 s23, 0
    s_cbranch_scc1 P1_wphi
    s_mov_b32 s92, s58
    s_and_b32 s93, s59, 0xffff
    s_mov_b32 s94, 7168
    s_mov_b32 s95, 0x20000
    s_lshl_b32 s40, s18, 6
    v_add_u32 v14, s40, v1
    v_add_u32 v15, 16, v14
    v_cmp_gt_u32 vcc, 112, v14
    s_nop 1
    v_cndmask_b32 v15, v15, v14, vcc
    v_subrev_u32 v16, 96, v14
    v_cmp_gt_u32 vcc, 208, v14
    s_nop 1
    v_cndmask_b32 v15, v16, v15, vcc
    v_lshlrev_b32 v15, 1, v15
    s_mul_i32 s40, s22, 448
    buffer_load_ushort v28, v15, s[92:95], s40 offen
    s_branch P1_aux
P1_wphi:
    s_mov_b32 s92, s52
    s_and_b32 s93, s53, 0xffff
    s_mov_b32 s94, 65536
    s_mov_b32 s95, 0x20000
    s_lshl_b32 s40, s18, 10
    s_add_u32 m0, s40, 158208
    s_lshl_b32 s41, s22, 12
    s_add_u32 s40, s40, s41
    v_lshlrev_b32 v14, 4, v1
    buffer_load_dwordx4 v14, s[92:95], s40 offen lds
P1_aux:
    s_mov_b32 s12, s66
    s_and_b32 s13, s67, 0xffff
    s_mov_b32 s14, 42991616
    s_mov_b32 s15, 0x20000
    s_add_u32 s16, s66, 65536
    s_addc_u32 s17, s67, 0
    v_lshrrev_b32 v12, 1, v13
    v_xor_b32 v12, v12, v11
    v_lshlrev_b32 v14, 7, v13
    s_lshl_b32 s40, s19, 14
    v_add_u32 v14, s40, v14
    v_lshl_add_u32 v5, v12, 4, v14
    v_xor_b32 v12, 4, v12
    v_lshl_add_u32 v6, v12, 4, v14
    v_bfrev_b32 v12, 1
    s_lshl_b32 s40, s2, 2
    s_add_u32 s40, s40, s18
    s_mul_i32 s40, s40, 7
    v_add_lshl_u32 v0, v1, s40, 7
    v_subrev_u32 v0, 3670016, v0
    v_cmp_gt_u32 vcc, 7, v1
    s_nop 1
    v_cndmask_b32 v0, v12, v0, vcc
    s_lshr_b32 s40, s2, 3
    s_and_b32 s40, s40, 3
    s_lshl_b32 s40, 4, s40
    s_cmp_eq_u32 s18, 0
    s_cselect_b32 s47, s40, 0
    s_or_b32 s47, s47, 5120
    s_mov_b32 s92, s60
    s_and_b32 s93, s61, 0xffff
    s_mov_b32 s94, 7340032
    s_mov_b32 s95, 0x20000
    s_lshl_b32 s96, s21, 11
    s_lshl_b32 s41, s19, 10
    s_add_u32 s96, s96, s41
    v_lshlrev_b32 v29, 3, v13
    s_lshl_b32 s40, s2, 2
    s_add_u32 s40, s40, s18
    s_lshl_b32 s41, s40, 4
    v_add_lshl_u32 v30, v13, s41, 7
    s_lshr_b32 s40, s40, 5
    s_lshl_b32 s40, s40, 2
    s_add_u32 s40, s40, s18
    s_lshl_b32 s40, s40, 2
    v_and_b32 v31, 3, v1
    v_add_lshl_u32 v31, v31, s40, 7
    s_add_u32 m0, s39, 14464
    s_mov_b64 exec, s[28:29]
    buffer_load_dwordx4 v4, s[8:11], s35 offen lds
    s_add_u32 m0, m0, s26
    s_add_u32 s35, s35, s24
    buffer_load_dwordx4 v4, s[8:11], s35 offen lds
    s_add_u32 m0, m0, s27
    s_add_u32 s35, s35, s24
    buffer_load_dwordx4 v4, s[8:11], s35 offen lds
    s_add_u32 m0, m0, s26
    s_add_u32 s35, s35, s24
    buffer_load_dwordx4 v4, s[8:11], s35 offen lds
    s_mov_b64 exec, -1
    s_add_u32 s35, s35, s25
    s_waitcnt vmcnt(17)
    v_lshlrev_b32 v32, 16, v64
    v_and_b32 v33, 0xffff0000, v64
    v_lshlrev_b32 v34, 16, v65
    v_and_b32 v35, 0xffff0000, v65
    v_lshlrev_b32 v36, 16, v66
    v_and_b32 v37, 0xffff0000, v66
    v_lshlrev_b32 v38, 16, v67
    v_and_b32 v39, 0xffff0000, v67
    v_lshlrev_b32 v40, 16, v68
    v_and_b32 v41, 0xffff0000, v68
    v_lshlrev_b32 v42, 16, v69
    v_and_b32 v43, 0xffff0000, v69
    v_lshlrev_b32 v44, 16, v70
    v_and_b32 v45, 0xffff0000, v70
    v_lshlrev_b32 v46, 16, v71
    v_and_b32 v47, 0xffff0000, v71
    v_lshlrev_b32 v48, 16, v72
    v_and_b32 v49, 0xffff0000, v72
    v_lshlrev_b32 v50, 16, v73
    v_and_b32 v51, 0xffff0000, v73
    v_lshlrev_b32 v52, 16, v74
    v_and_b32 v53, 0xffff0000, v74
    v_lshlrev_b32 v54, 16, v75
    v_and_b32 v55, 0xffff0000, v75
    v_lshlrev_b32 v56, 16, v76
    v_and_b32 v57, 0xffff0000, v76
    v_lshlrev_b32 v58, 16, v77
    v_and_b32 v59, 0xffff0000, v77
    v_lshlrev_b32 v60, 16, v78
    v_and_b32 v61, 0xffff0000, v78
    v_lshlrev_b32 v62, 16, v79
    v_and_b32 v63, 0xffff0000, v79
    v_pk_add_f32 v[12:13], v[32:33], v[34:35] op_sel:[0,0] op_sel_hi:[1,1]
    v_pk_add_f32 v[12:13], v[12:13], v[36:37] op_sel:[0,0] op_sel_hi:[1,1]
    v_pk_add_f32 v[12:13], v[12:13], v[38:39] op_sel:[0,0] op_sel_hi:[1,1]
    v_pk_add_f32 v[12:13], v[12:13], v[40:41] op_sel:[0,0] op_sel_hi:[1,1]
    v_pk_add_f32 v[12:13], v[12:13], v[42:43] op_sel:[0,0] op_sel_hi:[1,1]
    v_pk_add_f32 v[12:13], v[12:13], v[44:45] op_sel:[0,0] op_sel_hi:[1,1]
    v_pk_add_f32 v[12:13], v[12:13], v[46:47] op_sel:[0,0] op_sel_hi:[1,1]
    v_pk_add_f32 v[12:13], v[12:13], v[48:49] op_sel:[0,0] op_sel_hi:[1,1]
    v_pk_add_f32 v[12:13], v[12:13], v[50:51] op_sel:[0,0] op_sel_hi:[1,1]
    v_pk_add_f32 v[12:13], v[12:13], v[52:53] op_sel:[0,0] op_sel_hi:[1,1]
    v_pk_add_f32 v[12:13], v[12:13], v[54:55] op_sel:[0,0] op_sel_hi:[1,1]
    v_pk_add_f32 v[12:13], v[12:13], v[56:57] op_sel:[0,0] op_sel_hi:[1,1]
    v_pk_add_f32 v[12:13], v[12:13], v[58:59] op_sel:[0,0] op_sel_hi:[1,1]
    v_pk_add_f32 v[12:13], v[12:13], v[60:61] op_sel:[0,0] op_sel_hi:[1,1]
    v_pk_add_f32 v[12:13], v[12:13], v[62:63] op_sel:[0,0] op_sel_hi:[1,1]
    v_add_f32 v12, v12, v13
    s_nop 1
    v_add_f32_dpp v12, v12, v12 row_ror:8 row_mask:0xf bank_mask:0xf
    s_nop 1
    v_add_f32_dpp v12, v12, v12 row_ror:4 row_mask:0xf bank_mask:0xf
    s_nop 1
    v_add_f32_dpp v12, v12, v12 row_ror:2 row_mask:0xf bank_mask:0xf
    s_nop 1
    v_add_f32_dpp v12, v12, v12 row_ror:1 row_mask:0xf bank_mask:0xf
    v_mov_b32 v14, v12
    s_nop 1
    v_permlane16_swap_b32 v12, v14
    v_add_f32 v12, v12, v14
    v_mul_f32 v12, 0x3a800000, v12
    v_pk_add_f32 v[32:33], v[32:33], v[12:13] op_sel:[0,0] op_sel_hi:[1,0] neg_lo:[0,1] neg_hi:[0,1]
    v_pk_add_f32 v[34:35], v[34:35], v[12:13] op_sel:[0,0] op_sel_hi:[1,0] neg_lo:[0,1] neg_hi:[0,1]
    v_pk_add_f32 v[36:37], v[36:37], v[12:13] op_sel:[0,0] op_sel_hi:[1,0] neg_lo:[0,1] neg_hi:[0,1]
    v_pk_add_f32 v[38:39], v[38:39], v[12:13] op_sel:[0,0] op_sel_hi:[1,0] neg_lo:[0,1] neg_hi:[0,1]
    v_pk_add_f32 v[40:41], v[40:41], v[12:13] op_sel:[0,0] op_sel_hi:[1,0] neg_lo:[0,1] neg_hi:[0,1]
    v_pk_add_f32 v[42:43], v[42:43], v[12:13] op_sel:[0,0] op_sel_hi:[1,0] neg_lo:[0,1] neg_hi:[0,1]
    v_pk_add_f32 v[44:45], v[44:45], v[12:13] op_sel:[0,0] op_sel_hi:[1,0] neg_lo:[0,1] neg_hi:[0,1]
    v_pk_add_f32 v[46:47], v[46:47], v[12:13] op_sel:[0,0] op_sel_hi:[1,0] neg_lo:[0,1] neg_hi:[0,1]
    v_pk_add_f32 v[48:49], v[48:49], v[12:13] op_sel:[0,0] op_sel_hi:[1,0] neg_lo:[0,1] neg_hi:[0,1]
    v_pk_add_f32 v[50:51], v[50:51], v[12:13] op_sel:[0,0] op_sel_hi:[1,0] neg_lo:[0,1] neg_hi:[0,1]
    v_pk_add_f32 v[52:53], v[52:53], v[12:13] op_sel:[0,0] op_sel_hi:[1,0] neg_lo:[0,1] neg_hi:[0,1]
    v_pk_add_f32 v[54:55], v[54:55], v[12:13] op_sel:[0,0] op_sel_hi:[1,0] neg_lo:[0,1] neg_hi:[0,1]
    v_pk_add_f32 v[56:57], v[56:57], v[12:13] op_sel:[0,0] op_sel_hi:[1,0] neg_lo:[0,1] neg_hi:[0,1]
    v_pk_add_f32 v[58:59], v[58:59], v[12:13] op_sel:[0,0] op_sel_hi:[1,0] neg_lo:[0,1] neg_hi:[0,1]
    v_pk_add_f32 v[60:61], v[60:61], v[12:13] op_sel:[0,0] op_sel_hi:[1,0] neg_lo:[0,1] neg_hi:[0,1]
    v_pk_add_f32 v[62:63], v[62:63], v[12:13] op_sel:[0,0] op_sel_hi:[1,0] neg_lo:[0,1] neg_hi:[0,1]
    v_pk_mul_f32 v[16:17], v[32:33], v[32:33] op_sel:[0,0] op_sel_hi:[1,1]
    v_pk_fma_f32 v[16:17], v[34:35], v[34:35], v[16:17] op_sel:[0,0,0] op_sel_hi:[1,1,1]
    v_pk_fma_f32 v[16:17], v[36:37], v[36:37], v[16:17] op_sel:[0,0,0] op_sel_hi:[1,1,1]
    v_pk_fma_f32 v[16:17], v[38:39], v[38:39], v[16:17] op_sel:[0,0,0] op_sel_hi:[1,1,1]
    v_pk_fma_f32 v[16:17], v[40:41], v[40:41], v[16:17] op_sel:[0,0,0] op_sel_hi:[1,1,1]
    v_pk_fma_f32 v[16:17], v[42:43], v[42:43], v[16:17] op_sel:[0,0,0] op_sel_hi:[1,1,1]
    v_pk_fma_f32 v[16:17], v[44:45], v[44:45], v[16:17] op_sel:[0,0,0] op_sel_hi:[1,1,1]
    v_pk_fma_f32 v[16:17], v[46:47], v[46:47], v[16:17] op_sel:[0,0,0] op_sel_hi:[1,1,1]
    v_pk_fma_f32 v[16:17], v[48:49], v[48:49], v[16:17] op_sel:[0,0,0] op_sel_hi:[1,1,1]
    v_pk_fma_f32 v[16:17], v[50:51], v[50:51], v[16:17] op_sel:[0,0,0] op_sel_hi:[1,1,1]
    v_pk_fma_f32 v[16:17], v[52:53], v[52:53], v[16:17] op_sel:[0,0,0] op_sel_hi:[1,1,1]
    v_pk_fma_f32 v[16:17], v[54:55], v[54:55], v[16:17] op_sel:[0,0,0] op_sel_hi:[1,1,1]
    v_pk_fma_f32 v[16:17], v[56:57], v[56:57], v[16:17] op_sel:[0,0,0] op_sel_hi:[1,1,1]
    v_pk_fma_f32 v[16:17], v[58:59], v[58:59], v[16:17] op_sel:[0,0,0] op_sel_hi:[1,1,1]
    v_pk_fma_f32 v[16:17], v[60:61], v[60:61], v[16:17] op_sel:[0,0,0] op_sel_hi:[1,1,1]
    v_pk_fma_f32 v[16:17], v[62:63], v[62:63], v[16:17] op_sel:[0,0,0] op_sel_hi:[1,1,1]
    v_add_f32 v16, v16, v17
    s_nop 1
    v_add_f32_dpp v16, v16, v16 row_ror:8 row_mask:0xf bank_mask:0xf
    s_nop 1
    v_add_f32_dpp v16, v16, v16 row_ror:4 row_mask:0xf bank_mask:0xf
    s_nop 1
    v_add_f32_dpp v16, v16, v16 row_ror:2 row_mask:0xf bank_mask:0xf
    s_nop 1
    v_add_f32_dpp v16, v16, v16 row_ror:1 row_mask:0xf bank_mask:0xf
    v_mov_b32 v14, v16
    s_nop 1
    v_permlane16_swap_b32 v16, v14
    v_add_f32 v16, v16, v14
    v_mul_f32 v16, 0x3a800000, v16
    v_cvt_pk_bf16_f32 v12, v12, v12
    v_lshlrev_b32 v12, 16, v12
    v_cvt_pk_bf16_f32 v16, v16, v16
    v_lshlrev_b32 v16, 16, v16
    v_add_f32 v16, 925353388, v16
    v_cvt_pk_bf16_f32 v16, v16, v16
    v_lshlrev_b32 v16, 16, v16
    v_sqrt_f32 v16, v16
    s_nop 0
    v_cvt_pk_bf16_f32 v16, v16, v16
    v_lshlrev_b32 v16, 16, v16
    v_rcp_f32 v13, v16
    s_nop 0
    v_mul_f32 v12, v12, v13
    v_lshlrev_b32 v9, 3, v9
    s_add_u32 m0, s31, s38
    s_mov_b32 s40, 128
    buffer_load_dwordx4 v2, s[4:7], s40 offen lds
    buffer_load_dwordx4 v3, s[4:7], s40 offen offset:1024 lds
    s_add_u32 s40, s40, 30720
    buffer_load_dwordx4 v2, s[4:7], s40 offen offset:2048 lds
    buffer_load_dwordx4 v3, s[4:7], s40 offen offset:3072 lds
    v_mov_b64 v[32:33], 0
    v_mov_b64 v[34:35], 0
    v_mov_b64 v[36:37], 0
    v_mov_b64 v[38:39], 0
    v_mov_b64 v[40:41], 0
    v_mov_b64 v[42:43], 0
    v_mov_b64 v[44:45], 0
    v_mov_b64 v[46:47], 0
    v_mov_b64 v[48:49], 0
    v_mov_b64 v[50:51], 0
    v_mov_b64 v[52:53], 0
    v_mov_b64 v[54:55], 0
    v_mov_b64 v[56:57], 0
    v_mov_b64 v[58:59], 0
    v_mov_b64 v[60:61], 0
    v_mov_b64 v[62:63], 0
    v_mov_b64 v[64:65], 0
    v_mov_b64 v[66:67], 0
    v_mov_b64 v[68:69], 0
    v_mov_b64 v[70:71], 0
    v_mov_b64 v[72:73], 0
    v_mov_b64 v[74:75], 0
    v_mov_b64 v[76:77], 0
    v_mov_b64 v[78:79], 0
    s_add_u32 m0, s31, s42
    s_mov_b32 s40, 65664
    buffer_load_dwordx4 v2, s[4:7], s40 offen lds
    buffer_load_dwordx4 v3, s[4:7], s40 offen offset:1024 lds
    s_add_u32 s40, s40, 30720
    buffer_load_dwordx4 v2, s[4:7], s40 offen offset:2048 lds
    buffer_load_dwordx4 v3, s[4:7], s40 offen offset:3072 lds
    s_add_u32 m0, s39, 28928
    s_mov_b64 exec, s[28:29]
    buffer_load_dwordx4 v4, s[8:11], s35 offen lds
    s_add_u32 m0, m0, s26
    s_add_u32 s35, s35, s24
    buffer_load_dwordx4 v4, s[8:11], s35 offen lds
    s_add_u32 m0, m0, s27
    s_add_u32 s35, s35, s24
    buffer_load_dwordx4 v4, s[8:11], s35 offen lds
    s_add_u32 m0, m0, s26
    s_add_u32 s35, s35, s24
    buffer_load_dwordx4 v4, s[8:11], s35 offen lds
    s_mov_b64 exec, -1
    s_add_u32 s35, s35, s25
    buffer_load_dword v25, v10, s[8:11], 0 offen
    v_add_u32 v10, s46, v10
    buffer_load_dword v25, v10, s[8:11], 0 offen
    v_add_u32 v10, s46, v10
    s_lshl_b32 s44, s44, 3
    s_mov_b32 exec_lo, 1
    s_mov_b32 exec_hi, 1
    buffer_store_dwordx2 v[12:13], v9, s[12:15], s44 offen offset:0 sc1
    s_lshl_b32 s40, s18, 9
    s_add_u32 s40, s40, s2
    s_mov_b64 exec, 3
    v_lshl_add_u32 v14, v1, 8, s40
    v_cmp_gt_u32 vcc, 112, v14
    v_lshlrev_b32 v14, 8, v14
    v_add_u32 v14, 65536, v14
    v_bfrev_b32 v15, 1
    v_cndmask_b32 v14, v15, v14, vcc
    v_mov_b32 v15, 0
    buffer_store_dword v15, v14, s[12:15], 0 offen sc1
    s_mov_b64 exec, -1
    s_cmp_eq_u32 s19, 1
    s_cselect_b64 vcc, -1, 0
    s_cmp_eq_u32 s23, 0
    s_cbranch_scc1 P1_six
    s_waitcnt vmcnt(21)
    s_barrier
    v_add_u32 v8, s30, v5
    ds_read_b64_tr_b16 a[0:1], v7 offset:0
    ds_read_b64_tr_b16 a[2:3], v7 offset:1808
    ds_read_b64_tr_b16 a[4:5], v7 offset:32
    ds_read_b64_tr_b16 a[6:7], v7 offset:1840
    ds_read_b64_tr_b16 a[8:9], v7 offset:64
    ds_read_b64_tr_b16 a[10:11], v7 offset:1872
    ds_read_b64_tr_b16 a[12:13], v7 offset:96
    ds_read_b64_tr_b16 a[14:15], v7 offset:1904
    ds_read_b64_tr_b16 a[16:17], v7 offset:128
    ds_read_b64_tr_b16 a[18:19], v7 offset:1936
    ds_read_b64_tr_b16 a[20:21], v7 offset:160
    ds_read_b64_tr_b16 a[22:23], v7 offset:1968
    ds_read_b64_tr_b16 a[24:25], v7 offset:192
    ds_read_b64_tr_b16 a[26:27], v7 offset:2000
    ds_read_b128 a[56:59], v8 offset:0
    ds_read_b128 a[60:63], v8 offset:2048
    ds_read_b128 a[64:67], v8 offset:4096
    ds_read_b128 a[68:71], v8 offset:6144
    ds_read_b128 a[72:75], v8 offset:8192
    ds_read_b128 a[76:79], v8 offset:10240
    ds_read_b128 a[80:83], v8 offset:12288
    ds_read_b128 a[84:87], v8 offset:14336
    v_add_u32 v8, s30, v6
    v_add_u32 v9, s33, v7
    s_cbranch_vccnz P1_loopW1
.p2align 6
P1_loopW0:
    s_waitcnt vmcnt(12) lgkmcnt(0)
    s_barrier
    v_mfma_f32_16x16x32_bf16 v[32:35], a[0:3], a[56:59], v[32:35]
    s_bitcmp1_b32 s47, s37
    s_cbranch_scc1 P1_hookW
P1_backW0:
    v_mfma_f32_16x16x32_bf16 v[64:67], a[4:7], a[56:59], v[64:67]
    buffer_load_dword v11, v10, s[8:11], 0 offen
    v_mfma_f32_16x16x32_bf16 v[96:99], a[8:11], a[56:59], v[96:99]
    v_add_u32 v10, s46, v10
    v_mfma_f32_16x16x32_bf16 v[128:131], a[12:15], a[56:59], v[128:131]
    buffer_load_dword v11, v0, s[92:95], 0 offen
    v_mfma_f32_16x16x32_bf16 v[160:163], a[16:19], a[56:59], v[160:163]
    v_mfma_f32_16x16x32_bf16 v[192:195], a[20:23], a[56:59], v[192:195]
    v_add_u32 v0, 917504, v0
    v_mfma_f32_16x16x32_bf16 a[152:155], a[24:27], a[56:59], a[152:155]
    s_cmp_ge_u32 s37, 14
    s_cselect_b32 s6, 0, s6
    v_mfma_f32_16x16x32_bf16 a[156:159], a[24:27], a[60:63], a[156:159]
    ds_read_b64_tr_b16 a[28:29], v9 offset:14464
    v_mfma_f32_16x16x32_bf16 v[196:199], a[20:23], a[60:63], v[196:199]
    ds_read_b64_tr_b16 a[30:31], v9 offset:16272
    v_mfma_f32_16x16x32_bf16 v[164:167], a[16:19], a[60:63], v[164:167]
    v_mfma_f32_16x16x32_bf16 v[132:135], a[12:15], a[60:63], v[132:135]
    ds_read_b128 a[88:91], v8 offset:0
    v_mfma_f32_16x16x32_bf16 v[100:103], a[8:11], a[60:63], v[100:103]
    ds_read_b64_tr_b16 a[32:33], v9 offset:14496
    v_mfma_f32_16x16x32_bf16 v[68:71], a[4:7], a[60:63], v[68:71]
    ds_read_b64_tr_b16 a[34:35], v9 offset:16304
    v_mfma_f32_16x16x32_bf16 v[36:39], a[0:3], a[60:63], v[36:39]
    v_mfma_f32_16x16x32_bf16 v[40:43], a[0:3], a[64:67], v[40:43]
    ds_read_b128 a[92:95], v8 offset:2048
    v_mfma_f32_16x16x32_bf16 v[72:75], a[4:7], a[64:67], v[72:75]
    ds_read_b64_tr_b16 a[36:37], v9 offset:14528
    v_mfma_f32_16x16x32_bf16 v[104:107], a[8:11], a[64:67], v[104:107]
    ds_read_b64_tr_b16 a[38:39], v9 offset:16336
    v_mfma_f32_16x16x32_bf16 v[136:139], a[12:15], a[64:67], v[136:139]
    ds_read_b128 a[96:99], v8 offset:4096
    v_mfma_f32_16x16x32_bf16 v[168:171], a[16:19], a[64:67], v[168:171]
    v_mfma_f32_16x16x32_bf16 v[200:203], a[20:23], a[64:67], v[200:203]
    ds_read_b64_tr_b16 a[40:41], v9 offset:14560
    v_mfma_f32_16x16x32_bf16 a[160:163], a[24:27], a[64:67], a[160:163]
    ds_read_b64_tr_b16 a[42:43], v9 offset:16368
    v_mfma_f32_16x16x32_bf16 a[164:167], a[24:27], a[68:71], a[164:167]
    ds_read_b128 a[100:103], v8 offset:6144
    v_mfma_f32_16x16x32_bf16 v[204:207], a[20:23], a[68:71], v[204:207]
    v_mfma_f32_16x16x32_bf16 v[172:175], a[16:19], a[68:71], v[172:175]
    s_add_u32 m0, s34, s43
    s_mov_b64 exec, s[28:29]
    v_mfma_f32_16x16x32_bf16 v[140:143], a[12:15], a[68:71], v[140:143]
    buffer_load_dwordx4 v4, s[8:11], s35 offen offset:0 lds
    v_mfma_f32_16x16x32_bf16 v[108:111], a[8:11], a[68:71], v[108:111]
    s_add_u32 s35, s35, 13440
    v_mfma_f32_16x16x32_bf16 v[76:79], a[4:7], a[68:71], v[76:79]
    buffer_load_dwordx4 v4, s[8:11], s35 offen offset:896 lds
    v_mfma_f32_16x16x32_bf16 v[44:47], a[0:3], a[68:71], v[44:47]
    v_mfma_f32_16x16x32_bf16 v[48:51], a[0:3], a[72:75], v[48:51]
    s_add_u32 s35, s35, 13424
    v_mfma_f32_16x16x32_bf16 v[80:83], a[4:7], a[72:75], v[80:83]
    buffer_load_dwordx4 v4, s[8:11], s35 offen offset:1808 lds
    v_mfma_f32_16x16x32_bf16 v[112:115], a[8:11], a[72:75], v[112:115]
    s_add_u32 s35, s35, 13440
    v_mfma_f32_16x16x32_bf16 v[144:147], a[12:15], a[72:75], v[144:147]
    v_mfma_f32_16x16x32_bf16 v[176:179], a[16:19], a[72:75], v[176:179]
    buffer_load_dwordx4 v4, s[8:11], s35 offen offset:2704 lds
    v_mfma_f32_16x16x32_bf16 v[208:211], a[20:23], a[72:75], v[208:211]
    s_mov_b64 exec, -1
    s_add_u32 s35, s35, 189072
    v_mfma_f32_16x16x32_bf16 a[168:171], a[24:27], a[72:75], a[168:171]
    ds_read_b64_tr_b16 a[44:45], v9 offset:14592
    v_mfma_f32_16x16x32_bf16 a[172:175], a[24:27], a[76:79], a[172:175]
    ds_read_b64_tr_b16 a[46:47], v9 offset:16400
    v_mfma_f32_16x16x32_bf16 v[212:215], a[20:23], a[76:79], v[212:215]
    v_mfma_f32_16x16x32_bf16 v[180:183], a[16:19], a[76:79], v[180:183]
    ds_read_b128 a[104:107], v8 offset:8192
    v_mfma_f32_16x16x32_bf16 v[148:151], a[12:15], a[76:79], v[148:151]
    s_add_u32 m0, s32, s38
    v_mfma_f32_16x16x32_bf16 v[116:119], a[8:11], a[76:79], v[116:119]
    s_mov_b32 s40, s36
    v_mfma_f32_16x16x32_bf16 v[84:87], a[4:7], a[76:79], v[84:87]
    v_mfma_f32_16x16x32_bf16 v[52:55], a[0:3], a[76:79], v[52:55]
    buffer_load_dwordx4 v2, s[4:7], s40 offen offset:0 lds
    v_mfma_f32_16x16x32_bf16 v[56:59], a[0:3], a[80:83], v[56:59]
    ds_read_b64_tr_b16 a[48:49], v9 offset:14624
    v_mfma_f32_16x16x32_bf16 v[88:91], a[4:7], a[80:83], v[88:91]
    ds_read_b64_tr_b16 a[50:51], v9 offset:16432
    v_mfma_f32_16x16x32_bf16 v[120:123], a[8:11], a[80:83], v[120:123]
    buffer_load_dwordx4 v3, s[4:7], s40 offen offset:1024 lds
    v_mfma_f32_16x16x32_bf16 v[152:155], a[12:15], a[80:83], v[152:155]
    v_mfma_f32_16x16x32_bf16 v[184:187], a[16:19], a[80:83], v[184:187]
    ds_read_b128 a[108:111], v8 offset:10240
    v_mfma_f32_16x16x32_bf16 v[216:219], a[20:23], a[80:83], v[216:219]
    ds_read_b64_tr_b16 a[52:53], v9 offset:14656
    v_mfma_f32_16x16x32_bf16 a[176:179], a[24:27], a[80:83], a[176:179]
    ds_read_b64_tr_b16 a[54:55], v9 offset:16464
    v_mfma_f32_16x16x32_bf16 a[180:183], a[24:27], a[84:87], a[180:183]
    v_mfma_f32_16x16x32_bf16 v[220:223], a[20:23], a[84:87], v[220:223]
    s_add_u32 s40, s40, 30720
    v_mfma_f32_16x16x32_bf16 v[188:191], a[16:19], a[84:87], v[188:191]
    buffer_load_dwordx4 v2, s[4:7], s40 offen offset:2048 lds
    v_mfma_f32_16x16x32_bf16 v[156:159], a[12:15], a[84:87], v[156:159]
    ds_read_b128 a[112:115], v8 offset:12288
    v_mfma_f32_16x16x32_bf16 v[124:127], a[8:11], a[84:87], v[124:127]
    ds_read_b128 a[116:119], v8 offset:14336
    v_mfma_f32_16x16x32_bf16 v[92:95], a[4:7], a[84:87], v[92:95]
    v_mfma_f32_16x16x32_bf16 v[60:63], a[0:3], a[84:87], v[60:63]
    buffer_load_dwordx4 v3, s[4:7], s40 offen offset:3072 lds
    v_mfma_f32_16x16x32_bf16 a[120:123], a[0:3], a[148:151], a[120:123]
    v_add_u32 v8, s31, v5
    v_mfma_f32_16x16x32_bf16 a[124:127], a[4:7], a[148:151], a[124:127]
    v_add_u32 v9, s34, v7
    v_mfma_f32_16x16x32_bf16 a[128:131], a[8:11], a[148:151], a[128:131]
    v_mfma_f32_16x16x32_bf16 a[132:135], a[12:15], a[148:151], a[132:135]
    s_waitcnt vmcnt(10) lgkmcnt(0)
    s_barrier
    v_mfma_f32_16x16x32_bf16 v[32:35], a[28:31], a[88:91], v[32:35]
    s_cmp_ge_u32 s37, 14
    s_cselect_b32 s10, 0, s10
    v_mfma_f32_16x16x32_bf16 v[64:67], a[32:35], a[88:91], v[64:67]
    ds_read_b64_tr_b16 a[0:1], v9 offset:0
    v_mfma_f32_16x16x32_bf16 v[96:99], a[36:39], a[88:91], v[96:99]
    ds_read_b64_tr_b16 a[2:3], v9 offset:1808
    v_mfma_f32_16x16x32_bf16 v[128:131], a[40:43], a[88:91], v[128:131]
    ds_read_b128 a[56:59], v8 offset:0
    v_mfma_f32_16x16x32_bf16 v[160:163], a[44:47], a[88:91], v[160:163]
    v_mfma_f32_16x16x32_bf16 v[192:195], a[48:51], a[88:91], v[192:195]
    ds_read_b64_tr_b16 a[4:5], v9 offset:32
    v_mfma_f32_16x16x32_bf16 a[152:155], a[52:55], a[88:91], a[152:155]
    ds_read_b64_tr_b16 a[6:7], v9 offset:1840
    v_mfma_f32_16x16x32_bf16 a[156:159], a[52:55], a[92:95], a[156:159]
    ds_read_b128 a[60:63], v8 offset:2048
    v_mfma_f32_16x16x32_bf16 v[196:199], a[48:51], a[92:95], v[196:199]
    v_mfma_f32_16x16x32_bf16 v[164:167], a[44:47], a[92:95], v[164:167]
    ds_read_b64_tr_b16 a[8:9], v9 offset:64
    v_mfma_f32_16x16x32_bf16 v[132:135], a[40:43], a[92:95], v[132:135]
    ds_read_b64_tr_b16 a[10:11], v9 offset:1872
    v_mfma_f32_16x16x32_bf16 v[100:103], a[36:39], a[92:95], v[100:103]
    ds_read_b128 a[64:67], v8 offset:4096
    v_mfma_f32_16x16x32_bf16 v[68:71], a[32:35], a[92:95], v[68:71]
    v_mfma_f32_16x16x32_bf16 v[36:39], a[28:31], a[92:95], v[36:39]
    ds_read_b64_tr_b16 a[12:13], v9 offset:96
    v_mfma_f32_16x16x32_bf16 v[40:43], a[28:31], a[96:99], v[40:43]
    ds_read_b64_tr_b16 a[14:15], v9 offset:1904
    v_mfma_f32_16x16x32_bf16 v[72:75], a[32:35], a[96:99], v[72:75]
    ds_read_b128 a[68:71], v8 offset:6144
    v_mfma_f32_16x16x32_bf16 v[104:107], a[36:39], a[96:99], v[104:107]
    v_mfma_f32_16x16x32_bf16 v[136:139], a[40:43], a[96:99], v[136:139]
    s_add_u32 m0, s33, s39
    s_mov_b64 exec, s[28:29]
    v_mfma_f32_16x16x32_bf16 v[168:171], a[44:47], a[96:99], v[168:171]
    buffer_load_dwordx4 v4, s[8:11], s35 offen offset:0 lds
    v_mfma_f32_16x16x32_bf16 v[200:203], a[48:51], a[96:99], v[200:203]
    s_add_u32 s35, s35, 13440
    v_mfma_f32_16x16x32_bf16 a[160:163], a[52:55], a[96:99], a[160:163]
    buffer_load_dwordx4 v4, s[8:11], s35 offen offset:896 lds
    v_mfma_f32_16x16x32_bf16 a[164:167], a[52:55], a[100:103], a[164:167]
    v_mfma_f32_16x16x32_bf16 v[204:207], a[48:51], a[100:103], v[204:207]
    s_add_u32 s35, s35, 13424
    v_mfma_f32_16x16x32_bf16 v[172:175], a[44:47], a[100:103], v[172:175]
    buffer_load_dwordx4 v4, s[8:11], s35 offen offset:1808 lds
    v_mfma_f32_16x16x32_bf16 v[140:143], a[40:43], a[100:103], v[140:143]
    s_add_u32 s35, s35, 13440
    v_mfma_f32_16x16x32_bf16 v[108:111], a[36:39], a[100:103], v[108:111]
    v_mfma_f32_16x16x32_bf16 v[76:79], a[32:35], a[100:103], v[76:79]
    buffer_load_dwordx4 v4, s[8:11], s35 offen offset:2704 lds
    v_mfma_f32_16x16x32_bf16 v[44:47], a[28:31], a[100:103], v[44:47]
    s_mov_b64 exec, -1
    s_add_u32 s35, s35, 189072
    v_mfma_f32_16x16x32_bf16 v[48:51], a[28:31], a[104:107], v[48:51]
    ds_read_b64_tr_b16 a[16:17], v9 offset:128
    v_mfma_f32_16x16x32_bf16 v[80:83], a[32:35], a[104:107], v[80:83]
    v_mfma_f32_16x16x32_bf16 v[112:115], a[36:39], a[104:107], v[112:115]
    ds_read_b64_tr_b16 a[18:19], v9 offset:1936
    v_mfma_f32_16x16x32_bf16 v[144:147], a[40:43], a[104:107], v[144:147]
    ds_read_b128 a[72:75], v8 offset:8192
    v_mfma_f32_16x16x32_bf16 v[176:179], a[44:47], a[104:107], v[176:179]
    s_add_u32 m0, s32, s42
    v_mfma_f32_16x16x32_bf16 v[208:211], a[48:51], a[104:107], v[208:211]
    v_mfma_f32_16x16x32_bf16 a[168:171], a[52:55], a[104:107], a[168:171]
    s_add_u32 s40, s36, 65536
    v_mfma_f32_16x16x32_bf16 a[172:175], a[52:55], a[108:111], a[172:175]
    buffer_load_dwordx4 v2, s[4:7], s40 offen offset:0 lds
    v_mfma_f32_16x16x32_bf16 v[212:215], a[48:51], a[108:111], v[212:215]
    ds_read_b64_tr_b16 a[20:21], v9 offset:160
    v_mfma_f32_16x16x32_bf16 v[180:183], a[44:47], a[108:111], v[180:183]
    v_mfma_f32_16x16x32_bf16 v[148:151], a[40:43], a[108:111], v[148:151]
    ds_read_b64_tr_b16 a[22:23], v9 offset:1968
    v_mfma_f32_16x16x32_bf16 v[116:119], a[36:39], a[108:111], v[116:119]
    buffer_load_dwordx4 v3, s[4:7], s40 offen offset:1024 lds
    v_mfma_f32_16x16x32_bf16 v[84:87], a[32:35], a[108:111], v[84:87]
    ds_read_b128 a[76:79], v8 offset:10240
    v_mfma_f32_16x16x32_bf16 v[52:55], a[28:31], a[108:111], v[52:55]
    ds_read_b64_tr_b16 a[24:25], v9 offset:192
    v_mfma_f32_16x16x32_bf16 v[56:59], a[28:31], a[112:115], v[56:59]
    v_mfma_f32_16x16x32_bf16 v[88:91], a[32:35], a[112:115], v[88:91]
    ds_read_b64_tr_b16 a[26:27], v9 offset:2000
    v_mfma_f32_16x16x32_bf16 v[120:123], a[36:39], a[112:115], v[120:123]
    s_add_u32 s40, s40, 30720
    v_mfma_f32_16x16x32_bf16 v[152:155], a[40:43], a[112:115], v[152:155]
    buffer_load_dwordx4 v2, s[4:7], s40 offen offset:2048 lds
    v_mfma_f32_16x16x32_bf16 v[184:187], a[44:47], a[112:115], v[184:187]
    v_mfma_f32_16x16x32_bf16 v[216:219], a[48:51], a[112:115], v[216:219]
    ds_read_b128 a[80:83], v8 offset:12288
    v_mfma_f32_16x16x32_bf16 a[176:179], a[52:55], a[112:115], a[176:179]
    ds_read_b128 a[84:87], v8 offset:14336
    v_mfma_f32_16x16x32_bf16 a[180:183], a[52:55], a[116:119], a[180:183]
    buffer_load_dwordx4 v3, s[4:7], s40 offen offset:3072 lds
    v_mfma_f32_16x16x32_bf16 v[220:223], a[48:51], a[116:119], v[220:223]
    v_mfma_f32_16x16x32_bf16 v[188:191], a[44:47], a[116:119], v[188:191]
    s_mov_b32 s40, s30
    s_mov_b32 s30, s31
    v_mfma_f32_16x16x32_bf16 v[156:159], a[40:43], a[116:119], v[156:159]
    s_mov_b32 s31, s32
    s_mov_b32 s32, s40
    v_mfma_f32_16x16x32_bf16 v[124:127], a[36:39], a[116:119], v[124:127]
    s_xor_b32 s33, s33, 28928
    s_xor_b32 s34, s34, 28928
    v_mfma_f32_16x16x32_bf16 v[92:95], a[32:35], a[116:119], v[92:95]
    v_mfma_f32_16x16x32_bf16 v[60:63], a[28:31], a[116:119], v[60:63]
    s_add_u32 s36, s36, 128
    s_add_u32 s37, s37, 1
    v_mfma_f32_16x16x32_bf16 a[120:123], a[28:31], a[148:151], a[120:123]
    v_add_u32 v8, s30, v6
    v_mfma_f32_16x16x32_bf16 a[124:127], a[32:35], a[148:151], a[124:127]
    v_add_u32 v9, s33, v7
    v_mfma_f32_16x16x32_bf16 a[128:131], a[36:39], a[148:151], a[128:131]
    v_mfma_f32_16x16x32_bf16 a[132:135], a[40:43], a[148:151], a[132:135]
    s_cmp_lt_u32 s37, 16
    s_cbranch_scc1 P1_loopW0
    s_branch P1_endW
.p2align 6
P1_loopW1:
    s_waitcnt vmcnt(12) lgkmcnt(0)
    s_barrier
    v_mfma_f32_16x16x32_bf16 v[32:35], a[0:3], a[56:59], v[32:35]
    s_bitcmp1_b32 s47, s37
    s_cbranch_scc1 P1_hookW
P1_backW1:
    v_mfma_f32_16x16x32_bf16 v[64:67], a[4:7], a[56:59], v[64:67]
    buffer_load_dword v11, v10, s[8:11], 0 offen
    v_mfma_f32_16x16x32_bf16 v[96:99], a[8:11], a[56:59], v[96:99]
    v_add_u32 v10, s46, v10
    v_mfma_f32_16x16x32_bf16 v[128:131], a[12:15], a[56:59], v[128:131]
    buffer_load_dword v11, v0, s[92:95], 0 offen
    v_mfma_f32_16x16x32_bf16 v[160:163], a[16:19], a[56:59], v[160:163]
    v_mfma_f32_16x16x32_bf16 v[192:195], a[20:23], a[56:59], v[192:195]
    v_add_u32 v0, 917504, v0
    v_mfma_f32_16x16x32_bf16 a[152:155], a[24:27], a[56:59], a[152:155]
    s_cmp_ge_u32 s37, 14
    s_cselect_b32 s6, 0, s6
    v_mfma_f32_16x16x32_bf16 a[156:159], a[24:27], a[60:63], a[156:159]
    ds_read_b64_tr_b16 a[28:29], v9 offset:14464
    v_mfma_f32_16x16x32_bf16 v[196:199], a[20:23], a[60:63], v[196:199]
    ds_read_b64_tr_b16 a[30:31], v9 offset:16272
    v_mfma_f32_16x16x32_bf16 v[164:167], a[16:19], a[60:63], v[164:167]
    v_mfma_f32_16x16x32_bf16 v[132:135], a[12:15], a[60:63], v[132:135]
    ds_read_b128 a[88:91], v8 offset:0
    v_mfma_f32_16x16x32_bf16 v[100:103], a[8:11], a[60:63], v[100:103]
    ds_read_b64_tr_b16 a[32:33], v9 offset:14496
    v_mfma_f32_16x16x32_bf16 v[68:71], a[4:7], a[60:63], v[68:71]
    ds_read_b64_tr_b16 a[34:35], v9 offset:16304
    v_mfma_f32_16x16x32_bf16 v[36:39], a[0:3], a[60:63], v[36:39]
    ds_read_b128 a[92:95], v8 offset:2048
    v_mfma_f32_16x16x32_bf16 v[40:43], a[0:3], a[64:67], v[40:43]
    v_mfma_f32_16x16x32_bf16 v[72:75], a[4:7], a[64:67], v[72:75]
    ds_read_b64_tr_b16 a[36:37], v9 offset:14528
    v_mfma_f32_16x16x32_bf16 v[104:107], a[8:11], a[64:67], v[104:107]
    ds_read_b64_tr_b16 a[38:39], v9 offset:16336
    v_mfma_f32_16x16x32_bf16 v[136:139], a[12:15], a[64:67], v[136:139]
    ds_read_b128 a[96:99], v8 offset:4096
    v_mfma_f32_16x16x32_bf16 v[168:171], a[16:19], a[64:67], v[168:171]
    ds_read_b64_tr_b16 a[40:41], v9 offset:14560
    v_mfma_f32_16x16x32_bf16 v[200:203], a[20:23], a[64:67], v[200:203]
    v_mfma_f32_16x16x32_bf16 a[160:163], a[24:27], a[64:67], a[160:163]
    ds_read_b64_tr_b16 a[42:43], v9 offset:16368
    v_mfma_f32_16x16x32_bf16 a[164:167], a[24:27], a[68:71], a[164:167]
    ds_read_b128 a[100:103], v8 offset:6144
    v_mfma_f32_16x16x32_bf16 v[204:207], a[20:23], a[68:71], v[204:207]
    s_add_u32 m0, s34, s43
    s_mov_b64 exec, s[28:29]
    v_mfma_f32_16x16x32_bf16 v[172:175], a[16:19], a[68:71], v[172:175]
    buffer_load_dwordx4 v4, s[8:11], s35 offen offset:0 lds
    v_mfma_f32_16x16x32_bf16 v[140:143], a[12:15], a[68:71], v[140:143]
    v_mfma_f32_16x16x32_bf16 v[108:111], a[8:11], a[68:71], v[108:111]
    s_add_u32 s35, s35, 13440
    v_mfma_f32_16x16x32_bf16 v[76:79], a[4:7], a[68:71], v[76:79]
    buffer_load_dwordx4 v4, s[8:11], s35 offen offset:896 lds
    v_mfma_f32_16x16x32_bf16 v[44:47], a[0:3], a[68:71], v[44:47]
    s_add_u32 s35, s35, 13424
    v_mfma_f32_16x16x32_bf16 v[48:51], a[0:3], a[72:75], v[48:51]
    v_mfma_f32_16x16x32_bf16 v[80:83], a[4:7], a[72:75], v[80:83]
    buffer_load_dwordx4 v4, s[8:11], s35 offen offset:1808 lds
    v_mfma_f32_16x16x32_bf16 v[112:115], a[8:11], a[72:75], v[112:115]
    s_add_u32 s35, s35, 13440
    v_mfma_f32_16x16x32_bf16 v[144:147], a[12:15], a[72:75], v[144:147]
    buffer_load_dwordx4 v4, s[8:11], s35 offen offset:2704 lds
    v_mfma_f32_16x16x32_bf16 v[176:179], a[16:19], a[72:75], v[176:179]
    s_mov_b64 exec, -1
    s_add_u32 s35, s35, 189072
    v_mfma_f32_16x16x32_bf16 v[208:211], a[20:23], a[72:75], v[208:211]
    v_mfma_f32_16x16x32_bf16 a[168:171], a[24:27], a[72:75], a[168:171]
    ds_read_b64_tr_b16 a[44:45], v9 offset:14592
    v_mfma_f32_16x16x32_bf16 a[172:175], a[24:27], a[76:79], a[172:175]
    ds_read_b64_tr_b16 a[46:47], v9 offset:16400
    v_mfma_f32_16x16x32_bf16 v[212:215], a[20:23], a[76:79], v[212:215]
    ds_read_b128 a[104:107], v8 offset:8192
    v_mfma_f32_16x16x32_bf16 v[180:183], a[16:19], a[76:79], v[180:183]
    s_add_u32 m0, s32, s38
    v_mfma_f32_16x16x32_bf16 v[148:151], a[12:15], a[76:79], v[148:151]
    v_mfma_f32_16x16x32_bf16 v[116:119], a[8:11], a[76:79], v[116:119]
    s_mov_b32 s40, s36
    v_mfma_f32_16x16x32_bf16 v[84:87], a[4:7], a[76:79], v[84:87]
    buffer_load_dwordx4 v2, s[4:7], s40 offen offset:0 lds
    v_mfma_f32_16x16x32_bf16 v[52:55], a[0:3], a[76:79], v[52:55]
    ds_read_b64_tr_b16 a[48:49], v9 offset:14624
    v_mfma_f32_16x16x32_bf16 v[56:59], a[0:3], a[80:83], v[56:59]
    ds_read_b64_tr_b16 a[50:51], v9 offset:16432
    v_mfma_f32_16x16x32_bf16 v[88:91], a[4:7], a[80:83], v[88:91]
    v_mfma_f32_16x16x32_bf16 v[120:123], a[8:11], a[80:83], v[120:123]
    buffer_load_dwordx4 v3, s[4:7], s40 offen offset:1024 lds
    v_mfma_f32_16x16x32_bf16 v[152:155], a[12:15], a[80:83], v[152:155]
    ds_read_b128 a[108:111], v8 offset:10240
    v_mfma_f32_16x16x32_bf16 v[184:187], a[16:19], a[80:83], v[184:187]
    ds_read_b64_tr_b16 a[52:53], v9 offset:14656
    v_mfma_f32_16x16x32_bf16 v[216:219], a[20:23], a[80:83], v[216:219]
    ds_read_b64_tr_b16 a[54:55], v9 offset:16464
    v_mfma_f32_16x16x32_bf16 a[176:179], a[24:27], a[80:83], a[176:179]
    v_mfma_f32_16x16x32_bf16 a[180:183], a[24:27], a[84:87], a[180:183]
    s_add_u32 s40, s40, 30720
    v_mfma_f32_16x16x32_bf16 v[220:223], a[20:23], a[84:87], v[220:223]
    buffer_load_dwordx4 v2, s[4:7], s40 offen offset:2048 lds
    v_mfma_f32_16x16x32_bf16 v[188:191], a[16:19], a[84:87], v[188:191]
    ds_read_b128 a[112:115], v8 offset:12288
    v_mfma_f32_16x16x32_bf16 v[156:159], a[12:15], a[84:87], v[156:159]
    ds_read_b128 a[116:119], v8 offset:14336
    v_mfma_f32_16x16x32_bf16 v[124:127], a[8:11], a[84:87], v[124:127]
    v_mfma_f32_16x16x32_bf16 v[92:95], a[4:7], a[84:87], v[92:95]
    buffer_load_dwordx4 v3, s[4:7], s40 offen offset:3072 lds
    v_mfma_f32_16x16x32_bf16 v[60:63], a[0:3], a[84:87], v[60:63]
    v_add_u32 v8, s31, v5
    v_mfma_f32_16x16x32_bf16 a[136:139], a[16:19], a[148:151], a[136:139]
    v_add_u32 v9, s34, v7
    v_mfma_f32_16x16x32_bf16 a[140:143], a[20:23], a[148:151], a[140:143]
    v_mfma_f32_16x16x32_bf16 a[144:147], a[24:27], a[148:151], a[144:147]
    s_waitcnt vmcnt(10) lgkmcnt(0)
    s_barrier
    v_mfma_f32_16x16x32_bf16 v[32:35], a[28:31], a[88:91], v[32:35]
    s_cmp_ge_u32 s37, 14
    s_cselect_b32 s10, 0, s10
    v_mfma_f32_16x16x32_bf16 v[64:67], a[32:35], a[88:91], v[64:67]
    ds_read_b64_tr_b16 a[0:1], v9 offset:0
    v_mfma_f32_16x16x32_bf16 v[96:99], a[36:39], a[88:91], v[96:99]
    ds_read_b64_tr_b16 a[2:3], v9 offset:1808
    v_mfma_f32_16x16x32_bf16 v[128:131], a[40:43], a[88:91], v[128:131]
    ds_read_b128 a[56:59], v8 offset:0
    v_mfma_f32_16x16x32_bf16 v[160:163], a[44:47], a[88:91], v[160:163]
    v_mfma_f32_16x16x32_bf16 v[192:195], a[48:51], a[88:91], v[192:195]
    ds_read_b64_tr_b16 a[4:5], v9 offset:32
    v_mfma_f32_16x16x32_bf16 a[152:155], a[52:55], a[88:91], a[152:155]
    ds_read_b64_tr_b16 a[6:7], v9 offset:1840
    v_mfma_f32_16x16x32_bf16 a[156:159], a[52:55], a[92:95], a[156:159]
    ds_read_b128 a[60:63], v8 offset:2048
    v_mfma_f32_16x16x32_bf16 v[196:199], a[48:51], a[92:95], v[196:199]
    v_mfma_f32_16x16x32_bf16 v[164:167], a[44:47], a[92:95], v[164:167]
    ds_read_b64_tr_b16 a[8:9], v9 offset:64
    v_mfma_f32_16x16x32_bf16 v[132:135], a[40:43], a[92:95], v[132:135]
    ds_read_b64_tr_b16 a[10:11], v9 offset:1872
    v_mfma_f32_16x16x32_bf16 v[100:103], a[36:39], a[92:95], v[100:103]
    ds_read_b128 a[64:67], v8 offset:4096
    v_mfma_f32_16x16x32_bf16 v[68:71], a[32:35], a[92:95], v[68:71]
    ds_read_b64_tr_b16 a[12:13], v9 offset:96
    v_mfma_f32_16x16x32_bf16 v[36:39], a[28:31], a[92:95], v[36:39]
    v_mfma_f32_16x16x32_bf16 v[40:43], a[28:31], a[96:99], v[40:43]
    ds_read_b64_tr_b16 a[14:15], v9 offset:1904
    v_mfma_f32_16x16x32_bf16 v[72:75], a[32:35], a[96:99], v[72:75]
    ds_read_b128 a[68:71], v8 offset:6144
    v_mfma_f32_16x16x32_bf16 v[104:107], a[36:39], a[96:99], v[104:107]
    s_add_u32 m0, s33, s39
    s_mov_b64 exec, s[28:29]
    v_mfma_f32_16x16x32_bf16 v[136:139], a[40:43], a[96:99], v[136:139]
    v_mfma_f32_16x16x32_bf16 v[168:171], a[44:47], a[96:99], v[168:171]
    buffer_load_dwordx4 v4, s[8:11], s35 offen offset:0 lds
    v_mfma_f32_16x16x32_bf16 v[200:203], a[48:51], a[96:99], v[200:203]
    s_add_u32 s35, s35, 13440
    v_mfma_f32_16x16x32_bf16 a[160:163], a[52:55], a[96:99], a[160:163]
    buffer_load_dwordx4 v4, s[8:11], s35 offen offset:896 lds
    v_mfma_f32_16x16x32_bf16 a[164:167], a[52:55], a[100:103], a[164:167]
    s_add_u32 s35, s35, 13424
    v_mfma_f32_16x16x32_bf16 v[204:207], a[48:51], a[100:103], v[204:207]
    v_mfma_f32_16x16x32_bf16 v[172:175], a[44:47], a[100:103], v[172:175]
    buffer_load_dwordx4 v4, s[8:11], s35 offen offset:1808 lds
    v_mfma_f32_16x16x32_bf16 v[140:143], a[40:43], a[100:103], v[140:143]
    s_add_u32 s35, s35, 13440
    v_mfma_f32_16x16x32_bf16 v[108:111], a[36:39], a[100:103], v[108:111]
    buffer_load_dwordx4 v4, s[8:11], s35 offen offset:2704 lds
    v_mfma_f32_16x16x32_bf16 v[76:79], a[32:35], a[100:103], v[76:79]
    v_mfma_f32_16x16x32_bf16 v[44:47], a[28:31], a[100:103], v[44:47]
    s_mov_b64 exec, -1
    s_add_u32 s35, s35, 189072
    v_mfma_f32_16x16x32_bf16 v[48:51], a[28:31], a[104:107], v[48:51]
    ds_read_b64_tr_b16 a[16:17], v9 offset:128
    v_mfma_f32_16x16x32_bf16 v[80:83], a[32:35], a[104:107], v[80:83]
    ds_read_b64_tr_b16 a[18:19], v9 offset:1936
    v_mfma_f32_16x16x32_bf16 v[112:115], a[36:39], a[104:107], v[112:115]
    ds_read_b128 a[72:75], v8 offset:8192
    v_mfma_f32_16x16x32_bf16 v[144:147], a[40:43], a[104:107], v[144:147]
    v_mfma_f32_16x16x32_bf16 v[176:179], a[44:47], a[104:107], v[176:179]
    s_add_u32 m0, s32, s42
    v_mfma_f32_16x16x32_bf16 v[208:211], a[48:51], a[104:107], v[208:211]
    s_add_u32 s40, s36, 65536
    v_mfma_f32_16x16x32_bf16 a[168:171], a[52:55], a[104:107], a[168:171]
    buffer_load_dwordx4 v2, s[4:7], s40 offen offset:0 lds
    v_mfma_f32_16x16x32_bf16 a[172:175], a[52:55], a[108:111], a[172:175]
    v_mfma_f32_16x16x32_bf16 v[212:215], a[48:51], a[108:111], v[212:215]
    ds_read_b64_tr_b16 a[20:21], v9 offset:160
    v_mfma_f32_16x16x32_bf16 v[180:183], a[44:47], a[108:111], v[180:183]
    ds_read_b64_tr_b16 a[22:23], v9 offset:1968
    v_mfma_f32_16x16x32_bf16 v[148:151], a[40:43], a[108:111], v[148:151]
    buffer_load_dwordx4 v3, s[4:7], s40 offen offset:1024 lds
    v_mfma_f32_16x16x32_bf16 v[116:119], a[36:39], a[108:111], v[116:119]
    ds_read_b128 a[76:79], v8 offset:10240
    v_mfma_f32_16x16x32_bf16 v[84:87], a[32:35], a[108:111], v[84:87]
    v_mfma_f32_16x16x32_bf16 v[52:55], a[28:31], a[108:111], v[52:55]
    ds_read_b64_tr_b16 a[24:25], v9 offset:192
    v_mfma_f32_16x16x32_bf16 v[56:59], a[28:31], a[112:115], v[56:59]
    ds_read_b64_tr_b16 a[26:27], v9 offset:2000
    v_mfma_f32_16x16x32_bf16 v[88:91], a[32:35], a[112:115], v[88:91]
    s_add_u32 s40, s40, 30720
    v_mfma_f32_16x16x32_bf16 v[120:123], a[36:39], a[112:115], v[120:123]
    v_mfma_f32_16x16x32_bf16 v[152:155], a[40:43], a[112:115], v[152:155]
    buffer_load_dwordx4 v2, s[4:7], s40 offen offset:2048 lds
    v_mfma_f32_16x16x32_bf16 v[184:187], a[44:47], a[112:115], v[184:187]
    ds_read_b128 a[80:83], v8 offset:12288
    v_mfma_f32_16x16x32_bf16 v[216:219], a[48:51], a[112:115], v[216:219]
    ds_read_b128 a[84:87], v8 offset:14336
    v_mfma_f32_16x16x32_bf16 a[176:179], a[52:55], a[112:115], a[176:179]
    buffer_load_dwordx4 v3, s[4:7], s40 offen offset:3072 lds
    v_mfma_f32_16x16x32_bf16 a[180:183], a[52:55], a[116:119], a[180:183]
    v_mfma_f32_16x16x32_bf16 v[220:223], a[48:51], a[116:119], v[220:223]
    s_mov_b32 s40, s30
    s_mov_b32 s30, s31
    v_mfma_f32_16x16x32_bf16 v[188:191], a[44:47], a[116:119], v[188:191]
    s_mov_b32 s31, s32
    s_mov_b32 s32, s40
    v_mfma_f32_16x16x32_bf16 v[156:159], a[40:43], a[116:119], v[156:159]
    s_xor_b32 s33, s33, 28928
    s_xor_b32 s34, s34, 28928
    v_mfma_f32_16x16x32_bf16 v[124:127], a[36:39], a[116:119], v[124:127]
    v_mfma_f32_16x16x32_bf16 v[92:95], a[32:35], a[116:119], v[92:95]
    s_add_u32 s36, s36, 128
    s_add_u32 s37, s37, 1
    v_mfma_f32_16x16x32_bf16 v[60:63], a[28:31], a[116:119], v[60:63]
    v_add_u32 v8, s30, v6
    v_mfma_f32_16x16x32_bf16 a[136:139], a[44:47], a[148:151], a[136:139]
    v_add_u32 v9, s33, v7
    v_mfma_f32_16x16x32_bf16 a[140:143], a[48:51], a[148:151], a[140:143]
    v_mfma_f32_16x16x32_bf16 a[144:147], a[52:55], a[148:151], a[144:147]
    s_cmp_lt_u32 s37, 16
    s_cbranch_scc1 P1_loopW1
P1_endW:
    v_lshrrev_b32 v10, 4, v1
    v_lshlrev_b32 v10, 4, v10
    s_mul_i32 s40, s20, 448
    s_add_u32 s40, s40, 156160
    v_add_u32 v10, s40, v10
    s_mov_b32 s42, 1069066811
    s_cbranch_vccnz P1_o1W
    v_accvgpr_read_b32 v240, a120
    v_accvgpr_read_b32 v241, a121
    v_accvgpr_read_b32 v242, a122
    v_accvgpr_read_b32 v243, a123
    v_mul_f32 v240, s42, v240
    v_mul_f32 v241, s42, v241
    v_mul_f32 v242, s42, v242
    v_mul_f32 v243, s42, v243
    ds_write_b128 v10, v[240:243] offset:0
    v_accvgpr_read_b32 v244, a124
    v_accvgpr_read_b32 v245, a125
    v_accvgpr_read_b32 v246, a126
    v_accvgpr_read_b32 v247, a127
    v_mul_f32 v244, s42, v244
    v_mul_f32 v245, s42, v245
    v_mul_f32 v246, s42, v246
    v_mul_f32 v247, s42, v247
    ds_write_b128 v10, v[244:247] offset:64
    v_accvgpr_read_b32 v248, a128
    v_accvgpr_read_b32 v249, a129
    v_accvgpr_read_b32 v250, a130
    v_accvgpr_read_b32 v251, a131
    v_mul_f32 v248, s42, v248
    v_mul_f32 v249, s42, v249
    v_mul_f32 v250, s42, v250
    v_mul_f32 v251, s42, v251
    ds_write_b128 v10, v[248:251] offset:128
    v_accvgpr_read_b32 v252, a132
    v_accvgpr_read_b32 v253, a133
    v_accvgpr_read_b32 v254, a134
    v_accvgpr_read_b32 v255, a135
    v_mul_f32 v252, s42, v252
    v_mul_f32 v253, s42, v253
    v_mul_f32 v254, s42, v254
    v_mul_f32 v255, s42, v255
    ds_write_b128 v10, v[252:255] offset:192
    s_branch P1_o2W
P1_o1W:
    v_accvgpr_read_b32 v240, a136
    v_accvgpr_read_b32 v241, a137
    v_accvgpr_read_b32 v242, a138
    v_accvgpr_read_b32 v243, a139
    v_mul_f32 v240, s42, v240
    v_mul_f32 v241, s42, v241
    v_mul_f32 v242, s42, v242
    v_mul_f32 v243, s42, v243
    ds_write_b128 v10, v[240:243] offset:256
    v_accvgpr_read_b32 v244, a140
    v_accvgpr_read_b32 v245, a141
    v_accvgpr_read_b32 v246, a142
    v_accvgpr_read_b32 v247, a143
    v_mul_f32 v244, s42, v244
    v_mul_f32 v245, s42, v245
    v_mul_f32 v246, s42, v246
    v_mul_f32 v247, s42, v247
    ds_write_b128 v10, v[244:247] offset:320
    v_accvgpr_read_b32 v248, a144
    v_accvgpr_read_b32 v249, a145
    v_accvgpr_read_b32 v250, a146
    v_accvgpr_read_b32 v251, a147
    v_mul_f32 v248, s42, v248
    v_mul_f32 v249, s42, v249
    v_mul_f32 v250, s42, v250
    v_mul_f32 v251, s42, v251
    ds_write_b128 v10, v[248:251] offset:384
P1_o2W:
    s_waitcnt vmcnt(0)
    v_lshlrev_b32 v28, 16, v28
    v_mul_f32 v28, s42, v28
    s_lshl_b32 s40, s18, 8
    s_add_u32 s40, s40, 157184
    v_lshl_add_u32 v0, v1, 2, s40
    ds_write_b32 v0, v28
    v_lshrrev_b32 v8, 4, v1
    v_and_b32 v9, 15, v1
    v_lshlrev_b32 v6, 4, v1
    s_lshl_b32 s40, s100, 2
    s_add_u32 s40, s40, s18
    s_mul_i32 s40, s40, 589824
    v_add_u32 v2, s40, v6
    v_add_u32 v3, 147456, v2
    v_lshlrev_b32 v4, 14, v8
    v_lshl_add_u32 v4, v9, 4, v4
    s_lshl_b32 s40, s18, 12
    s_lshl_b32 s41, s101, 8
    s_add_u32 s40, s40, s41
    v_add_u32 v4, s40, v4
    s_xor_b32 s41, s23, 1
    s_lshl_b32 s41, s41, 7
    v_xor_b32 v4, s41, v4
    v_and_b32 v5, 1, v8
    v_lshrrev_b32 v9, 2, v9
    v_lshl_add_u32 v5, v5, 2, v9
    v_mul_u32_u24 v7, 1056, v5
    v_lshrrev_b32 v5, 1, v8
    v_lshl_add_u32 v7, v5, 8, v7
    v_and_b32 v5, 3, v1
    v_lshl_add_u32 v7, v5, 3, v7
    v_add_u32 v5, 992, v4
    s_mul_i32 s39, s18, 2112
    s_mov_b32 s86, 0
    s_mov_b32 s8, s60
    s_and_b32 s9, s61, 0xffff
    s_mov_b32 s10, 7340032
    s_mov_b32 s11, 0x20000
    s_add_u32 s4, s66, 4194304
    s_addc_u32 s5, s67, 0
    s_and_b32 s5, s5, 0xffff
    s_mov_b32 s6, 18874368
    s_mov_b32 s7, 0x20000
    s_cmp_eq_u32 s23, 0
    s_cselect_b32 s35, 1441792, 0
    s_cselect_b32 s36, 38912, 0
    s_cselect_b32 s29, 13, 15
    s_mul_i32 s27, s3, 3670016
    s_add_u32 s35, s35, s27
    s_lshl_b32 s40, s3, 14
    s_add_u32 s36, s36, s40
    s_mov_b32 s30, 262144
    s_mov_b32 s31, 458752
    s_lshl_b32 s24, s21, 8
    s_lshl_b32 s25, s100, 8
    s_mov_b32 s47, 35088
    s_cmp_eq_u32 s23, 0
    s_cselect_b32 s47, 6160, s47
    s_waitcnt lgkmcnt(0)
    s_barrier
    ds_read_b128 v[240:243], v10 offset:0
    ds_read_b128 v[244:247], v10 offset:1024
    ds_read_b128 v[248:251], v10 offset:64
    ds_read_b128 v[252:255], v10 offset:1088
    s_mov_b32 s92, s48
    s_and_b32 s93, s49, 0xffff
    s_mov_b32 s94, 4194304
    s_mov_b32 s95, 0x20000
    s_mov_b32 s96, s62
    s_and_b32 s97, s63, 0xffff
    s_mov_b32 s98, 4194304
    s_mov_b32 s99, 0x20000
    s_lshl_b32 s32, s100, 2
    s_add_u32 s32, s32, s18
    s_lshl_b32 s32, s32, 1
    s_add_u32 s32, s32, s3
    s_lshl_b32 s32, s32, 16
    s_lshl_b32 s33, s101, 1
    s_add_u32 s33, s33, 1
    s_sub_u32 s33, s33, s23
    s_lshl_b32 s33, s33, 7
    s_add_u32 s32, s32, s33
    s_add_u32 s33, s32, 32768
    s_lshl_b32 s37, s18, 12
    s_add_u32 s37, s37, 114688
    s_mov_b32 s38, s32
    s_lshl_b32 s40, s21, 4
    s_lshl_b32 s41, s19, 3
    s_add_u32 s40, s40, s41
    s_mul_i32 s40, s40, 144
    s_lshl_b32 s41, s22, 1
    s_add_u32 s46, s40, s41
    s_add_u32 s28, s46, 65
    s_add_u32 s43, s46, 64
    s_add_u32 s46, s46, s20
    s_add_u32 s40, s40, s22
    s_add_u32 s40, s40, 96
    s_cmp_eq_u32 s20, 0
    s_cselect_b32 s43, s43, s40
    s_lshl_b32 s46, s46, 10
    s_add_u32 s46, s46, 4194304
    s_lshl_b32 s43, s43, 10
    s_add_u32 s43, s43, 4194304
    s_lshl_b32 s28, s28, 10
    s_add_u32 s28, s28, 4194304
    v_mul_f32 v13, s42, v13
    v_mul_f32 v15, s42, v15
    v_mul_f32 v17, s42, v17
    v_mul_f32 v19, s42, v19
    v_mul_f32 v21, s42, v21
    v_mul_f32 v23, s42, v23
    v_mul_f32 v25, s42, v25
    v_mul_f32 v27, s42, v27
    s_waitcnt lgkmcnt(0)
    s_mov_b32 s40, s46
    v_pk_fma_f32 v[224:225], v[240:241], v[12:13], v[244:245] op_sel:[0,0,0] op_sel_hi:[1,0,1] neg_lo:[0,1,0] neg_hi:[0,1,0]
    v_pk_fma_f32 v[226:227], v[242:243], v[12:13], v[246:247] op_sel:[0,0,0] op_sel_hi:[1,0,1] neg_lo:[0,1,0] neg_hi:[0,1,0]
    v_pk_fma_f32 v[228:229], v[248:249], v[12:13], v[252:253] op_sel:[0,0,0] op_sel_hi:[1,0,1] neg_lo:[0,1,0] neg_hi:[0,1,0]
    v_pk_fma_f32 v[230:231], v[250:251], v[12:13], v[254:255] op_sel:[0,0,0] op_sel_hi:[1,0,1] neg_lo:[0,1,0] neg_hi:[0,1,0]
    v_pk_fma_f32 v[32:33], v[32:33], v[12:13], v[224:225] op_sel:[0,1,0] op_sel_hi:[1,1,1]
    v_pk_fma_f32 v[34:35], v[34:35], v[12:13], v[226:227] op_sel:[0,1,0] op_sel_hi:[1,1,1]
    v_pk_fma_f32 v[64:65], v[64:65], v[12:13], v[228:229] op_sel:[0,1,0] op_sel_hi:[1,1,1]
    v_pk_fma_f32 v[66:67], v[66:67], v[12:13], v[230:231] op_sel:[0,1,0] op_sel_hi:[1,1,1]
    v_exp_f32 v224, v32
    v_exp_f32 v225, v33
    v_exp_f32 v226, v34
    v_exp_f32 v227, v35
    v_exp_f32 v228, v64
    v_exp_f32 v229, v65
    v_exp_f32 v230, v66
    v_exp_f32 v231, v67
    v_pk_fma_f32 v[232:233], v[224:225], 0.5, 1.0 op_sel:[0,0,0] op_sel_hi:[1,0,0]
    v_pk_fma_f32 v[234:235], v[226:227], 0.5, 1.0 op_sel:[0,0,0] op_sel_hi:[1,0,0]
    v_pk_fma_f32 v[236:237], v[228:229], 0.5, 1.0 op_sel:[0,0,0] op_sel_hi:[1,0,0]
    v_pk_fma_f32 v[238:239], v[230:231], 0.5, 1.0 op_sel:[0,0,0] op_sel_hi:[1,0,0]
    s_add_u32 m0, s39, 16896
    s_add_u32 s45, s35, s30
    buffer_load_dwordx4 v4, s[8:11], s35 offen lds
    v_pk_fma_f32 v[224:225], v[224:225], v[232:233], 1.0 op_sel:[0,0,0] op_sel_hi:[1,1,0]
    v_pk_fma_f32 v[226:227], v[226:227], v[234:235], 1.0 op_sel:[0,0,0] op_sel_hi:[1,1,0]
    v_pk_fma_f32 v[228:229], v[228:229], v[236:237], 1.0 op_sel:[0,0,0] op_sel_hi:[1,1,0]
    v_pk_fma_f32 v[230:231], v[230:231], v[238:239], 1.0 op_sel:[0,0,0] op_sel_hi:[1,1,0]
    v_rcp_f32 v224, v224
    v_rcp_f32 v225, v225
    v_rcp_f32 v226, v226
    v_rcp_f32 v227, v227
    v_rcp_f32 v228, v228
    v_rcp_f32 v229, v229
    v_rcp_f32 v230, v230
    v_rcp_f32 v231, v231
    v_pk_fma_f32 v[224:225], v[32:33], v[224:225], v[32:33] op_sel:[0,0,0] op_sel_hi:[1,1,1] neg_lo:[1,0,0] neg_hi:[1,0,0]
    v_pk_fma_f32 v[226:227], v[34:35], v[226:227], v[34:35] op_sel:[0,0,0] op_sel_hi:[1,1,1] neg_lo:[1,0,0] neg_hi:[1,0,0]
    v_pk_fma_f32 v[228:229], v[64:65], v[228:229], v[64:65] op_sel:[0,0,0] op_sel_hi:[1,1,1] neg_lo:[1,0,0] neg_hi:[1,0,0]
    v_pk_fma_f32 v[230:231], v[66:67], v[230:231], v[66:67] op_sel:[0,0,0] op_sel_hi:[1,1,1] neg_lo:[1,0,0] neg_hi:[1,0,0]
    v_cvt_pk_bf16_f32 v32, v224, v225
    v_cvt_pk_bf16_f32 v33, v226, v227
    v_cvt_pk_bf16_f32 v34, v228, v229
    v_cvt_pk_bf16_f32 v35, v230, v231
    buffer_store_dwordx4 v[32:35], v6, s[12:15], s40 offen sc1
    s_add_u32 s40, s40, 147456
    v_pk_fma_f32 v[224:225], v[240:241], v[14:15], v[244:245] op_sel:[0,0,0] op_sel_hi:[1,0,1] neg_lo:[0,1,0] neg_hi:[0,1,0]
    v_pk_fma_f32 v[226:227], v[242:243], v[14:15], v[246:247] op_sel:[0,0,0] op_sel_hi:[1,0,1] neg_lo:[0,1,0] neg_hi:[0,1,0]
    v_pk_fma_f32 v[228:229], v[248:249], v[14:15], v[252:253] op_sel:[0,0,0] op_sel_hi:[1,0,1] neg_lo:[0,1,0] neg_hi:[0,1,0]
    v_pk_fma_f32 v[230:231], v[250:251], v[14:15], v[254:255] op_sel:[0,0,0] op_sel_hi:[1,0,1] neg_lo:[0,1,0] neg_hi:[0,1,0]
    v_pk_fma_f32 v[36:37], v[36:37], v[14:15], v[224:225] op_sel:[0,1,0] op_sel_hi:[1,1,1]
    v_pk_fma_f32 v[38:39], v[38:39], v[14:15], v[226:227] op_sel:[0,1,0] op_sel_hi:[1,1,1]
    v_pk_fma_f32 v[68:69], v[68:69], v[14:15], v[228:229] op_sel:[0,1,0] op_sel_hi:[1,1,1]
    v_pk_fma_f32 v[70:71], v[70:71], v[14:15], v[230:231] op_sel:[0,1,0] op_sel_hi:[1,1,1]
    v_exp_f32 v224, v36
    v_exp_f32 v225, v37
    v_exp_f32 v226, v38
    v_exp_f32 v227, v39
    v_exp_f32 v228, v68
    v_exp_f32 v229, v69
    v_exp_f32 v230, v70
    v_exp_f32 v231, v71
    v_pk_fma_f32 v[232:233], v[224:225], 0.5, 1.0 op_sel:[0,0,0] op_sel_hi:[1,0,0]
    v_pk_fma_f32 v[234:235], v[226:227], 0.5, 1.0 op_sel:[0,0,0] op_sel_hi:[1,0,0]
    v_pk_fma_f32 v[236:237], v[228:229], 0.5, 1.0 op_sel:[0,0,0] op_sel_hi:[1,0,0]
    v_pk_fma_f32 v[238:239], v[230:231], 0.5, 1.0 op_sel:[0,0,0] op_sel_hi:[1,0,0]
    buffer_load_dwordx4 v5, s[8:11], s35 offen offset:1056 lds
    v_pk_fma_f32 v[224:225], v[224:225], v[232:233], 1.0 op_sel:[0,0,0] op_sel_hi:[1,1,0]
    v_pk_fma_f32 v[226:227], v[226:227], v[234:235], 1.0 op_sel:[0,0,0] op_sel_hi:[1,1,0]
    v_pk_fma_f32 v[228:229], v[228:229], v[236:237], 1.0 op_sel:[0,0,0] op_sel_hi:[1,1,0]
    v_pk_fma_f32 v[230:231], v[230:231], v[238:239], 1.0 op_sel:[0,0,0] op_sel_hi:[1,1,0]
    v_rcp_f32 v224, v224
    v_rcp_f32 v225, v225
    v_rcp_f32 v226, v226
    v_rcp_f32 v227, v227
    v_rcp_f32 v228, v228
    v_rcp_f32 v229, v229
    v_rcp_f32 v230, v230
    v_rcp_f32 v231, v231
    v_pk_fma_f32 v[224:225], v[36:37], v[224:225], v[36:37] op_sel:[0,0,0] op_sel_hi:[1,1,1] neg_lo:[1,0,0] neg_hi:[1,0,0]
    v_pk_fma_f32 v[226:227], v[38:39], v[226:227], v[38:39] op_sel:[0,0,0] op_sel_hi:[1,1,1] neg_lo:[1,0,0] neg_hi:[1,0,0]
    v_pk_fma_f32 v[228:229], v[68:69], v[228:229], v[68:69] op_sel:[0,0,0] op_sel_hi:[1,1,1] neg_lo:[1,0,0] neg_hi:[1,0,0]
    v_pk_fma_f32 v[230:231], v[70:71], v[230:231], v[70:71] op_sel:[0,0,0] op_sel_hi:[1,1,1] neg_lo:[1,0,0] neg_hi:[1,0,0]
    v_cvt_pk_bf16_f32 v36, v224, v225
    v_cvt_pk_bf16_f32 v37, v226, v227
    v_cvt_pk_bf16_f32 v38, v228, v229
    v_cvt_pk_bf16_f32 v39, v230, v231
    buffer_store_dwordx4 v[36:39], v6, s[12:15], s40 offen sc1
    s_add_u32 s40, s40, 147456
    v_pk_fma_f32 v[224:225], v[240:241], v[16:17], v[244:245] op_sel:[0,0,0] op_sel_hi:[1,0,1] neg_lo:[0,1,0] neg_hi:[0,1,0]
    v_pk_fma_f32 v[226:227], v[242:243], v[16:17], v[246:247] op_sel:[0,0,0] op_sel_hi:[1,0,1] neg_lo:[0,1,0] neg_hi:[0,1,0]
    v_pk_fma_f32 v[228:229], v[248:249], v[16:17], v[252:253] op_sel:[0,0,0] op_sel_hi:[1,0,1] neg_lo:[0,1,0] neg_hi:[0,1,0]
    v_pk_fma_f32 v[230:231], v[250:251], v[16:17], v[254:255] op_sel:[0,0,0] op_sel_hi:[1,0,1] neg_lo:[0,1,0] neg_hi:[0,1,0]
    v_pk_fma_f32 v[40:41], v[40:41], v[16:17], v[224:225] op_sel:[0,1,0] op_sel_hi:[1,1,1]
    v_pk_fma_f32 v[42:43], v[42:43], v[16:17], v[226:227] op_sel:[0,1,0] op_sel_hi:[1,1,1]
    v_pk_fma_f32 v[72:73], v[72:73], v[16:17], v[228:229] op_sel:[0,1,0] op_sel_hi:[1,1,1]
    v_pk_fma_f32 v[74:75], v[74:75], v[16:17], v[230:231] op_sel:[0,1,0] op_sel_hi:[1,1,1]
    v_exp_f32 v224, v40
    v_exp_f32 v225, v41
    v_exp_f32 v226, v42
    v_exp_f32 v227, v43
    v_exp_f32 v228, v72
    v_exp_f32 v229, v73
    v_exp_f32 v230, v74
    v_exp_f32 v231, v75
    v_pk_fma_f32 v[232:233], v[224:225], 0.5, 1.0 op_sel:[0,0,0] op_sel_hi:[1,0,0]
    v_pk_fma_f32 v[234:235], v[226:227], 0.5, 1.0 op_sel:[0,0,0] op_sel_hi:[1,0,0]
    v_pk_fma_f32 v[236:237], v[228:229], 0.5, 1.0 op_sel:[0,0,0] op_sel_hi:[1,0,0]
    v_pk_fma_f32 v[238:239], v[230:231], 0.5, 1.0 op_sel:[0,0,0] op_sel_hi:[1,0,0]
    s_add_u32 m0, m0, 8448
    s_add_u32 s35, s35, s31
    buffer_load_dwordx4 v4, s[8:11], s45 offen lds
    v_pk_fma_f32 v[224:225], v[224:225], v[232:233], 1.0 op_sel:[0,0,0] op_sel_hi:[1,1,0]
    v_pk_fma_f32 v[226:227], v[226:227], v[234:235], 1.0 op_sel:[0,0,0] op_sel_hi:[1,1,0]
    v_pk_fma_f32 v[228:229], v[228:229], v[236:237], 1.0 op_sel:[0,0,0] op_sel_hi:[1,1,0]
    v_pk_fma_f32 v[230:231], v[230:231], v[238:239], 1.0 op_sel:[0,0,0] op_sel_hi:[1,1,0]
    v_rcp_f32 v224, v224
    v_rcp_f32 v225, v225
    v_rcp_f32 v226, v226
    v_rcp_f32 v227, v227
    v_rcp_f32 v228, v228
    v_rcp_f32 v229, v229
    v_rcp_f32 v230, v230
    v_rcp_f32 v231, v231
    v_pk_fma_f32 v[224:225], v[40:41], v[224:225], v[40:41] op_sel:[0,0,0] op_sel_hi:[1,1,1] neg_lo:[1,0,0] neg_hi:[1,0,0]
    v_pk_fma_f32 v[226:227], v[42:43], v[226:227], v[42:43] op_sel:[0,0,0] op_sel_hi:[1,1,1] neg_lo:[1,0,0] neg_hi:[1,0,0]
    v_pk_fma_f32 v[228:229], v[72:73], v[228:229], v[72:73] op_sel:[0,0,0] op_sel_hi:[1,1,1] neg_lo:[1,0,0] neg_hi:[1,0,0]
    v_pk_fma_f32 v[230:231], v[74:75], v[230:231], v[74:75] op_sel:[0,0,0] op_sel_hi:[1,1,1] neg_lo:[1,0,0] neg_hi:[1,0,0]
    v_cvt_pk_bf16_f32 v40, v224, v225
    v_cvt_pk_bf16_f32 v41, v226, v227
    v_cvt_pk_bf16_f32 v42, v228, v229
    v_cvt_pk_bf16_f32 v43, v230, v231
    buffer_store_dwordx4 v[40:43], v6, s[12:15], s40 offen sc1
    s_add_u32 s40, s40, 147456
    v_pk_fma_f32 v[224:225], v[240:241], v[18:19], v[244:245] op_sel:[0,0,0] op_sel_hi:[1,0,1] neg_lo:[0,1,0] neg_hi:[0,1,0]
    v_pk_fma_f32 v[226:227], v[242:243], v[18:19], v[246:247] op_sel:[0,0,0] op_sel_hi:[1,0,1] neg_lo:[0,1,0] neg_hi:[0,1,0]
    v_pk_fma_f32 v[228:229], v[248:249], v[18:19], v[252:253] op_sel:[0,0,0] op_sel_hi:[1,0,1] neg_lo:[0,1,0] neg_hi:[0,1,0]
    v_pk_fma_f32 v[230:231], v[250:251], v[18:19], v[254:255] op_sel:[0,0,0] op_sel_hi:[1,0,1] neg_lo:[0,1,0] neg_hi:[0,1,0]
    v_pk_fma_f32 v[44:45], v[44:45], v[18:19], v[224:225] op_sel:[0,1,0] op_sel_hi:[1,1,1]
    v_pk_fma_f32 v[46:47], v[46:47], v[18:19], v[226:227] op_sel:[0,1,0] op_sel_hi:[1,1,1]
    v_pk_fma_f32 v[76:77], v[76:77], v[18:19], v[228:229] op_sel:[0,1,0] op_sel_hi:[1,1,1]
    v_pk_fma_f32 v[78:79], v[78:79], v[18:19], v[230:231] op_sel:[0,1,0] op_sel_hi:[1,1,1]
    v_exp_f32 v224, v44
    v_exp_f32 v225, v45
    v_exp_f32 v226, v46
    v_exp_f32 v227, v47
    v_exp_f32 v228, v76
    v_exp_f32 v229, v77
    v_exp_f32 v230, v78
    v_exp_f32 v231, v79
    v_pk_fma_f32 v[232:233], v[224:225], 0.5, 1.0 op_sel:[0,0,0] op_sel_hi:[1,0,0]
    v_pk_fma_f32 v[234:235], v[226:227], 0.5, 1.0 op_sel:[0,0,0] op_sel_hi:[1,0,0]
    v_pk_fma_f32 v[236:237], v[228:229], 0.5, 1.0 op_sel:[0,0,0] op_sel_hi:[1,0,0]
    v_pk_fma_f32 v[238:239], v[230:231], 0.5, 1.0 op_sel:[0,0,0] op_sel_hi:[1,0,0]
    buffer_load_dwordx4 v5, s[8:11], s45 offen offset:1056 lds
    v_pk_fma_f32 v[224:225], v[224:225], v[232:233], 1.0 op_sel:[0,0,0] op_sel_hi:[1,1,0]
    v_pk_fma_f32 v[226:227], v[226:227], v[234:235], 1.0 op_sel:[0,0,0] op_sel_hi:[1,1,0]
    v_pk_fma_f32 v[228:229], v[228:229], v[236:237], 1.0 op_sel:[0,0,0] op_sel_hi:[1,1,0]
    v_pk_fma_f32 v[230:231], v[230:231], v[238:239], 1.0 op_sel:[0,0,0] op_sel_hi:[1,1,0]
    v_rcp_f32 v224, v224
    v_rcp_f32 v225, v225
    v_rcp_f32 v226, v226
    v_rcp_f32 v227, v227
    v_rcp_f32 v228, v228
    v_rcp_f32 v229, v229
    v_rcp_f32 v230, v230
    v_rcp_f32 v231, v231
    v_pk_fma_f32 v[224:225], v[44:45], v[224:225], v[44:45] op_sel:[0,0,0] op_sel_hi:[1,1,1] neg_lo:[1,0,0] neg_hi:[1,0,0]
    v_pk_fma_f32 v[226:227], v[46:47], v[226:227], v[46:47] op_sel:[0,0,0] op_sel_hi:[1,1,1] neg_lo:[1,0,0] neg_hi:[1,0,0]
    v_pk_fma_f32 v[228:229], v[76:77], v[228:229], v[76:77] op_sel:[0,0,0] op_sel_hi:[1,1,1] neg_lo:[1,0,0] neg_hi:[1,0,0]
    v_pk_fma_f32 v[230:231], v[78:79], v[230:231], v[78:79] op_sel:[0,0,0] op_sel_hi:[1,1,1] neg_lo:[1,0,0] neg_hi:[1,0,0]
    v_cvt_pk_bf16_f32 v44, v224, v225
    v_cvt_pk_bf16_f32 v45, v226, v227
    v_cvt_pk_bf16_f32 v46, v228, v229
    v_cvt_pk_bf16_f32 v47, v230, v231
    buffer_store_dwordx4 v[44:47], v6, s[12:15], s40 offen sc1
    s_add_u32 s40, s40, 147456
    v_pk_fma_f32 v[224:225], v[240:241], v[20:21], v[244:245] op_sel:[0,0,0] op_sel_hi:[1,0,1] neg_lo:[0,1,0] neg_hi:[0,1,0]
    v_pk_fma_f32 v[226:227], v[242:243], v[20:21], v[246:247] op_sel:[0,0,0] op_sel_hi:[1,0,1] neg_lo:[0,1,0] neg_hi:[0,1,0]
    v_pk_fma_f32 v[228:229], v[248:249], v[20:21], v[252:253] op_sel:[0,0,0] op_sel_hi:[1,0,1] neg_lo:[0,1,0] neg_hi:[0,1,0]
    v_pk_fma_f32 v[230:231], v[250:251], v[20:21], v[254:255] op_sel:[0,0,0] op_sel_hi:[1,0,1] neg_lo:[0,1,0] neg_hi:[0,1,0]
    v_pk_fma_f32 v[48:49], v[48:49], v[20:21], v[224:225] op_sel:[0,1,0] op_sel_hi:[1,1,1]
    v_pk_fma_f32 v[50:51], v[50:51], v[20:21], v[226:227] op_sel:[0,1,0] op_sel_hi:[1,1,1]
    v_pk_fma_f32 v[80:81], v[80:81], v[20:21], v[228:229] op_sel:[0,1,0] op_sel_hi:[1,1,1]
    v_pk_fma_f32 v[82:83], v[82:83], v[20:21], v[230:231] op_sel:[0,1,0] op_sel_hi:[1,1,1]
    v_exp_f32 v224, v48
    v_exp_f32 v225, v49
    v_exp_f32 v226, v50
    v_exp_f32 v227, v51
    v_exp_f32 v228, v80
    v_exp_f32 v229, v81
    v_exp_f32 v230, v82
    v_exp_f32 v231, v83
    v_pk_fma_f32 v[232:233], v[224:225], 0.5, 1.0 op_sel:[0,0,0] op_sel_hi:[1,0,0]
    v_pk_fma_f32 v[234:235], v[226:227], 0.5, 1.0 op_sel:[0,0,0] op_sel_hi:[1,0,0]
    v_pk_fma_f32 v[236:237], v[228:229], 0.5, 1.0 op_sel:[0,0,0] op_sel_hi:[1,0,0]
    v_pk_fma_f32 v[238:239], v[230:231], 0.5, 1.0 op_sel:[0,0,0] op_sel_hi:[1,0,0]
    s_add_u32 m0, s39, 33792
    s_add_u32 s45, s35, s30
    buffer_load_dwordx4 v4, s[8:11], s35 offen lds
    v_pk_fma_f32 v[224:225], v[224:225], v[232:233], 1.0 op_sel:[0,0,0] op_sel_hi:[1,1,0]
    v_pk_fma_f32 v[226:227], v[226:227], v[234:235], 1.0 op_sel:[0,0,0] op_sel_hi:[1,1,0]
    v_pk_fma_f32 v[228:229], v[228:229], v[236:237], 1.0 op_sel:[0,0,0] op_sel_hi:[1,1,0]
    v_pk_fma_f32 v[230:231], v[230:231], v[238:239], 1.0 op_sel:[0,0,0] op_sel_hi:[1,1,0]
    v_rcp_f32 v224, v224
    v_rcp_f32 v225, v225
    v_rcp_f32 v226, v226
    v_rcp_f32 v227, v227
    v_rcp_f32 v228, v228
    v_rcp_f32 v229, v229
    v_rcp_f32 v230, v230
    v_rcp_f32 v231, v231
    v_pk_fma_f32 v[224:225], v[48:49], v[224:225], v[48:49] op_sel:[0,0,0] op_sel_hi:[1,1,1] neg_lo:[1,0,0] neg_hi:[1,0,0]
    v_pk_fma_f32 v[226:227], v[50:51], v[226:227], v[50:51] op_sel:[0,0,0] op_sel_hi:[1,1,1] neg_lo:[1,0,0] neg_hi:[1,0,0]
    v_pk_fma_f32 v[228:229], v[80:81], v[228:229], v[80:81] op_sel:[0,0,0] op_sel_hi:[1,1,1] neg_lo:[1,0,0] neg_hi:[1,0,0]
    v_pk_fma_f32 v[230:231], v[82:83], v[230:231], v[82:83] op_sel:[0,0,0] op_sel_hi:[1,1,1] neg_lo:[1,0,0] neg_hi:[1,0,0]
    v_cvt_pk_bf16_f32 v48, v224, v225
    v_cvt_pk_bf16_f32 v49, v226, v227
    v_cvt_pk_bf16_f32 v50, v228, v229
    v_cvt_pk_bf16_f32 v51, v230, v231
    buffer_store_dwordx4 v[48:51], v6, s[12:15], s40 offen sc1
    s_add_u32 s40, s40, 147456
    v_pk_fma_f32 v[224:225], v[240:241], v[22:23], v[244:245] op_sel:[0,0,0] op_sel_hi:[1,0,1] neg_lo:[0,1,0] neg_hi:[0,1,0]
    v_pk_fma_f32 v[226:227], v[242:243], v[22:23], v[246:247] op_sel:[0,0,0] op_sel_hi:[1,0,1] neg_lo:[0,1,0] neg_hi:[0,1,0]
    v_pk_fma_f32 v[228:229], v[248:249], v[22:23], v[252:253] op_sel:[0,0,0] op_sel_hi:[1,0,1] neg_lo:[0,1,0] neg_hi:[0,1,0]
    v_pk_fma_f32 v[230:231], v[250:251], v[22:23], v[254:255] op_sel:[0,0,0] op_sel_hi:[1,0,1] neg_lo:[0,1,0] neg_hi:[0,1,0]
    v_pk_fma_f32 v[52:53], v[52:53], v[22:23], v[224:225] op_sel:[0,1,0] op_sel_hi:[1,1,1]
    v_pk_fma_f32 v[54:55], v[54:55], v[22:23], v[226:227] op_sel:[0,1,0] op_sel_hi:[1,1,1]
    v_pk_fma_f32 v[84:85], v[84:85], v[22:23], v[228:229] op_sel:[0,1,0] op_sel_hi:[1,1,1]
    v_pk_fma_f32 v[86:87], v[86:87], v[22:23], v[230:231] op_sel:[0,1,0] op_sel_hi:[1,1,1]
    v_exp_f32 v224, v52
    v_exp_f32 v225, v53
    v_exp_f32 v226, v54
    v_exp_f32 v227, v55
    v_exp_f32 v228, v84
    v_exp_f32 v229, v85
    v_exp_f32 v230, v86
    v_exp_f32 v231, v87
    v_pk_fma_f32 v[232:233], v[224:225], 0.5, 1.0 op_sel:[0,0,0] op_sel_hi:[1,0,0]
    v_pk_fma_f32 v[234:235], v[226:227], 0.5, 1.0 op_sel:[0,0,0] op_sel_hi:[1,0,0]
    v_pk_fma_f32 v[236:237], v[228:229], 0.5, 1.0 op_sel:[0,0,0] op_sel_hi:[1,0,0]
    v_pk_fma_f32 v[238:239], v[230:231], 0.5, 1.0 op_sel:[0,0,0] op_sel_hi:[1,0,0]
    buffer_load_dwordx4 v5, s[8:11], s35 offen offset:1056 lds
    v_pk_fma_f32 v[224:225], v[224:225], v[232:233], 1.0 op_sel:[0,0,0] op_sel_hi:[1,1,0]
    v_pk_fma_f32 v[226:227], v[226:227], v[234:235], 1.0 op_sel:[0,0,0] op_sel_hi:[1,1,0]
    v_pk_fma_f32 v[228:229], v[228:229], v[236:237], 1.0 op_sel:[0,0,0] op_sel_hi:[1,1,0]
    v_pk_fma_f32 v[230:231], v[230:231], v[238:239], 1.0 op_sel:[0,0,0] op_sel_hi:[1,1,0]
    v_rcp_f32 v224, v224
    v_rcp_f32 v225, v225
    v_rcp_f32 v226, v226
    v_rcp_f32 v227, v227
    v_rcp_f32 v228, v228
    v_rcp_f32 v229, v229
    v_rcp_f32 v230, v230
    v_rcp_f32 v231, v231
    v_pk_fma_f32 v[224:225], v[52:53], v[224:225], v[52:53] op_sel:[0,0,0] op_sel_hi:[1,1,1] neg_lo:[1,0,0] neg_hi:[1,0,0]
    v_pk_fma_f32 v[226:227], v[54:55], v[226:227], v[54:55] op_sel:[0,0,0] op_sel_hi:[1,1,1] neg_lo:[1,0,0] neg_hi:[1,0,0]
    v_pk_fma_f32 v[228:229], v[84:85], v[228:229], v[84:85] op_sel:[0,0,0] op_sel_hi:[1,1,1] neg_lo:[1,0,0] neg_hi:[1,0,0]
    v_pk_fma_f32 v[230:231], v[86:87], v[230:231], v[86:87] op_sel:[0,0,0] op_sel_hi:[1,1,1] neg_lo:[1,0,0] neg_hi:[1,0,0]
    v_cvt_pk_bf16_f32 v52, v224, v225
    v_cvt_pk_bf16_f32 v53, v226, v227
    v_cvt_pk_bf16_f32 v54, v228, v229
    v_cvt_pk_bf16_f32 v55, v230, v231
    buffer_store_dwordx4 v[52:55], v6, s[12:15], s40 offen sc1
    s_add_u32 s40, s40, 147456
    v_pk_fma_f32 v[224:225], v[240:241], v[24:25], v[244:245] op_sel:[0,0,0] op_sel_hi:[1,0,1] neg_lo:[0,1,0] neg_hi:[0,1,0]
    v_pk_fma_f32 v[226:227], v[242:243], v[24:25], v[246:247] op_sel:[0,0,0] op_sel_hi:[1,0,1] neg_lo:[0,1,0] neg_hi:[0,1,0]
    v_pk_fma_f32 v[228:229], v[248:249], v[24:25], v[252:253] op_sel:[0,0,0] op_sel_hi:[1,0,1] neg_lo:[0,1,0] neg_hi:[0,1,0]
    v_pk_fma_f32 v[230:231], v[250:251], v[24:25], v[254:255] op_sel:[0,0,0] op_sel_hi:[1,0,1] neg_lo:[0,1,0] neg_hi:[0,1,0]
    v_pk_fma_f32 v[56:57], v[56:57], v[24:25], v[224:225] op_sel:[0,1,0] op_sel_hi:[1,1,1]
    v_pk_fma_f32 v[58:59], v[58:59], v[24:25], v[226:227] op_sel:[0,1,0] op_sel_hi:[1,1,1]
    v_pk_fma_f32 v[88:89], v[88:89], v[24:25], v[228:229] op_sel:[0,1,0] op_sel_hi:[1,1,1]
    v_pk_fma_f32 v[90:91], v[90:91], v[24:25], v[230:231] op_sel:[0,1,0] op_sel_hi:[1,1,1]
    v_exp_f32 v224, v56
    v_exp_f32 v225, v57
    v_exp_f32 v226, v58
    v_exp_f32 v227, v59
    v_exp_f32 v228, v88
    v_exp_f32 v229, v89
    v_exp_f32 v230, v90
    v_exp_f32 v231, v91
    v_pk_fma_f32 v[232:233], v[224:225], 0.5, 1.0 op_sel:[0,0,0] op_sel_hi:[1,0,0]
    v_pk_fma_f32 v[234:235], v[226:227], 0.5, 1.0 op_sel:[0,0,0] op_sel_hi:[1,0,0]
    v_pk_fma_f32 v[236:237], v[228:229], 0.5, 1.0 op_sel:[0,0,0] op_sel_hi:[1,0,0]
    v_pk_fma_f32 v[238:239], v[230:231], 0.5, 1.0 op_sel:[0,0,0] op_sel_hi:[1,0,0]
    s_add_u32 m0, m0, 8448
    s_add_u32 s35, s35, s31
    buffer_load_dwordx4 v4, s[8:11], s45 offen lds
    v_pk_fma_f32 v[224:225], v[224:225], v[232:233], 1.0 op_sel:[0,0,0] op_sel_hi:[1,1,0]
    v_pk_fma_f32 v[226:227], v[226:227], v[234:235], 1.0 op_sel:[0,0,0] op_sel_hi:[1,1,0]
    v_pk_fma_f32 v[228:229], v[228:229], v[236:237], 1.0 op_sel:[0,0,0] op_sel_hi:[1,1,0]
    v_pk_fma_f32 v[230:231], v[230:231], v[238:239], 1.0 op_sel:[0,0,0] op_sel_hi:[1,1,0]
    v_rcp_f32 v224, v224
    v_rcp_f32 v225, v225
    v_rcp_f32 v226, v226
    v_rcp_f32 v227, v227
    v_rcp_f32 v228, v228
    v_rcp_f32 v229, v229
    v_rcp_f32 v230, v230
    v_rcp_f32 v231, v231
    v_pk_fma_f32 v[224:225], v[56:57], v[224:225], v[56:57] op_sel:[0,0,0] op_sel_hi:[1,1,1] neg_lo:[1,0,0] neg_hi:[1,0,0]
    v_pk_fma_f32 v[226:227], v[58:59], v[226:227], v[58:59] op_sel:[0,0,0] op_sel_hi:[1,1,1] neg_lo:[1,0,0] neg_hi:[1,0,0]
    v_pk_fma_f32 v[228:229], v[88:89], v[228:229], v[88:89] op_sel:[0,0,0] op_sel_hi:[1,1,1] neg_lo:[1,0,0] neg_hi:[1,0,0]
    v_pk_fma_f32 v[230:231], v[90:91], v[230:231], v[90:91] op_sel:[0,0,0] op_sel_hi:[1,1,1] neg_lo:[1,0,0] neg_hi:[1,0,0]
    v_cvt_pk_bf16_f32 v56, v224, v225
    v_cvt_pk_bf16_f32 v57, v226, v227
    v_cvt_pk_bf16_f32 v58, v228, v229
    v_cvt_pk_bf16_f32 v59, v230, v231
    buffer_store_dwordx4 v[56:59], v6, s[12:15], s40 offen sc1
    s_add_u32 s40, s40, 147456
    v_pk_fma_f32 v[224:225], v[240:241], v[26:27], v[244:245] op_sel:[0,0,0] op_sel_hi:[1,0,1] neg_lo:[0,1,0] neg_hi:[0,1,0]
    v_pk_fma_f32 v[226:227], v[242:243], v[26:27], v[246:247] op_sel:[0,0,0] op_sel_hi:[1,0,1] neg_lo:[0,1,0] neg_hi:[0,1,0]
    v_pk_fma_f32 v[228:229], v[248:249], v[26:27], v[252:253] op_sel:[0,0,0] op_sel_hi:[1,0,1] neg_lo:[0,1,0] neg_hi:[0,1,0]
    v_pk_fma_f32 v[230:231], v[250:251], v[26:27], v[254:255] op_sel:[0,0,0] op_sel_hi:[1,0,1] neg_lo:[0,1,0] neg_hi:[0,1,0]
    v_pk_fma_f32 v[60:61], v[60:61], v[26:27], v[224:225] op_sel:[0,1,0] op_sel_hi:[1,1,1]
    v_pk_fma_f32 v[62:63], v[62:63], v[26:27], v[226:227] op_sel:[0,1,0] op_sel_hi:[1,1,1]
    v_pk_fma_f32 v[92:93], v[92:93], v[26:27], v[228:229] op_sel:[0,1,0] op_sel_hi:[1,1,1]
    v_pk_fma_f32 v[94:95], v[94:95], v[26:27], v[230:231] op_sel:[0,1,0] op_sel_hi:[1,1,1]
    v_exp_f32 v224, v60
    v_exp_f32 v225, v61
    v_exp_f32 v226, v62
    v_exp_f32 v227, v63
    v_exp_f32 v228, v92
    v_exp_f32 v229, v93
    v_exp_f32 v230, v94
    v_exp_f32 v231, v95
    v_pk_fma_f32 v[232:233], v[224:225], 0.5, 1.0 op_sel:[0,0,0] op_sel_hi:[1,0,0]
    v_pk_fma_f32 v[234:235], v[226:227], 0.5, 1.0 op_sel:[0,0,0] op_sel_hi:[1,0,0]
    v_pk_fma_f32 v[236:237], v[228:229], 0.5, 1.0 op_sel:[0,0,0] op_sel_hi:[1,0,0]
    v_pk_fma_f32 v[238:239], v[230:231], 0.5, 1.0 op_sel:[0,0,0] op_sel_hi:[1,0,0]
    buffer_load_dwordx4 v5, s[8:11], s45 offen offset:1056 lds
    v_pk_fma_f32 v[224:225], v[224:225], v[232:233], 1.0 op_sel:[0,0,0] op_sel_hi:[1,1,0]
    v_pk_fma_f32 v[226:227], v[226:227], v[234:235], 1.0 op_sel:[0,0,0] op_sel_hi:[1,1,0]
    v_pk_fma_f32 v[228:229], v[228:229], v[236:237], 1.0 op_sel:[0,0,0] op_sel_hi:[1,1,0]
    v_pk_fma_f32 v[230:231], v[230:231], v[238:239], 1.0 op_sel:[0,0,0] op_sel_hi:[1,1,0]
    v_rcp_f32 v224, v224
    v_rcp_f32 v225, v225
    v_rcp_f32 v226, v226
    v_rcp_f32 v227, v227
    v_rcp_f32 v228, v228
    v_rcp_f32 v229, v229
    v_rcp_f32 v230, v230
    v_rcp_f32 v231, v231
    v_pk_fma_f32 v[224:225], v[60:61], v[224:225], v[60:61] op_sel:[0,0,0] op_sel_hi:[1,1,1] neg_lo:[1,0,0] neg_hi:[1,0,0]
    v_pk_fma_f32 v[226:227], v[62:63], v[226:227], v[62:63] op_sel:[0,0,0] op_sel_hi:[1,1,1] neg_lo:[1,0,0] neg_hi:[1,0,0]
    v_pk_fma_f32 v[228:229], v[92:93], v[228:229], v[92:93] op_sel:[0,0,0] op_sel_hi:[1,1,1] neg_lo:[1,0,0] neg_hi:[1,0,0]
    v_pk_fma_f32 v[230:231], v[94:95], v[230:231], v[94:95] op_sel:[0,0,0] op_sel_hi:[1,1,1] neg_lo:[1,0,0] neg_hi:[1,0,0]
    v_cvt_pk_bf16_f32 v60, v224, v225
    v_cvt_pk_bf16_f32 v61, v226, v227
    v_cvt_pk_bf16_f32 v62, v228, v229
    v_cvt_pk_bf16_f32 v63, v230, v231
    buffer_store_dwordx4 v[60:63], v6, s[12:15], s40 offen sc1
    ds_read_b128 v[48:51], v10 offset:128
    ds_read_b128 v[52:55], v10 offset:1152
    ds_read_b128 v[56:59], v10 offset:192
    ds_read_b128 v[60:63], v10 offset:1216
    s_waitcnt lgkmcnt(0)
    s_add_u32 s40, s46, 32768
    v_pk_fma_f32 v[224:225], v[48:49], v[12:13], v[52:53] op_sel:[0,0,0] op_sel_hi:[1,0,1] neg_lo:[0,1,0] neg_hi:[0,1,0]
    v_pk_fma_f32 v[226:227], v[50:51], v[12:13], v[54:55] op_sel:[0,0,0] op_sel_hi:[1,0,1] neg_lo:[0,1,0] neg_hi:[0,1,0]
    v_pk_fma_f32 v[228:229], v[56:57], v[12:13], v[60:61] op_sel:[0,0,0] op_sel_hi:[1,0,1] neg_lo:[0,1,0] neg_hi:[0,1,0]
    v_pk_fma_f32 v[230:231], v[58:59], v[12:13], v[62:63] op_sel:[0,0,0] op_sel_hi:[1,0,1] neg_lo:[0,1,0] neg_hi:[0,1,0]
    v_pk_fma_f32 v[96:97], v[96:97], v[12:13], v[224:225] op_sel:[0,1,0] op_sel_hi:[1,1,1]
    v_pk_fma_f32 v[98:99], v[98:99], v[12:13], v[226:227] op_sel:[0,1,0] op_sel_hi:[1,1,1]
    v_pk_fma_f32 v[128:129], v[128:129], v[12:13], v[228:229] op_sel:[0,1,0] op_sel_hi:[1,1,1]
    v_pk_fma_f32 v[130:131], v[130:131], v[12:13], v[230:231] op_sel:[0,1,0] op_sel_hi:[1,1,1]
    v_exp_f32 v224, v96
    v_exp_f32 v225, v97
    v_exp_f32 v226, v98
    v_exp_f32 v227, v99
    v_exp_f32 v228, v128
    v_exp_f32 v229, v129
    v_exp_f32 v230, v130
    v_exp_f32 v231, v131
    v_pk_fma_f32 v[232:233], v[224:225], 0.5, 1.0 op_sel:[0,0,0] op_sel_hi:[1,0,0]
    v_pk_fma_f32 v[234:235], v[226:227], 0.5, 1.0 op_sel:[0,0,0] op_sel_hi:[1,0,0]
    v_pk_fma_f32 v[236:237], v[228:229], 0.5, 1.0 op_sel:[0,0,0] op_sel_hi:[1,0,0]
    v_pk_fma_f32 v[238:239], v[230:231], 0.5, 1.0 op_sel:[0,0,0] op_sel_hi:[1,0,0]
    s_add_u32 m0, s39, 50688
    s_add_u32 s45, s35, s30
    buffer_load_dwordx4 v4, s[8:11], s35 offen lds
    v_pk_fma_f32 v[224:225], v[224:225], v[232:233], 1.0 op_sel:[0,0,0] op_sel_hi:[1,1,0]
    v_pk_fma_f32 v[226:227], v[226:227], v[234:235], 1.0 op_sel:[0,0,0] op_sel_hi:[1,1,0]
    v_pk_fma_f32 v[228:229], v[228:229], v[236:237], 1.0 op_sel:[0,0,0] op_sel_hi:[1,1,0]
    v_pk_fma_f32 v[230:231], v[230:231], v[238:239], 1.0 op_sel:[0,0,0] op_sel_hi:[1,1,0]
    v_rcp_f32 v224, v224
    v_rcp_f32 v225, v225
    v_rcp_f32 v226, v226
    v_rcp_f32 v227, v227
    v_rcp_f32 v228, v228
    v_rcp_f32 v229, v229
    v_rcp_f32 v230, v230
    v_rcp_f32 v231, v231
    v_pk_fma_f32 v[224:225], v[96:97], v[224:225], v[96:97] op_sel:[0,0,0] op_sel_hi:[1,1,1] neg_lo:[1,0,0] neg_hi:[1,0,0]
    v_pk_fma_f32 v[226:227], v[98:99], v[226:227], v[98:99] op_sel:[0,0,0] op_sel_hi:[1,1,1] neg_lo:[1,0,0] neg_hi:[1,0,0]
    v_pk_fma_f32 v[228:229], v[128:129], v[228:229], v[128:129] op_sel:[0,0,0] op_sel_hi:[1,1,1] neg_lo:[1,0,0] neg_hi:[1,0,0]
    v_pk_fma_f32 v[230:231], v[130:131], v[230:231], v[130:131] op_sel:[0,0,0] op_sel_hi:[1,1,1] neg_lo:[1,0,0] neg_hi:[1,0,0]
    v_cvt_pk_bf16_f32 v96, v224, v225
    v_cvt_pk_bf16_f32 v97, v226, v227
    v_cvt_pk_bf16_f32 v98, v228, v229
    v_cvt_pk_bf16_f32 v99, v230, v231
    buffer_store_dwordx4 v[96:99], v6, s[12:15], s40 offen sc1
    s_add_u32 s40, s40, 147456
    v_pk_fma_f32 v[224:225], v[48:49], v[14:15], v[52:53] op_sel:[0,0,0] op_sel_hi:[1,0,1] neg_lo:[0,1,0] neg_hi:[0,1,0]
    v_pk_fma_f32 v[226:227], v[50:51], v[14:15], v[54:55] op_sel:[0,0,0] op_sel_hi:[1,0,1] neg_lo:[0,1,0] neg_hi:[0,1,0]
    v_pk_fma_f32 v[228:229], v[56:57], v[14:15], v[60:61] op_sel:[0,0,0] op_sel_hi:[1,0,1] neg_lo:[0,1,0] neg_hi:[0,1,0]
    v_pk_fma_f32 v[230:231], v[58:59], v[14:15], v[62:63] op_sel:[0,0,0] op_sel_hi:[1,0,1] neg_lo:[0,1,0] neg_hi:[0,1,0]
    v_pk_fma_f32 v[100:101], v[100:101], v[14:15], v[224:225] op_sel:[0,1,0] op_sel_hi:[1,1,1]
    v_pk_fma_f32 v[102:103], v[102:103], v[14:15], v[226:227] op_sel:[0,1,0] op_sel_hi:[1,1,1]
    v_pk_fma_f32 v[132:133], v[132:133], v[14:15], v[228:229] op_sel:[0,1,0] op_sel_hi:[1,1,1]
    v_pk_fma_f32 v[134:135], v[134:135], v[14:15], v[230:231] op_sel:[0,1,0] op_sel_hi:[1,1,1]
    v_exp_f32 v224, v100
    v_exp_f32 v225, v101
    v_exp_f32 v226, v102
    v_exp_f32 v227, v103
    v_exp_f32 v228, v132
    v_exp_f32 v229, v133
    v_exp_f32 v230, v134
    v_exp_f32 v231, v135
    v_pk_fma_f32 v[232:233], v[224:225], 0.5, 1.0 op_sel:[0,0,0] op_sel_hi:[1,0,0]
    v_pk_fma_f32 v[234:235], v[226:227], 0.5, 1.0 op_sel:[0,0,0] op_sel_hi:[1,0,0]
    v_pk_fma_f32 v[236:237], v[228:229], 0.5, 1.0 op_sel:[0,0,0] op_sel_hi:[1,0,0]
    v_pk_fma_f32 v[238:239], v[230:231], 0.5, 1.0 op_sel:[0,0,0] op_sel_hi:[1,0,0]
    buffer_load_dwordx4 v5, s[8:11], s35 offen offset:1056 lds
    v_pk_fma_f32 v[224:225], v[224:225], v[232:233], 1.0 op_sel:[0,0,0] op_sel_hi:[1,1,0]
    v_pk_fma_f32 v[226:227], v[226:227], v[234:235], 1.0 op_sel:[0,0,0] op_sel_hi:[1,1,0]
    v_pk_fma_f32 v[228:229], v[228:229], v[236:237], 1.0 op_sel:[0,0,0] op_sel_hi:[1,1,0]
    v_pk_fma_f32 v[230:231], v[230:231], v[238:239], 1.0 op_sel:[0,0,0] op_sel_hi:[1,1,0]
    v_rcp_f32 v224, v224
    v_rcp_f32 v225, v225
    v_rcp_f32 v226, v226
    v_rcp_f32 v227, v227
    v_rcp_f32 v228, v228
    v_rcp_f32 v229, v229
    v_rcp_f32 v230, v230
    v_rcp_f32 v231, v231
    v_pk_fma_f32 v[224:225], v[100:101], v[224:225], v[100:101] op_sel:[0,0,0] op_sel_hi:[1,1,1] neg_lo:[1,0,0] neg_hi:[1,0,0]
    v_pk_fma_f32 v[226:227], v[102:103], v[226:227], v[102:103] op_sel:[0,0,0] op_sel_hi:[1,1,1] neg_lo:[1,0,0] neg_hi:[1,0,0]
    v_pk_fma_f32 v[228:229], v[132:133], v[228:229], v[132:133] op_sel:[0,0,0] op_sel_hi:[1,1,1] neg_lo:[1,0,0] neg_hi:[1,0,0]
    v_pk_fma_f32 v[230:231], v[134:135], v[230:231], v[134:135] op_sel:[0,0,0] op_sel_hi:[1,1,1] neg_lo:[1,0,0] neg_hi:[1,0,0]
    v_cvt_pk_bf16_f32 v100, v224, v225
    v_cvt_pk_bf16_f32 v101, v226, v227
    v_cvt_pk_bf16_f32 v102, v228, v229
    v_cvt_pk_bf16_f32 v103, v230, v231
    buffer_store_dwordx4 v[100:103], v6, s[12:15], s40 offen sc1
    s_add_u32 s40, s40, 147456
    v_pk_fma_f32 v[224:225], v[48:49], v[16:17], v[52:53] op_sel:[0,0,0] op_sel_hi:[1,0,1] neg_lo:[0,1,0] neg_hi:[0,1,0]
    v_pk_fma_f32 v[226:227], v[50:51], v[16:17], v[54:55] op_sel:[0,0,0] op_sel_hi:[1,0,1] neg_lo:[0,1,0] neg_hi:[0,1,0]
    v_pk_fma_f32 v[228:229], v[56:57], v[16:17], v[60:61] op_sel:[0,0,0] op_sel_hi:[1,0,1] neg_lo:[0,1,0] neg_hi:[0,1,0]
    v_pk_fma_f32 v[230:231], v[58:59], v[16:17], v[62:63] op_sel:[0,0,0] op_sel_hi:[1,0,1] neg_lo:[0,1,0] neg_hi:[0,1,0]
    v_pk_fma_f32 v[104:105], v[104:105], v[16:17], v[224:225] op_sel:[0,1,0] op_sel_hi:[1,1,1]
    v_pk_fma_f32 v[106:107], v[106:107], v[16:17], v[226:227] op_sel:[0,1,0] op_sel_hi:[1,1,1]
    v_pk_fma_f32 v[136:137], v[136:137], v[16:17], v[228:229] op_sel:[0,1,0] op_sel_hi:[1,1,1]
    v_pk_fma_f32 v[138:139], v[138:139], v[16:17], v[230:231] op_sel:[0,1,0] op_sel_hi:[1,1,1]
    v_exp_f32 v224, v104
    v_exp_f32 v225, v105
    v_exp_f32 v226, v106
    v_exp_f32 v227, v107
    v_exp_f32 v228, v136
    v_exp_f32 v229, v137
    v_exp_f32 v230, v138
    v_exp_f32 v231, v139
    v_pk_fma_f32 v[232:233], v[224:225], 0.5, 1.0 op_sel:[0,0,0] op_sel_hi:[1,0,0]
    v_pk_fma_f32 v[234:235], v[226:227], 0.5, 1.0 op_sel:[0,0,0] op_sel_hi:[1,0,0]
    v_pk_fma_f32 v[236:237], v[228:229], 0.5, 1.0 op_sel:[0,0,0] op_sel_hi:[1,0,0]
    v_pk_fma_f32 v[238:239], v[230:231], 0.5, 1.0 op_sel:[0,0,0] op_sel_hi:[1,0,0]
    s_add_u32 m0, m0, 8448
    s_add_u32 s35, s35, s31
    buffer_load_dwordx4 v4, s[8:11], s45 offen lds
    v_pk_fma_f32 v[224:225], v[224:225], v[232:233], 1.0 op_sel:[0,0,0] op_sel_hi:[1,1,0]
    v_pk_fma_f32 v[226:227], v[226:227], v[234:235], 1.0 op_sel:[0,0,0] op_sel_hi:[1,1,0]
    v_pk_fma_f32 v[228:229], v[228:229], v[236:237], 1.0 op_sel:[0,0,0] op_sel_hi:[1,1,0]
    v_pk_fma_f32 v[230:231], v[230:231], v[238:239], 1.0 op_sel:[0,0,0] op_sel_hi:[1,1,0]
    v_rcp_f32 v224, v224
    v_rcp_f32 v225, v225
    v_rcp_f32 v226, v226
    v_rcp_f32 v227, v227
    v_rcp_f32 v228, v228
    v_rcp_f32 v229, v229
    v_rcp_f32 v230, v230
    v_rcp_f32 v231, v231
    v_pk_fma_f32 v[224:225], v[104:105], v[224:225], v[104:105] op_sel:[0,0,0] op_sel_hi:[1,1,1] neg_lo:[1,0,0] neg_hi:[1,0,0]
    v_pk_fma_f32 v[226:227], v[106:107], v[226:227], v[106:107] op_sel:[0,0,0] op_sel_hi:[1,1,1] neg_lo:[1,0,0] neg_hi:[1,0,0]
    v_pk_fma_f32 v[228:229], v[136:137], v[228:229], v[136:137] op_sel:[0,0,0] op_sel_hi:[1,1,1] neg_lo:[1,0,0] neg_hi:[1,0,0]
    v_pk_fma_f32 v[230:231], v[138:139], v[230:231], v[138:139] op_sel:[0,0,0] op_sel_hi:[1,1,1] neg_lo:[1,0,0] neg_hi:[1,0,0]
    v_cvt_pk_bf16_f32 v104, v224, v225
    v_cvt_pk_bf16_f32 v105, v226, v227
    v_cvt_pk_bf16_f32 v106, v228, v229
    v_cvt_pk_bf16_f32 v107, v230, v231
    buffer_store_dwordx4 v[104:107], v6, s[12:15], s40 offen sc1
    s_add_u32 s40, s40, 147456
    v_pk_fma_f32 v[224:225], v[48:49], v[18:19], v[52:53] op_sel:[0,0,0] op_sel_hi:[1,0,1] neg_lo:[0,1,0] neg_hi:[0,1,0]
    v_pk_fma_f32 v[226:227], v[50:51], v[18:19], v[54:55] op_sel:[0,0,0] op_sel_hi:[1,0,1] neg_lo:[0,1,0] neg_hi:[0,1,0]
    v_pk_fma_f32 v[228:229], v[56:57], v[18:19], v[60:61] op_sel:[0,0,0] op_sel_hi:[1,0,1] neg_lo:[0,1,0] neg_hi:[0,1,0]
    v_pk_fma_f32 v[230:231], v[58:59], v[18:19], v[62:63] op_sel:[0,0,0] op_sel_hi:[1,0,1] neg_lo:[0,1,0] neg_hi:[0,1,0]
    v_pk_fma_f32 v[108:109], v[108:109], v[18:19], v[224:225] op_sel:[0,1,0] op_sel_hi:[1,1,1]
    v_pk_fma_f32 v[110:111], v[110:111], v[18:19], v[226:227] op_sel:[0,1,0] op_sel_hi:[1,1,1]
    v_pk_fma_f32 v[140:141], v[140:141], v[18:19], v[228:229] op_sel:[0,1,0] op_sel_hi:[1,1,1]
    v_pk_fma_f32 v[142:143], v[142:143], v[18:19], v[230:231] op_sel:[0,1,0] op_sel_hi:[1,1,1]
    v_exp_f32 v224, v108
    v_exp_f32 v225, v109
    v_exp_f32 v226, v110
    v_exp_f32 v227, v111
    v_exp_f32 v228, v140
    v_exp_f32 v229, v141
    v_exp_f32 v230, v142
    v_exp_f32 v231, v143
    v_pk_fma_f32 v[232:233], v[224:225], 0.5, 1.0 op_sel:[0,0,0] op_sel_hi:[1,0,0]
    v_pk_fma_f32 v[234:235], v[226:227], 0.5, 1.0 op_sel:[0,0,0] op_sel_hi:[1,0,0]
    v_pk_fma_f32 v[236:237], v[228:229], 0.5, 1.0 op_sel:[0,0,0] op_sel_hi:[1,0,0]
    v_pk_fma_f32 v[238:239], v[230:231], 0.5, 1.0 op_sel:[0,0,0] op_sel_hi:[1,0,0]
    buffer_load_dwordx4 v5, s[8:11], s45 offen offset:1056 lds
    v_pk_fma_f32 v[224:225], v[224:225], v[232:233], 1.0 op_sel:[0,0,0] op_sel_hi:[1,1,0]
    v_pk_fma_f32 v[226:227], v[226:227], v[234:235], 1.0 op_sel:[0,0,0] op_sel_hi:[1,1,0]
    v_pk_fma_f32 v[228:229], v[228:229], v[236:237], 1.0 op_sel:[0,0,0] op_sel_hi:[1,1,0]
    v_pk_fma_f32 v[230:231], v[230:231], v[238:239], 1.0 op_sel:[0,0,0] op_sel_hi:[1,1,0]
    v_rcp_f32 v224, v224
    v_rcp_f32 v225, v225
    v_rcp_f32 v226, v226
    v_rcp_f32 v227, v227
    v_rcp_f32 v228, v228
    v_rcp_f32 v229, v229
    v_rcp_f32 v230, v230
    v_rcp_f32 v231, v231
    v_pk_fma_f32 v[224:225], v[108:109], v[224:225], v[108:109] op_sel:[0,0,0] op_sel_hi:[1,1,1] neg_lo:[1,0,0] neg_hi:[1,0,0]
    v_pk_fma_f32 v[226:227], v[110:111], v[226:227], v[110:111] op_sel:[0,0,0] op_sel_hi:[1,1,1] neg_lo:[1,0,0] neg_hi:[1,0,0]
    v_pk_fma_f32 v[228:229], v[140:141], v[228:229], v[140:141] op_sel:[0,0,0] op_sel_hi:[1,1,1] neg_lo:[1,0,0] neg_hi:[1,0,0]
    v_pk_fma_f32 v[230:231], v[142:143], v[230:231], v[142:143] op_sel:[0,0,0] op_sel_hi:[1,1,1] neg_lo:[1,0,0] neg_hi:[1,0,0]
    v_cvt_pk_bf16_f32 v108, v224, v225
    v_cvt_pk_bf16_f32 v109, v226, v227
    v_cvt_pk_bf16_f32 v110, v228, v229
    v_cvt_pk_bf16_f32 v111, v230, v231
    buffer_store_dwordx4 v[108:111], v6, s[12:15], s40 offen sc1
    s_add_u32 s40, s40, 147456
    v_pk_fma_f32 v[224:225], v[48:49], v[20:21], v[52:53] op_sel:[0,0,0] op_sel_hi:[1,0,1] neg_lo:[0,1,0] neg_hi:[0,1,0]
    v_pk_fma_f32 v[226:227], v[50:51], v[20:21], v[54:55] op_sel:[0,0,0] op_sel_hi:[1,0,1] neg_lo:[0,1,0] neg_hi:[0,1,0]
    v_pk_fma_f32 v[228:229], v[56:57], v[20:21], v[60:61] op_sel:[0,0,0] op_sel_hi:[1,0,1] neg_lo:[0,1,0] neg_hi:[0,1,0]
    v_pk_fma_f32 v[230:231], v[58:59], v[20:21], v[62:63] op_sel:[0,0,0] op_sel_hi:[1,0,1] neg_lo:[0,1,0] neg_hi:[0,1,0]
    v_pk_fma_f32 v[112:113], v[112:113], v[20:21], v[224:225] op_sel:[0,1,0] op_sel_hi:[1,1,1]
    v_pk_fma_f32 v[114:115], v[114:115], v[20:21], v[226:227] op_sel:[0,1,0] op_sel_hi:[1,1,1]
    v_pk_fma_f32 v[144:145], v[144:145], v[20:21], v[228:229] op_sel:[0,1,0] op_sel_hi:[1,1,1]
    v_pk_fma_f32 v[146:147], v[146:147], v[20:21], v[230:231] op_sel:[0,1,0] op_sel_hi:[1,1,1]
    v_exp_f32 v224, v112
    v_exp_f32 v225, v113
    v_exp_f32 v226, v114
    v_exp_f32 v227, v115
    v_exp_f32 v228, v144
    v_exp_f32 v229, v145
    v_exp_f32 v230, v146
    v_exp_f32 v231, v147
    v_pk_fma_f32 v[232:233], v[224:225], 0.5, 1.0 op_sel:[0,0,0] op_sel_hi:[1,0,0]
    v_pk_fma_f32 v[234:235], v[226:227], 0.5, 1.0 op_sel:[0,0,0] op_sel_hi:[1,0,0]
    v_pk_fma_f32 v[236:237], v[228:229], 0.5, 1.0 op_sel:[0,0,0] op_sel_hi:[1,0,0]
    v_pk_fma_f32 v[238:239], v[230:231], 0.5, 1.0 op_sel:[0,0,0] op_sel_hi:[1,0,0]
    s_add_u32 m0, s39, 0
    s_add_u32 s45, s35, s30
    buffer_load_dwordx4 v4, s[8:11], s35 offen lds
    v_pk_fma_f32 v[224:225], v[224:225], v[232:233], 1.0 op_sel:[0,0,0] op_sel_hi:[1,1,0]
    v_pk_fma_f32 v[226:227], v[226:227], v[234:235], 1.0 op_sel:[0,0,0] op_sel_hi:[1,1,0]
    v_pk_fma_f32 v[228:229], v[228:229], v[236:237], 1.0 op_sel:[0,0,0] op_sel_hi:[1,1,0]
    v_pk_fma_f32 v[230:231], v[230:231], v[238:239], 1.0 op_sel:[0,0,0] op_sel_hi:[1,1,0]
    v_rcp_f32 v224, v224
    v_rcp_f32 v225, v225
    v_rcp_f32 v226, v226
    v_rcp_f32 v227, v227
    v_rcp_f32 v228, v228
    v_rcp_f32 v229, v229
    v_rcp_f32 v230, v230
    v_rcp_f32 v231, v231
    v_pk_fma_f32 v[224:225], v[112:113], v[224:225], v[112:113] op_sel:[0,0,0] op_sel_hi:[1,1,1] neg_lo:[1,0,0] neg_hi:[1,0,0]
    v_pk_fma_f32 v[226:227], v[114:115], v[226:227], v[114:115] op_sel:[0,0,0] op_sel_hi:[1,1,1] neg_lo:[1,0,0] neg_hi:[1,0,0]
    v_pk_fma_f32 v[228:229], v[144:145], v[228:229], v[144:145] op_sel:[0,0,0] op_sel_hi:[1,1,1] neg_lo:[1,0,0] neg_hi:[1,0,0]
    v_pk_fma_f32 v[230:231], v[146:147], v[230:231], v[146:147] op_sel:[0,0,0] op_sel_hi:[1,1,1] neg_lo:[1,0,0] neg_hi:[1,0,0]
    v_cvt_pk_bf16_f32 v112, v224, v225
    v_cvt_pk_bf16_f32 v113, v226, v227
    v_cvt_pk_bf16_f32 v114, v228, v229
    v_cvt_pk_bf16_f32 v115, v230, v231
    buffer_store_dwordx4 v[112:115], v6, s[12:15], s40 offen sc1
    s_add_u32 s40, s40, 147456
    ds_read_b128 v[32:35], v10 offset:256
    ds_read_b128 v[36:39], v10 offset:1280
    ds_read_b128 v[40:43], v10 offset:320
    ds_read_b128 v[44:47], v10 offset:1344
    v_accvgpr_read_b32 v64, a152
    v_accvgpr_read_b32 v65, a153
    v_accvgpr_read_b32 v66, a154
    v_accvgpr_read_b32 v67, a155
    v_accvgpr_read_b32 v68, a156
    v_accvgpr_read_b32 v69, a157
    v_accvgpr_read_b32 v70, a158
    v_accvgpr_read_b32 v71, a159
    v_pk_fma_f32 v[224:225], v[48:49], v[22:23], v[52:53] op_sel:[0,0,0] op_sel_hi:[1,0,1] neg_lo:[0,1,0] neg_hi:[0,1,0]
    v_pk_fma_f32 v[226:227], v[50:51], v[22:23], v[54:55] op_sel:[0,0,0] op_sel_hi:[1,0,1] neg_lo:[0,1,0] neg_hi:[0,1,0]
    v_pk_fma_f32 v[228:229], v[56:57], v[22:23], v[60:61] op_sel:[0,0,0] op_sel_hi:[1,0,1] neg_lo:[0,1,0] neg_hi:[0,1,0]
    v_pk_fma_f32 v[230:231], v[58:59], v[22:23], v[62:63] op_sel:[0,0,0] op_sel_hi:[1,0,1] neg_lo:[0,1,0] neg_hi:[0,1,0]
    v_pk_fma_f32 v[116:117], v[116:117], v[22:23], v[224:225] op_sel:[0,1,0] op_sel_hi:[1,1,1]
    v_pk_fma_f32 v[118:119], v[118:119], v[22:23], v[226:227] op_sel:[0,1,0] op_sel_hi:[1,1,1]
    v_pk_fma_f32 v[148:149], v[148:149], v[22:23], v[228:229] op_sel:[0,1,0] op_sel_hi:[1,1,1]
    v_pk_fma_f32 v[150:151], v[150:151], v[22:23], v[230:231] op_sel:[0,1,0] op_sel_hi:[1,1,1]
    v_exp_f32 v224, v116
    v_exp_f32 v225, v117
    v_exp_f32 v226, v118
    v_exp_f32 v227, v119
    v_exp_f32 v228, v148
    v_exp_f32 v229, v149
    v_exp_f32 v230, v150
    v_exp_f32 v231, v151
    v_pk_fma_f32 v[232:233], v[224:225], 0.5, 1.0 op_sel:[0,0,0] op_sel_hi:[1,0,0]
    v_pk_fma_f32 v[234:235], v[226:227], 0.5, 1.0 op_sel:[0,0,0] op_sel_hi:[1,0,0]
    v_pk_fma_f32 v[236:237], v[228:229], 0.5, 1.0 op_sel:[0,0,0] op_sel_hi:[1,0,0]
    v_pk_fma_f32 v[238:239], v[230:231], 0.5, 1.0 op_sel:[0,0,0] op_sel_hi:[1,0,0]
    buffer_load_dwordx4 v5, s[8:11], s35 offen offset:1056 lds
    v_pk_fma_f32 v[224:225], v[224:225], v[232:233], 1.0 op_sel:[0,0,0] op_sel_hi:[1,1,0]
    v_pk_fma_f32 v[226:227], v[226:227], v[234:235], 1.0 op_sel:[0,0,0] op_sel_hi:[1,1,0]
    v_pk_fma_f32 v[228:229], v[228:229], v[236:237], 1.0 op_sel:[0,0,0] op_sel_hi:[1,1,0]
    v_pk_fma_f32 v[230:231], v[230:231], v[238:239], 1.0 op_sel:[0,0,0] op_sel_hi:[1,1,0]
    v_rcp_f32 v224, v224
    v_rcp_f32 v225, v225
    v_rcp_f32 v226, v226
    v_rcp_f32 v227, v227
    v_rcp_f32 v228, v228
    v_rcp_f32 v229, v229
    v_rcp_f32 v230, v230
    v_rcp_f32 v231, v231
    v_pk_fma_f32 v[224:225], v[116:117], v[224:225], v[116:117] op_sel:[0,0,0] op_sel_hi:[1,1,1] neg_lo:[1,0,0] neg_hi:[1,0,0]
    v_pk_fma_f32 v[226:227], v[118:119], v[226:227], v[118:119] op_sel:[0,0,0] op_sel_hi:[1,1,1] neg_lo:[1,0,0] neg_hi:[1,0,0]
    v_pk_fma_f32 v[228:229], v[148:149], v[228:229], v[148:149] op_sel:[0,0,0] op_sel_hi:[1,1,1] neg_lo:[1,0,0] neg_hi:[1,0,0]
    v_pk_fma_f32 v[230:231], v[150:151], v[230:231], v[150:151] op_sel:[0,0,0] op_sel_hi:[1,1,1] neg_lo:[1,0,0] neg_hi:[1,0,0]
    v_cvt_pk_bf16_f32 v116, v224, v225
    v_cvt_pk_bf16_f32 v117, v226, v227
    v_cvt_pk_bf16_f32 v118, v228, v229
    v_cvt_pk_bf16_f32 v119, v230, v231
    buffer_store_dwordx4 v[116:119], v6, s[12:15], s40 offen sc1
    s_add_u32 s40, s40, 147456
    v_accvgpr_read_b32 v72, a160
    v_accvgpr_read_b32 v73, a161
    v_accvgpr_read_b32 v74, a162
    v_accvgpr_read_b32 v75, a163
    v_accvgpr_read_b32 v76, a164
    v_accvgpr_read_b32 v77, a165
    v_accvgpr_read_b32 v78, a166
    v_accvgpr_read_b32 v79, a167
    v_pk_fma_f32 v[224:225], v[48:49], v[24:25], v[52:53] op_sel:[0,0,0] op_sel_hi:[1,0,1] neg_lo:[0,1,0] neg_hi:[0,1,0]
    v_pk_fma_f32 v[226:227], v[50:51], v[24:25], v[54:55] op_sel:[0,0,0] op_sel_hi:[1,0,1] neg_lo:[0,1,0] neg_hi:[0,1,0]
    v_pk_fma_f32 v[228:229], v[56:57], v[24:25], v[60:61] op_sel:[0,0,0] op_sel_hi:[1,0,1] neg_lo:[0,1,0] neg_hi:[0,1,0]
    v_pk_fma_f32 v[230:231], v[58:59], v[24:25], v[62:63] op_sel:[0,0,0] op_sel_hi:[1,0,1] neg_lo:[0,1,0] neg_hi:[0,1,0]
    v_pk_fma_f32 v[120:121], v[120:121], v[24:25], v[224:225] op_sel:[0,1,0] op_sel_hi:[1,1,1]
    v_pk_fma_f32 v[122:123], v[122:123], v[24:25], v[226:227] op_sel:[0,1,0] op_sel_hi:[1,1,1]
    v_pk_fma_f32 v[152:153], v[152:153], v[24:25], v[228:229] op_sel:[0,1,0] op_sel_hi:[1,1,1]
    v_pk_fma_f32 v[154:155], v[154:155], v[24:25], v[230:231] op_sel:[0,1,0] op_sel_hi:[1,1,1]
    v_exp_f32 v224, v120
    v_exp_f32 v225, v121
    v_exp_f32 v226, v122
    v_exp_f32 v227, v123
    v_exp_f32 v228, v152
    v_exp_f32 v229, v153
    v_exp_f32 v230, v154
    v_exp_f32 v231, v155
    v_pk_fma_f32 v[232:233], v[224:225], 0.5, 1.0 op_sel:[0,0,0] op_sel_hi:[1,0,0]
    v_pk_fma_f32 v[234:235], v[226:227], 0.5, 1.0 op_sel:[0,0,0] op_sel_hi:[1,0,0]
    v_pk_fma_f32 v[236:237], v[228:229], 0.5, 1.0 op_sel:[0,0,0] op_sel_hi:[1,0,0]
    v_pk_fma_f32 v[238:239], v[230:231], 0.5, 1.0 op_sel:[0,0,0] op_sel_hi:[1,0,0]
    s_add_u32 m0, m0, 8448
    s_add_u32 s35, s35, s31
    buffer_load_dwordx4 v4, s[8:11], s45 offen lds
    v_pk_fma_f32 v[224:225], v[224:225], v[232:233], 1.0 op_sel:[0,0,0] op_sel_hi:[1,1,0]
    v_pk_fma_f32 v[226:227], v[226:227], v[234:235], 1.0 op_sel:[0,0,0] op_sel_hi:[1,1,0]
    v_pk_fma_f32 v[228:229], v[228:229], v[236:237], 1.0 op_sel:[0,0,0] op_sel_hi:[1,1,0]
    v_pk_fma_f32 v[230:231], v[230:231], v[238:239], 1.0 op_sel:[0,0,0] op_sel_hi:[1,1,0]
    v_rcp_f32 v224, v224
    v_rcp_f32 v225, v225
    v_rcp_f32 v226, v226
    v_rcp_f32 v227, v227
    v_rcp_f32 v228, v228
    v_rcp_f32 v229, v229
    v_rcp_f32 v230, v230
    v_rcp_f32 v231, v231
    v_pk_fma_f32 v[224:225], v[120:121], v[224:225], v[120:121] op_sel:[0,0,0] op_sel_hi:[1,1,1] neg_lo:[1,0,0] neg_hi:[1,0,0]
    v_pk_fma_f32 v[226:227], v[122:123], v[226:227], v[122:123] op_sel:[0,0,0] op_sel_hi:[1,1,1] neg_lo:[1,0,0] neg_hi:[1,0,0]
    v_pk_fma_f32 v[228:229], v[152:153], v[228:229], v[152:153] op_sel:[0,0,0] op_sel_hi:[1,1,1] neg_lo:[1,0,0] neg_hi:[1,0,0]
    v_pk_fma_f32 v[230:231], v[154:155], v[230:231], v[154:155] op_sel:[0,0,0] op_sel_hi:[1,1,1] neg_lo:[1,0,0] neg_hi:[1,0,0]
    v_cvt_pk_bf16_f32 v120, v224, v225
    v_cvt_pk_bf16_f32 v121, v226, v227
    v_cvt_pk_bf16_f32 v122, v228, v229
    v_cvt_pk_bf16_f32 v123, v230, v231
    buffer_store_dwordx4 v[120:123], v6, s[12:15], s40 offen sc1
    s_add_u32 s40, s40, 147456
    v_accvgpr_read_b32 v80, a168
    v_accvgpr_read_b32 v81, a169
    v_accvgpr_read_b32 v82, a170
    v_accvgpr_read_b32 v83, a171
    v_accvgpr_read_b32 v84, a172
    v_accvgpr_read_b32 v85, a173
    v_accvgpr_read_b32 v86, a174
    v_accvgpr_read_b32 v87, a175
    v_pk_fma_f32 v[224:225], v[48:49], v[26:27], v[52:53] op_sel:[0,0,0] op_sel_hi:[1,0,1] neg_lo:[0,1,0] neg_hi:[0,1,0]
    v_pk_fma_f32 v[226:227], v[50:51], v[26:27], v[54:55] op_sel:[0,0,0] op_sel_hi:[1,0,1] neg_lo:[0,1,0] neg_hi:[0,1,0]
    v_pk_fma_f32 v[228:229], v[56:57], v[26:27], v[60:61] op_sel:[0,0,0] op_sel_hi:[1,0,1] neg_lo:[0,1,0] neg_hi:[0,1,0]
    v_pk_fma_f32 v[230:231], v[58:59], v[26:27], v[62:63] op_sel:[0,0,0] op_sel_hi:[1,0,1] neg_lo:[0,1,0] neg_hi:[0,1,0]
    v_pk_fma_f32 v[124:125], v[124:125], v[26:27], v[224:225] op_sel:[0,1,0] op_sel_hi:[1,1,1]
    v_pk_fma_f32 v[126:127], v[126:127], v[26:27], v[226:227] op_sel:[0,1,0] op_sel_hi:[1,1,1]
    v_pk_fma_f32 v[156:157], v[156:157], v[26:27], v[228:229] op_sel:[0,1,0] op_sel_hi:[1,1,1]
    v_pk_fma_f32 v[158:159], v[158:159], v[26:27], v[230:231] op_sel:[0,1,0] op_sel_hi:[1,1,1]
    v_exp_f32 v224, v124
    v_exp_f32 v225, v125
    v_exp_f32 v226, v126
    v_exp_f32 v227, v127
    v_exp_f32 v228, v156
    v_exp_f32 v229, v157
    v_exp_f32 v230, v158
    v_exp_f32 v231, v159
    v_pk_fma_f32 v[232:233], v[224:225], 0.5, 1.0 op_sel:[0,0,0] op_sel_hi:[1,0,0]
    v_pk_fma_f32 v[234:235], v[226:227], 0.5, 1.0 op_sel:[0,0,0] op_sel_hi:[1,0,0]
    v_pk_fma_f32 v[236:237], v[228:229], 0.5, 1.0 op_sel:[0,0,0] op_sel_hi:[1,0,0]
    v_pk_fma_f32 v[238:239], v[230:231], 0.5, 1.0 op_sel:[0,0,0] op_sel_hi:[1,0,0]
    buffer_load_dwordx4 v5, s[8:11], s45 offen offset:1056 lds
    v_pk_fma_f32 v[224:225], v[224:225], v[232:233], 1.0 op_sel:[0,0,0] op_sel_hi:[1,1,0]
    v_pk_fma_f32 v[226:227], v[226:227], v[234:235], 1.0 op_sel:[0,0,0] op_sel_hi:[1,1,0]
    v_pk_fma_f32 v[228:229], v[228:229], v[236:237], 1.0 op_sel:[0,0,0] op_sel_hi:[1,1,0]
    v_pk_fma_f32 v[230:231], v[230:231], v[238:239], 1.0 op_sel:[0,0,0] op_sel_hi:[1,1,0]
    v_rcp_f32 v224, v224
    v_rcp_f32 v225, v225
    v_rcp_f32 v226, v226
    v_rcp_f32 v227, v227
    v_rcp_f32 v228, v228
    v_rcp_f32 v229, v229
    v_rcp_f32 v230, v230
    v_rcp_f32 v231, v231
    v_pk_fma_f32 v[224:225], v[124:125], v[224:225], v[124:125] op_sel:[0,0,0] op_sel_hi:[1,1,1] neg_lo:[1,0,0] neg_hi:[1,0,0]
    v_pk_fma_f32 v[226:227], v[126:127], v[226:227], v[126:127] op_sel:[0,0,0] op_sel_hi:[1,1,1] neg_lo:[1,0,0] neg_hi:[1,0,0]
    v_pk_fma_f32 v[228:229], v[156:157], v[228:229], v[156:157] op_sel:[0,0,0] op_sel_hi:[1,1,1] neg_lo:[1,0,0] neg_hi:[1,0,0]
    v_pk_fma_f32 v[230:231], v[158:159], v[230:231], v[158:159] op_sel:[0,0,0] op_sel_hi:[1,1,1] neg_lo:[1,0,0] neg_hi:[1,0,0]
    v_cvt_pk_bf16_f32 v124, v224, v225
    v_cvt_pk_bf16_f32 v125, v226, v227
    v_cvt_pk_bf16_f32 v126, v228, v229
    v_cvt_pk_bf16_f32 v127, v230, v231
    buffer_store_dwordx4 v[124:127], v6, s[12:15], s40 offen sc1
    v_accvgpr_read_b32 v88, a176
    v_accvgpr_read_b32 v89, a177
    v_accvgpr_read_b32 v90, a178
    v_accvgpr_read_b32 v91, a179
    v_accvgpr_read_b32 v92, a180
    v_accvgpr_read_b32 v93, a181
    v_accvgpr_read_b32 v94, a182
    v_accvgpr_read_b32 v95, a183
    s_waitcnt vmcnt(16)
    s_barrier
    s_add_u32 s41, s24, 4096
    s_cmp_lg_u32 s18, 0
    s_cbranch_scc1 P1_f1
    v_mov_b32 v28, s41
    v_mov_b32 v29, 1
    s_mov_b64 exec, 1
    global_atomic_add v28, v29, s[16:17] sc1
    s_mov_b64 exec, -1
P1_f1:
    s_waitcnt lgkmcnt(0)
    s_mov_b32 s40, s43
    v_pk_fma_f32 v[224:225], v[32:33], v[12:13], v[36:37] op_sel:[0,0,0] op_sel_hi:[1,0,1] neg_lo:[0,1,0] neg_hi:[0,1,0]
    v_pk_fma_f32 v[226:227], v[34:35], v[12:13], v[38:39] op_sel:[0,0,0] op_sel_hi:[1,0,1] neg_lo:[0,1,0] neg_hi:[0,1,0]
    v_pk_fma_f32 v[228:229], v[40:41], v[12:13], v[44:45] op_sel:[0,0,0] op_sel_hi:[1,0,1] neg_lo:[0,1,0] neg_hi:[0,1,0]
    v_pk_fma_f32 v[230:231], v[42:43], v[12:13], v[46:47] op_sel:[0,0,0] op_sel_hi:[1,0,1] neg_lo:[0,1,0] neg_hi:[0,1,0]
    v_pk_fma_f32 v[160:161], v[160:161], v[12:13], v[224:225] op_sel:[0,1,0] op_sel_hi:[1,1,1]
    v_pk_fma_f32 v[162:163], v[162:163], v[12:13], v[226:227] op_sel:[0,1,0] op_sel_hi:[1,1,1]
    v_pk_fma_f32 v[192:193], v[192:193], v[12:13], v[228:229] op_sel:[0,1,0] op_sel_hi:[1,1,1]
    v_pk_fma_f32 v[194:195], v[194:195], v[12:13], v[230:231] op_sel:[0,1,0] op_sel_hi:[1,1,1]
    v_exp_f32 v224, v160
    v_exp_f32 v225, v161
    v_exp_f32 v226, v162
    v_exp_f32 v227, v163
    v_exp_f32 v228, v192
    v_exp_f32 v229, v193
    v_exp_f32 v230, v194
    v_exp_f32 v231, v195
    v_pk_fma_f32 v[232:233], v[224:225], 0.5, 1.0 op_sel:[0,0,0] op_sel_hi:[1,0,0]
    v_pk_fma_f32 v[234:235], v[226:227], 0.5, 1.0 op_sel:[0,0,0] op_sel_hi:[1,0,0]
    v_pk_fma_f32 v[236:237], v[228:229], 0.5, 1.0 op_sel:[0,0,0] op_sel_hi:[1,0,0]
    v_pk_fma_f32 v[238:239], v[230:231], 0.5, 1.0 op_sel:[0,0,0] op_sel_hi:[1,0,0]
    v_pk_fma_f32 v[224:225], v[224:225], v[232:233], 1.0 op_sel:[0,0,0] op_sel_hi:[1,1,0]
    v_pk_fma_f32 v[226:227], v[226:227], v[234:235], 1.0 op_sel:[0,0,0] op_sel_hi:[1,1,0]
    v_pk_fma_f32 v[228:229], v[228:229], v[236:237], 1.0 op_sel:[0,0,0] op_sel_hi:[1,1,0]
    v_pk_fma_f32 v[230:231], v[230:231], v[238:239], 1.0 op_sel:[0,0,0] op_sel_hi:[1,1,0]
    v_rcp_f32 v224, v224
    v_rcp_f32 v225, v225
    v_rcp_f32 v226, v226
    v_rcp_f32 v227, v227
    v_rcp_f32 v228, v228
    v_rcp_f32 v229, v229
    v_rcp_f32 v230, v230
    v_rcp_f32 v231, v231
    v_pk_fma_f32 v[224:225], v[160:161], v[224:225], v[160:161] op_sel:[0,0,0] op_sel_hi:[1,1,1] neg_lo:[1,0,0] neg_hi:[1,0,0]
    v_pk_fma_f32 v[226:227], v[162:163], v[226:227], v[162:163] op_sel:[0,0,0] op_sel_hi:[1,1,1] neg_lo:[1,0,0] neg_hi:[1,0,0]
    v_pk_fma_f32 v[228:229], v[192:193], v[228:229], v[192:193] op_sel:[0,0,0] op_sel_hi:[1,1,1] neg_lo:[1,0,0] neg_hi:[1,0,0]
    v_pk_fma_f32 v[230:231], v[194:195], v[230:231], v[194:195] op_sel:[0,0,0] op_sel_hi:[1,1,1] neg_lo:[1,0,0] neg_hi:[1,0,0]
    v_cvt_pk_bf16_f32 v160, v224, v225
    v_cvt_pk_bf16_f32 v161, v226, v227
    v_cvt_pk_bf16_f32 v162, v228, v229
    v_cvt_pk_bf16_f32 v163, v230, v231
    buffer_store_dwordx4 v[160:163], v6, s[12:15], s40 offen sc1
    s_add_u32 s40, s40, 147456
    v_pk_fma_f32 v[224:225], v[32:33], v[14:15], v[36:37] op_sel:[0,0,0] op_sel_hi:[1,0,1] neg_lo:[0,1,0] neg_hi:[0,1,0]
    v_pk_fma_f32 v[226:227], v[34:35], v[14:15], v[38:39] op_sel:[0,0,0] op_sel_hi:[1,0,1] neg_lo:[0,1,0] neg_hi:[0,1,0]
    v_pk_fma_f32 v[228:229], v[40:41], v[14:15], v[44:45] op_sel:[0,0,0] op_sel_hi:[1,0,1] neg_lo:[0,1,0] neg_hi:[0,1,0]
    v_pk_fma_f32 v[230:231], v[42:43], v[14:15], v[46:47] op_sel:[0,0,0] op_sel_hi:[1,0,1] neg_lo:[0,1,0] neg_hi:[0,1,0]
    v_pk_fma_f32 v[164:165], v[164:165], v[14:15], v[224:225] op_sel:[0,1,0] op_sel_hi:[1,1,1]
    v_pk_fma_f32 v[166:167], v[166:167], v[14:15], v[226:227] op_sel:[0,1,0] op_sel_hi:[1,1,1]
    v_pk_fma_f32 v[196:197], v[196:197], v[14:15], v[228:229] op_sel:[0,1,0] op_sel_hi:[1,1,1]
    v_pk_fma_f32 v[198:199], v[198:199], v[14:15], v[230:231] op_sel:[0,1,0] op_sel_hi:[1,1,1]
    v_exp_f32 v224, v164
    v_exp_f32 v225, v165
    v_exp_f32 v226, v166
    v_exp_f32 v227, v167
    v_exp_f32 v228, v196
    v_exp_f32 v229, v197
    v_exp_f32 v230, v198
    v_exp_f32 v231, v199
    v_pk_fma_f32 v[232:233], v[224:225], 0.5, 1.0 op_sel:[0,0,0] op_sel_hi:[1,0,0]
    v_pk_fma_f32 v[234:235], v[226:227], 0.5, 1.0 op_sel:[0,0,0] op_sel_hi:[1,0,0]
    v_pk_fma_f32 v[236:237], v[228:229], 0.5, 1.0 op_sel:[0,0,0] op_sel_hi:[1,0,0]
    v_pk_fma_f32 v[238:239], v[230:231], 0.5, 1.0 op_sel:[0,0,0] op_sel_hi:[1,0,0]
    v_pk_fma_f32 v[224:225], v[224:225], v[232:233], 1.0 op_sel:[0,0,0] op_sel_hi:[1,1,0]
    v_pk_fma_f32 v[226:227], v[226:227], v[234:235], 1.0 op_sel:[0,0,0] op_sel_hi:[1,1,0]
    v_pk_fma_f32 v[228:229], v[228:229], v[236:237], 1.0 op_sel:[0,0,0] op_sel_hi:[1,1,0]
    v_pk_fma_f32 v[230:231], v[230:231], v[238:239], 1.0 op_sel:[0,0,0] op_sel_hi:[1,1,0]
    v_rcp_f32 v224, v224
    v_rcp_f32 v225, v225
    v_rcp_f32 v226, v226
    v_rcp_f32 v227, v227
    v_rcp_f32 v228, v228
    v_rcp_f32 v229, v229
    v_rcp_f32 v230, v230
    v_rcp_f32 v231, v231
    v_pk_fma_f32 v[224:225], v[164:165], v[224:225], v[164:165] op_sel:[0,0,0] op_sel_hi:[1,1,1] neg_lo:[1,0,0] neg_hi:[1,0,0]
    v_pk_fma_f32 v[226:227], v[166:167], v[226:227], v[166:167] op_sel:[0,0,0] op_sel_hi:[1,1,1] neg_lo:[1,0,0] neg_hi:[1,0,0]
    v_pk_fma_f32 v[228:229], v[196:197], v[228:229], v[196:197] op_sel:[0,0,0] op_sel_hi:[1,1,1] neg_lo:[1,0,0] neg_hi:[1,0,0]
    v_pk_fma_f32 v[230:231], v[198:199], v[230:231], v[198:199] op_sel:[0,0,0] op_sel_hi:[1,1,1] neg_lo:[1,0,0] neg_hi:[1,0,0]
    v_cvt_pk_bf16_f32 v164, v224, v225
    v_cvt_pk_bf16_f32 v165, v226, v227
    v_cvt_pk_bf16_f32 v166, v228, v229
    v_cvt_pk_bf16_f32 v167, v230, v231
    buffer_store_dwordx4 v[164:167], v6, s[12:15], s40 offen sc1
    s_add_u32 s40, s40, 147456
    v_pk_fma_f32 v[224:225], v[32:33], v[16:17], v[36:37] op_sel:[0,0,0] op_sel_hi:[1,0,1] neg_lo:[0,1,0] neg_hi:[0,1,0]
    v_pk_fma_f32 v[226:227], v[34:35], v[16:17], v[38:39] op_sel:[0,0,0] op_sel_hi:[1,0,1] neg_lo:[0,1,0] neg_hi:[0,1,0]
    v_pk_fma_f32 v[228:229], v[40:41], v[16:17], v[44:45] op_sel:[0,0,0] op_sel_hi:[1,0,1] neg_lo:[0,1,0] neg_hi:[0,1,0]
    v_pk_fma_f32 v[230:231], v[42:43], v[16:17], v[46:47] op_sel:[0,0,0] op_sel_hi:[1,0,1] neg_lo:[0,1,0] neg_hi:[0,1,0]
    v_pk_fma_f32 v[168:169], v[168:169], v[16:17], v[224:225] op_sel:[0,1,0] op_sel_hi:[1,1,1]
    v_pk_fma_f32 v[170:171], v[170:171], v[16:17], v[226:227] op_sel:[0,1,0] op_sel_hi:[1,1,1]
    v_pk_fma_f32 v[200:201], v[200:201], v[16:17], v[228:229] op_sel:[0,1,0] op_sel_hi:[1,1,1]
    v_pk_fma_f32 v[202:203], v[202:203], v[16:17], v[230:231] op_sel:[0,1,0] op_sel_hi:[1,1,1]
    v_exp_f32 v224, v168
    v_exp_f32 v225, v169
    v_exp_f32 v226, v170
    v_exp_f32 v227, v171
    v_exp_f32 v228, v200
    v_exp_f32 v229, v201
    v_exp_f32 v230, v202
    v_exp_f32 v231, v203
    v_pk_fma_f32 v[232:233], v[224:225], 0.5, 1.0 op_sel:[0,0,0] op_sel_hi:[1,0,0]
    v_pk_fma_f32 v[234:235], v[226:227], 0.5, 1.0 op_sel:[0,0,0] op_sel_hi:[1,0,0]
    v_pk_fma_f32 v[236:237], v[228:229], 0.5, 1.0 op_sel:[0,0,0] op_sel_hi:[1,0,0]
    v_pk_fma_f32 v[238:239], v[230:231], 0.5, 1.0 op_sel:[0,0,0] op_sel_hi:[1,0,0]
    v_pk_fma_f32 v[224:225], v[224:225], v[232:233], 1.0 op_sel:[0,0,0] op_sel_hi:[1,1,0]
    v_pk_fma_f32 v[226:227], v[226:227], v[234:235], 1.0 op_sel:[0,0,0] op_sel_hi:[1,1,0]
    v_pk_fma_f32 v[228:229], v[228:229], v[236:237], 1.0 op_sel:[0,0,0] op_sel_hi:[1,1,0]
    v_pk_fma_f32 v[230:231], v[230:231], v[238:239], 1.0 op_sel:[0,0,0] op_sel_hi:[1,1,0]
    v_rcp_f32 v224, v224
    v_rcp_f32 v225, v225
    v_rcp_f32 v226, v226
    v_rcp_f32 v227, v227
    v_rcp_f32 v228, v228
    v_rcp_f32 v229, v229
    v_rcp_f32 v230, v230
    v_rcp_f32 v231, v231
    v_pk_fma_f32 v[224:225], v[168:169], v[224:225], v[168:169] op_sel:[0,0,0] op_sel_hi:[1,1,1] neg_lo:[1,0,0] neg_hi:[1,0,0]
    v_pk_fma_f32 v[226:227], v[170:171], v[226:227], v[170:171] op_sel:[0,0,0] op_sel_hi:[1,1,1] neg_lo:[1,0,0] neg_hi:[1,0,0]
    v_pk_fma_f32 v[228:229], v[200:201], v[228:229], v[200:201] op_sel:[0,0,0] op_sel_hi:[1,1,1] neg_lo:[1,0,0] neg_hi:[1,0,0]
    v_pk_fma_f32 v[230:231], v[202:203], v[230:231], v[202:203] op_sel:[0,0,0] op_sel_hi:[1,1,1] neg_lo:[1,0,0] neg_hi:[1,0,0]
    v_cvt_pk_bf16_f32 v168, v224, v225
    v_cvt_pk_bf16_f32 v169, v226, v227
    v_cvt_pk_bf16_f32 v170, v228, v229
    v_cvt_pk_bf16_f32 v171, v230, v231
    buffer_store_dwordx4 v[168:171], v6, s[12:15], s40 offen sc1
    s_add_u32 s40, s40, 147456
    v_pk_fma_f32 v[224:225], v[32:33], v[18:19], v[36:37] op_sel:[0,0,0] op_sel_hi:[1,0,1] neg_lo:[0,1,0] neg_hi:[0,1,0]
    v_pk_fma_f32 v[226:227], v[34:35], v[18:19], v[38:39] op_sel:[0,0,0] op_sel_hi:[1,0,1] neg_lo:[0,1,0] neg_hi:[0,1,0]
    v_pk_fma_f32 v[228:229], v[40:41], v[18:19], v[44:45] op_sel:[0,0,0] op_sel_hi:[1,0,1] neg_lo:[0,1,0] neg_hi:[0,1,0]
    v_pk_fma_f32 v[230:231], v[42:43], v[18:19], v[46:47] op_sel:[0,0,0] op_sel_hi:[1,0,1] neg_lo:[0,1,0] neg_hi:[0,1,0]
    v_pk_fma_f32 v[172:173], v[172:173], v[18:19], v[224:225] op_sel:[0,1,0] op_sel_hi:[1,1,1]
    v_pk_fma_f32 v[174:175], v[174:175], v[18:19], v[226:227] op_sel:[0,1,0] op_sel_hi:[1,1,1]
    v_pk_fma_f32 v[204:205], v[204:205], v[18:19], v[228:229] op_sel:[0,1,0] op_sel_hi:[1,1,1]
    v_pk_fma_f32 v[206:207], v[206:207], v[18:19], v[230:231] op_sel:[0,1,0] op_sel_hi:[1,1,1]
    v_exp_f32 v224, v172
    v_exp_f32 v225, v173
    v_exp_f32 v226, v174
    v_exp_f32 v227, v175
    v_exp_f32 v228, v204
    v_exp_f32 v229, v205
    v_exp_f32 v230, v206
    v_exp_f32 v231, v207
    v_pk_fma_f32 v[232:233], v[224:225], 0.5, 1.0 op_sel:[0,0,0] op_sel_hi:[1,0,0]
    v_pk_fma_f32 v[234:235], v[226:227], 0.5, 1.0 op_sel:[0,0,0] op_sel_hi:[1,0,0]
    v_pk_fma_f32 v[236:237], v[228:229], 0.5, 1.0 op_sel:[0,0,0] op_sel_hi:[1,0,0]
    v_pk_fma_f32 v[238:239], v[230:231], 0.5, 1.0 op_sel:[0,0,0] op_sel_hi:[1,0,0]
    v_pk_fma_f32 v[224:225], v[224:225], v[232:233], 1.0 op_sel:[0,0,0] op_sel_hi:[1,1,0]
    v_pk_fma_f32 v[226:227], v[226:227], v[234:235], 1.0 op_sel:[0,0,0] op_sel_hi:[1,1,0]
    v_pk_fma_f32 v[228:229], v[228:229], v[236:237], 1.0 op_sel:[0,0,0] op_sel_hi:[1,1,0]
    v_pk_fma_f32 v[230:231], v[230:231], v[238:239], 1.0 op_sel:[0,0,0] op_sel_hi:[1,1,0]
    v_rcp_f32 v224, v224
    v_rcp_f32 v225, v225
    v_rcp_f32 v226, v226
    v_rcp_f32 v227, v227
    v_rcp_f32 v228, v228
    v_rcp_f32 v229, v229
    v_rcp_f32 v230, v230
    v_rcp_f32 v231, v231
    v_pk_fma_f32 v[224:225], v[172:173], v[224:225], v[172:173] op_sel:[0,0,0] op_sel_hi:[1,1,1] neg_lo:[1,0,0] neg_hi:[1,0,0]
    v_pk_fma_f32 v[226:227], v[174:175], v[226:227], v[174:175] op_sel:[0,0,0] op_sel_hi:[1,1,1] neg_lo:[1,0,0] neg_hi:[1,0,0]
    v_pk_fma_f32 v[228:229], v[204:205], v[228:229], v[204:205] op_sel:[0,0,0] op_sel_hi:[1,1,1] neg_lo:[1,0,0] neg_hi:[1,0,0]
    v_pk_fma_f32 v[230:231], v[206:207], v[230:231], v[206:207] op_sel:[0,0,0] op_sel_hi:[1,1,1] neg_lo:[1,0,0] neg_hi:[1,0,0]
    v_cvt_pk_bf16_f32 v172, v224, v225
    v_cvt_pk_bf16_f32 v173, v226, v227
    v_cvt_pk_bf16_f32 v174, v228, v229
    v_cvt_pk_bf16_f32 v175, v230, v231
    buffer_store_dwordx4 v[172:175], v6, s[12:15], s40 offen sc1
    s_add_u32 s40, s40, 147456
    v_pk_fma_f32 v[224:225], v[32:33], v[20:21], v[36:37] op_sel:[0,0,0] op_sel_hi:[1,0,1] neg_lo:[0,1,0] neg_hi:[0,1,0]
    v_pk_fma_f32 v[226:227], v[34:35], v[20:21], v[38:39] op_sel:[0,0,0] op_sel_hi:[1,0,1] neg_lo:[0,1,0] neg_hi:[0,1,0]
    v_pk_fma_f32 v[228:229], v[40:41], v[20:21], v[44:45] op_sel:[0,0,0] op_sel_hi:[1,0,1] neg_lo:[0,1,0] neg_hi:[0,1,0]
    v_pk_fma_f32 v[230:231], v[42:43], v[20:21], v[46:47] op_sel:[0,0,0] op_sel_hi:[1,0,1] neg_lo:[0,1,0] neg_hi:[0,1,0]
    v_pk_fma_f32 v[176:177], v[176:177], v[20:21], v[224:225] op_sel:[0,1,0] op_sel_hi:[1,1,1]
    v_pk_fma_f32 v[178:179], v[178:179], v[20:21], v[226:227] op_sel:[0,1,0] op_sel_hi:[1,1,1]
    v_pk_fma_f32 v[208:209], v[208:209], v[20:21], v[228:229] op_sel:[0,1,0] op_sel_hi:[1,1,1]
    v_pk_fma_f32 v[210:211], v[210:211], v[20:21], v[230:231] op_sel:[0,1,0] op_sel_hi:[1,1,1]
    v_exp_f32 v224, v176
    v_exp_f32 v225, v177
    v_exp_f32 v226, v178
    v_exp_f32 v227, v179
    v_exp_f32 v228, v208
    v_exp_f32 v229, v209
    v_exp_f32 v230, v210
    v_exp_f32 v231, v211
    v_pk_fma_f32 v[232:233], v[224:225], 0.5, 1.0 op_sel:[0,0,0] op_sel_hi:[1,0,0]
    v_pk_fma_f32 v[234:235], v[226:227], 0.5, 1.0 op_sel:[0,0,0] op_sel_hi:[1,0,0]
    v_pk_fma_f32 v[236:237], v[228:229], 0.5, 1.0 op_sel:[0,0,0] op_sel_hi:[1,0,0]
    v_pk_fma_f32 v[238:239], v[230:231], 0.5, 1.0 op_sel:[0,0,0] op_sel_hi:[1,0,0]
    v_pk_fma_f32 v[224:225], v[224:225], v[232:233], 1.0 op_sel:[0,0,0] op_sel_hi:[1,1,0]
    v_pk_fma_f32 v[226:227], v[226:227], v[234:235], 1.0 op_sel:[0,0,0] op_sel_hi:[1,1,0]
    v_pk_fma_f32 v[228:229], v[228:229], v[236:237], 1.0 op_sel:[0,0,0] op_sel_hi:[1,1,0]
    v_pk_fma_f32 v[230:231], v[230:231], v[238:239], 1.0 op_sel:[0,0,0] op_sel_hi:[1,1,0]
    v_rcp_f32 v224, v224
    v_rcp_f32 v225, v225
    v_rcp_f32 v226, v226
    v_rcp_f32 v227, v227
    v_rcp_f32 v228, v228
    v_rcp_f32 v229, v229
    v_rcp_f32 v230, v230
    v_rcp_f32 v231, v231
    v_pk_fma_f32 v[224:225], v[176:177], v[224:225], v[176:177] op_sel:[0,0,0] op_sel_hi:[1,1,1] neg_lo:[1,0,0] neg_hi:[1,0,0]
    v_pk_fma_f32 v[226:227], v[178:179], v[226:227], v[178:179] op_sel:[0,0,0] op_sel_hi:[1,1,1] neg_lo:[1,0,0] neg_hi:[1,0,0]
    v_pk_fma_f32 v[228:229], v[208:209], v[228:229], v[208:209] op_sel:[0,0,0] op_sel_hi:[1,1,1] neg_lo:[1,0,0] neg_hi:[1,0,0]
    v_pk_fma_f32 v[230:231], v[210:211], v[230:231], v[210:211] op_sel:[0,0,0] op_sel_hi:[1,1,1] neg_lo:[1,0,0] neg_hi:[1,0,0]
    v_cvt_pk_bf16_f32 v176, v224, v225
    v_cvt_pk_bf16_f32 v177, v226, v227
    v_cvt_pk_bf16_f32 v178, v228, v229
    v_cvt_pk_bf16_f32 v179, v230, v231
    buffer_store_dwordx4 v[176:179], v6, s[12:15], s40 offen sc1
    s_add_u32 s40, s40, 147456
    ds_read_b128 v[48:51], v10 offset:384
    ds_read_b128 v[52:55], v10 offset:1408
    v_pk_fma_f32 v[224:225], v[32:33], v[22:23], v[36:37] op_sel:[0,0,0] op_sel_hi:[1,0,1] neg_lo:[0,1,0] neg_hi:[0,1,0]
    v_pk_fma_f32 v[226:227], v[34:35], v[22:23], v[38:39] op_sel:[0,0,0] op_sel_hi:[1,0,1] neg_lo:[0,1,0] neg_hi:[0,1,0]
    v_pk_fma_f32 v[228:229], v[40:41], v[22:23], v[44:45] op_sel:[0,0,0] op_sel_hi:[1,0,1] neg_lo:[0,1,0] neg_hi:[0,1,0]
    v_pk_fma_f32 v[230:231], v[42:43], v[22:23], v[46:47] op_sel:[0,0,0] op_sel_hi:[1,0,1] neg_lo:[0,1,0] neg_hi:[0,1,0]
    v_pk_fma_f32 v[180:181], v[180:181], v[22:23], v[224:225] op_sel:[0,1,0] op_sel_hi:[1,1,1]
    v_pk_fma_f32 v[182:183], v[182:183], v[22:23], v[226:227] op_sel:[0,1,0] op_sel_hi:[1,1,1]
    v_pk_fma_f32 v[212:213], v[212:213], v[22:23], v[228:229] op_sel:[0,1,0] op_sel_hi:[1,1,1]
    v_pk_fma_f32 v[214:215], v[214:215], v[22:23], v[230:231] op_sel:[0,1,0] op_sel_hi:[1,1,1]
    v_exp_f32 v224, v180
    v_exp_f32 v225, v181
    v_exp_f32 v226, v182
    v_exp_f32 v227, v183
    v_exp_f32 v228, v212
    v_exp_f32 v229, v213
    v_exp_f32 v230, v214
    v_exp_f32 v231, v215
    v_pk_fma_f32 v[232:233], v[224:225], 0.5, 1.0 op_sel:[0,0,0] op_sel_hi:[1,0,0]
    v_pk_fma_f32 v[234:235], v[226:227], 0.5, 1.0 op_sel:[0,0,0] op_sel_hi:[1,0,0]
    v_pk_fma_f32 v[236:237], v[228:229], 0.5, 1.0 op_sel:[0,0,0] op_sel_hi:[1,0,0]
    v_pk_fma_f32 v[238:239], v[230:231], 0.5, 1.0 op_sel:[0,0,0] op_sel_hi:[1,0,0]
    v_pk_fma_f32 v[224:225], v[224:225], v[232:233], 1.0 op_sel:[0,0,0] op_sel_hi:[1,1,0]
    v_pk_fma_f32 v[226:227], v[226:227], v[234:235], 1.0 op_sel:[0,0,0] op_sel_hi:[1,1,0]
    v_pk_fma_f32 v[228:229], v[228:229], v[236:237], 1.0 op_sel:[0,0,0] op_sel_hi:[1,1,0]
    v_pk_fma_f32 v[230:231], v[230:231], v[238:239], 1.0 op_sel:[0,0,0] op_sel_hi:[1,1,0]
    v_rcp_f32 v224, v224
    v_rcp_f32 v225, v225
    v_rcp_f32 v226, v226
    v_rcp_f32 v227, v227
    v_rcp_f32 v228, v228
    v_rcp_f32 v229, v229
    v_rcp_f32 v230, v230
    v_rcp_f32 v231, v231
    v_pk_fma_f32 v[224:225], v[180:181], v[224:225], v[180:181] op_sel:[0,0,0] op_sel_hi:[1,1,1] neg_lo:[1,0,0] neg_hi:[1,0,0]
    v_pk_fma_f32 v[226:227], v[182:183], v[226:227], v[182:183] op_sel:[0,0,0] op_sel_hi:[1,1,1] neg_lo:[1,0,0] neg_hi:[1,0,0]
    v_pk_fma_f32 v[228:229], v[212:213], v[228:229], v[212:213] op_sel:[0,0,0] op_sel_hi:[1,1,1] neg_lo:[1,0,0] neg_hi:[1,0,0]
    v_pk_fma_f32 v[230:231], v[214:215], v[230:231], v[214:215] op_sel:[0,0,0] op_sel_hi:[1,1,1] neg_lo:[1,0,0] neg_hi:[1,0,0]
    v_cvt_pk_bf16_f32 v180, v224, v225
    v_cvt_pk_bf16_f32 v181, v226, v227
    v_cvt_pk_bf16_f32 v182, v228, v229
    v_cvt_pk_bf16_f32 v183, v230, v231
    buffer_store_dwordx4 v[180:183], v6, s[12:15], s40 offen sc1
    s_add_u32 s40, s40, 147456
    v_pk_fma_f32 v[224:225], v[32:33], v[24:25], v[36:37] op_sel:[0,0,0] op_sel_hi:[1,0,1] neg_lo:[0,1,0] neg_hi:[0,1,0]
    v_pk_fma_f32 v[226:227], v[34:35], v[24:25], v[38:39] op_sel:[0,0,0] op_sel_hi:[1,0,1] neg_lo:[0,1,0] neg_hi:[0,1,0]
    v_pk_fma_f32 v[228:229], v[40:41], v[24:25], v[44:45] op_sel:[0,0,0] op_sel_hi:[1,0,1] neg_lo:[0,1,0] neg_hi:[0,1,0]
    v_pk_fma_f32 v[230:231], v[42:43], v[24:25], v[46:47] op_sel:[0,0,0] op_sel_hi:[1,0,1] neg_lo:[0,1,0] neg_hi:[0,1,0]
    v_pk_fma_f32 v[184:185], v[184:185], v[24:25], v[224:225] op_sel:[0,1,0] op_sel_hi:[1,1,1]
    v_pk_fma_f32 v[186:187], v[186:187], v[24:25], v[226:227] op_sel:[0,1,0] op_sel_hi:[1,1,1]
    v_pk_fma_f32 v[216:217], v[216:217], v[24:25], v[228:229] op_sel:[0,1,0] op_sel_hi:[1,1,1]
    v_pk_fma_f32 v[218:219], v[218:219], v[24:25], v[230:231] op_sel:[0,1,0] op_sel_hi:[1,1,1]
    v_exp_f32 v224, v184
    v_exp_f32 v225, v185
    v_exp_f32 v226, v186
    v_exp_f32 v227, v187
    v_exp_f32 v228, v216
    v_exp_f32 v229, v217
    v_exp_f32 v230, v218
    v_exp_f32 v231, v219
    v_pk_fma_f32 v[232:233], v[224:225], 0.5, 1.0 op_sel:[0,0,0] op_sel_hi:[1,0,0]
    v_pk_fma_f32 v[234:235], v[226:227], 0.5, 1.0 op_sel:[0,0,0] op_sel_hi:[1,0,0]
    v_pk_fma_f32 v[236:237], v[228:229], 0.5, 1.0 op_sel:[0,0,0] op_sel_hi:[1,0,0]
    v_pk_fma_f32 v[238:239], v[230:231], 0.5, 1.0 op_sel:[0,0,0] op_sel_hi:[1,0,0]
    v_pk_fma_f32 v[224:225], v[224:225], v[232:233], 1.0 op_sel:[0,0,0] op_sel_hi:[1,1,0]
    v_pk_fma_f32 v[226:227], v[226:227], v[234:235], 1.0 op_sel:[0,0,0] op_sel_hi:[1,1,0]
    v_pk_fma_f32 v[228:229], v[228:229], v[236:237], 1.0 op_sel:[0,0,0] op_sel_hi:[1,1,0]
    v_pk_fma_f32 v[230:231], v[230:231], v[238:239], 1.0 op_sel:[0,0,0] op_sel_hi:[1,1,0]
    v_rcp_f32 v224, v224
    v_rcp_f32 v225, v225
    v_rcp_f32 v226, v226
    v_rcp_f32 v227, v227
    v_rcp_f32 v228, v228
    v_rcp_f32 v229, v229
    v_rcp_f32 v230, v230
    v_rcp_f32 v231, v231
    v_pk_fma_f32 v[224:225], v[184:185], v[224:225], v[184:185] op_sel:[0,0,0] op_sel_hi:[1,1,1] neg_lo:[1,0,0] neg_hi:[1,0,0]
    v_pk_fma_f32 v[226:227], v[186:187], v[226:227], v[186:187] op_sel:[0,0,0] op_sel_hi:[1,1,1] neg_lo:[1,0,0] neg_hi:[1,0,0]
    v_pk_fma_f32 v[228:229], v[216:217], v[228:229], v[216:217] op_sel:[0,0,0] op_sel_hi:[1,1,1] neg_lo:[1,0,0] neg_hi:[1,0,0]
    v_pk_fma_f32 v[230:231], v[218:219], v[230:231], v[218:219] op_sel:[0,0,0] op_sel_hi:[1,1,1] neg_lo:[1,0,0] neg_hi:[1,0,0]
    v_cvt_pk_bf16_f32 v184, v224, v225
    v_cvt_pk_bf16_f32 v185, v226, v227
    v_cvt_pk_bf16_f32 v186, v228, v229
    v_cvt_pk_bf16_f32 v187, v230, v231
    buffer_store_dwordx4 v[184:187], v6, s[12:15], s40 offen sc1
    s_add_u32 s40, s40, 147456
    s_waitcnt vmcnt(7) lgkmcnt(0)
    s_barrier
    s_add_u32 s41, s24, 6144
    s_cmp_lg_u32 s18, 0
    s_cbranch_scc1 P1_f2
    v_mov_b32 v28, s41
    v_mov_b32 v29, 1
    s_mov_b64 exec, 1
    global_atomic_add v28, v29, s[16:17] sc1
    s_mov_b64 exec, -1
P1_f2:
    s_add_u32 s41, s25, 4096
    v_mov_b32 v11, s41
    global_load_dword v30, v11, s[16:17] sc1
    v_pk_fma_f32 v[224:225], v[32:33], v[26:27], v[36:37] op_sel:[0,0,0] op_sel_hi:[1,0,1] neg_lo:[0,1,0] neg_hi:[0,1,0]
    v_pk_fma_f32 v[226:227], v[34:35], v[26:27], v[38:39] op_sel:[0,0,0] op_sel_hi:[1,0,1] neg_lo:[0,1,0] neg_hi:[0,1,0]
    v_pk_fma_f32 v[228:229], v[40:41], v[26:27], v[44:45] op_sel:[0,0,0] op_sel_hi:[1,0,1] neg_lo:[0,1,0] neg_hi:[0,1,0]
    v_pk_fma_f32 v[230:231], v[42:43], v[26:27], v[46:47] op_sel:[0,0,0] op_sel_hi:[1,0,1] neg_lo:[0,1,0] neg_hi:[0,1,0]
    v_pk_fma_f32 v[188:189], v[188:189], v[26:27], v[224:225] op_sel:[0,1,0] op_sel_hi:[1,1,1]
    v_pk_fma_f32 v[190:191], v[190:191], v[26:27], v[226:227] op_sel:[0,1,0] op_sel_hi:[1,1,1]
    v_pk_fma_f32 v[220:221], v[220:221], v[26:27], v[228:229] op_sel:[0,1,0] op_sel_hi:[1,1,1]
    v_pk_fma_f32 v[222:223], v[222:223], v[26:27], v[230:231] op_sel:[0,1,0] op_sel_hi:[1,1,1]
    v_exp_f32 v224, v188
    v_exp_f32 v225, v189
    v_exp_f32 v226, v190
    v_exp_f32 v227, v191
    v_exp_f32 v228, v220
    v_exp_f32 v229, v221
    v_exp_f32 v230, v222
    v_exp_f32 v231, v223
    v_pk_fma_f32 v[232:233], v[224:225], 0.5, 1.0 op_sel:[0,0,0] op_sel_hi:[1,0,0]
    v_pk_fma_f32 v[234:235], v[226:227], 0.5, 1.0 op_sel:[0,0,0] op_sel_hi:[1,0,0]
    v_pk_fma_f32 v[236:237], v[228:229], 0.5, 1.0 op_sel:[0,0,0] op_sel_hi:[1,0,0]
    v_pk_fma_f32 v[238:239], v[230:231], 0.5, 1.0 op_sel:[0,0,0] op_sel_hi:[1,0,0]
    v_pk_fma_f32 v[224:225], v[224:225], v[232:233], 1.0 op_sel:[0,0,0] op_sel_hi:[1,1,0]
    v_pk_fma_f32 v[226:227], v[226:227], v[234:235], 1.0 op_sel:[0,0,0] op_sel_hi:[1,1,0]
    v_pk_fma_f32 v[228:229], v[228:229], v[236:237], 1.0 op_sel:[0,0,0] op_sel_hi:[1,1,0]
    v_pk_fma_f32 v[230:231], v[230:231], v[238:239], 1.0 op_sel:[0,0,0] op_sel_hi:[1,1,0]
    v_rcp_f32 v224, v224
    v_rcp_f32 v225, v225
    v_rcp_f32 v226, v226
    v_rcp_f32 v227, v227
    v_rcp_f32 v228, v228
    v_rcp_f32 v229, v229
    v_rcp_f32 v230, v230
    v_rcp_f32 v231, v231
    v_pk_fma_f32 v[224:225], v[188:189], v[224:225], v[188:189] op_sel:[0,0,0] op_sel_hi:[1,1,1] neg_lo:[1,0,0] neg_hi:[1,0,0]
    v_pk_fma_f32 v[226:227], v[190:191], v[226:227], v[190:191] op_sel:[0,0,0] op_sel_hi:[1,1,1] neg_lo:[1,0,0] neg_hi:[1,0,0]
    v_pk_fma_f32 v[228:229], v[220:221], v[228:229], v[220:221] op_sel:[0,0,0] op_sel_hi:[1,1,1] neg_lo:[1,0,0] neg_hi:[1,0,0]
    v_pk_fma_f32 v[230:231], v[222:223], v[230:231], v[222:223] op_sel:[0,0,0] op_sel_hi:[1,1,1] neg_lo:[1,0,0] neg_hi:[1,0,0]
    v_cvt_pk_bf16_f32 v188, v224, v225
    v_cvt_pk_bf16_f32 v189, v226, v227
    v_cvt_pk_bf16_f32 v190, v228, v229
    v_cvt_pk_bf16_f32 v191, v230, v231
    buffer_store_dwordx4 v[188:191], v6, s[12:15], s40 offen sc1
    s_waitcnt lgkmcnt(0)
    s_nop 0
    v_pk_fma_f32 v[224:225], v[48:49], v[12:13], v[52:53] op_sel:[0,0,0] op_sel_hi:[1,0,1] neg_lo:[0,1,0] neg_hi:[0,1,0]
    v_pk_fma_f32 v[226:227], v[50:51], v[12:13], v[54:55] op_sel:[0,0,0] op_sel_hi:[1,0,1] neg_lo:[0,1,0] neg_hi:[0,1,0]
    v_pk_fma_f32 v[64:65], v[64:65], v[12:13], v[224:225] op_sel:[0,1,0] op_sel_hi:[1,1,1]
    v_pk_fma_f32 v[66:67], v[66:67], v[12:13], v[226:227] op_sel:[0,1,0] op_sel_hi:[1,1,1]
    v_exp_f32 v224, v64
    v_exp_f32 v225, v65
    v_exp_f32 v226, v66
    v_exp_f32 v227, v67
    v_pk_fma_f32 v[232:233], v[224:225], 0.5, 1.0 op_sel:[0,0,0] op_sel_hi:[1,0,0]
    v_pk_fma_f32 v[234:235], v[226:227], 0.5, 1.0 op_sel:[0,0,0] op_sel_hi:[1,0,0]
    s_add_u32 m0, s37, 0
    v_lshrrev_b32 v9, 3, v1
    v_and_b32 v8, 7, v1
    v_xor_b32 v8, v8, v9
    v_lshlrev_b32 v8, 4, v8
    v_lshl_add_u32 v8, v9, 11, v8
    buffer_load_dwordx4 v8, s[92:95], s38 offen lds
    s_add_u32 s38, s38, 16384
    v_pk_fma_f32 v[224:225], v[224:225], v[232:233], 1.0 op_sel:[0,0,0] op_sel_hi:[1,1,0]
    v_pk_fma_f32 v[226:227], v[226:227], v[234:235], 1.0 op_sel:[0,0,0] op_sel_hi:[1,1,0]
    v_rcp_f32 v224, v224
    v_rcp_f32 v225, v225
    v_rcp_f32 v226, v226
    v_rcp_f32 v227, v227
    v_pk_fma_f32 v[224:225], v[64:65], v[224:225], v[64:65] op_sel:[0,0,0] op_sel_hi:[1,1,1] neg_lo:[1,0,0] neg_hi:[1,0,0]
    v_pk_fma_f32 v[226:227], v[66:67], v[226:227], v[66:67] op_sel:[0,0,0] op_sel_hi:[1,1,1] neg_lo:[1,0,0] neg_hi:[1,0,0]
    v_cvt_pk_bf16_f32 v64, v224, v225
    v_cvt_pk_bf16_f32 v65, v226, v227
    v_pk_fma_f32 v[224:225], v[48:49], v[14:15], v[52:53] op_sel:[0,0,0] op_sel_hi:[1,0,1] neg_lo:[0,1,0] neg_hi:[0,1,0]
    v_pk_fma_f32 v[226:227], v[50:51], v[14:15], v[54:55] op_sel:[0,0,0] op_sel_hi:[1,0,1] neg_lo:[0,1,0] neg_hi:[0,1,0]
    v_pk_fma_f32 v[68:69], v[68:69], v[14:15], v[224:225] op_sel:[0,1,0] op_sel_hi:[1,1,1]
    v_pk_fma_f32 v[70:71], v[70:71], v[14:15], v[226:227] op_sel:[0,1,0] op_sel_hi:[1,1,1]
    v_exp_f32 v224, v68
    v_exp_f32 v225, v69
    v_exp_f32 v226, v70
    v_exp_f32 v227, v71
    v_pk_fma_f32 v[232:233], v[224:225], 0.5, 1.0 op_sel:[0,0,0] op_sel_hi:[1,0,0]
    v_pk_fma_f32 v[234:235], v[226:227], 0.5, 1.0 op_sel:[0,0,0] op_sel_hi:[1,0,0]
    v_pk_fma_f32 v[224:225], v[224:225], v[232:233], 1.0 op_sel:[0,0,0] op_sel_hi:[1,1,0]
    v_pk_fma_f32 v[226:227], v[226:227], v[234:235], 1.0 op_sel:[0,0,0] op_sel_hi:[1,1,0]
    v_rcp_f32 v224, v224
    v_rcp_f32 v225, v225
    v_rcp_f32 v226, v226
    v_rcp_f32 v227, v227
    v_pk_fma_f32 v[224:225], v[68:69], v[224:225], v[68:69] op_sel:[0,0,0] op_sel_hi:[1,1,1] neg_lo:[1,0,0] neg_hi:[1,0,0]
    v_pk_fma_f32 v[226:227], v[70:71], v[226:227], v[70:71] op_sel:[0,0,0] op_sel_hi:[1,1,1] neg_lo:[1,0,0] neg_hi:[1,0,0]
    v_cvt_pk_bf16_f32 v68, v224, v225
    v_cvt_pk_bf16_f32 v69, v226, v227
    v_pk_fma_f32 v[224:225], v[48:49], v[16:17], v[52:53] op_sel:[0,0,0] op_sel_hi:[1,0,1] neg_lo:[0,1,0] neg_hi:[0,1,0]
    v_pk_fma_f32 v[226:227], v[50:51], v[16:17], v[54:55] op_sel:[0,0,0] op_sel_hi:[1,0,1] neg_lo:[0,1,0] neg_hi:[0,1,0]
    v_pk_fma_f32 v[72:73], v[72:73], v[16:17], v[224:225] op_sel:[0,1,0] op_sel_hi:[1,1,1]
    v_pk_fma_f32 v[74:75], v[74:75], v[16:17], v[226:227] op_sel:[0,1,0] op_sel_hi:[1,1,1]
    v_exp_f32 v224, v72
    v_exp_f32 v225, v73
    v_exp_f32 v226, v74
    v_exp_f32 v227, v75
    v_pk_fma_f32 v[232:233], v[224:225], 0.5, 1.0 op_sel:[0,0,0] op_sel_hi:[1,0,0]
    v_pk_fma_f32 v[234:235], v[226:227], 0.5, 1.0 op_sel:[0,0,0] op_sel_hi:[1,0,0]
    s_add_u32 m0, s37, 1024
    s_nop 0
    buffer_load_dwordx4 v8, s[92:95], s38 offen lds
    s_add_u32 s38, s38, 16384
    v_pk_fma_f32 v[224:225], v[224:225], v[232:233], 1.0 op_sel:[0,0,0] op_sel_hi:[1,1,0]
    v_pk_fma_f32 v[226:227], v[226:227], v[234:235], 1.0 op_sel:[0,0,0] op_sel_hi:[1,1,0]
    v_rcp_f32 v224, v224
    v_rcp_f32 v225, v225
    v_rcp_f32 v226, v226
    v_rcp_f32 v227, v227
    v_pk_fma_f32 v[224:225], v[72:73], v[224:225], v[72:73] op_sel:[0,0,0] op_sel_hi:[1,1,1] neg_lo:[1,0,0] neg_hi:[1,0,0]
    v_pk_fma_f32 v[226:227], v[74:75], v[226:227], v[74:75] op_sel:[0,0,0] op_sel_hi:[1,1,1] neg_lo:[1,0,0] neg_hi:[1,0,0]
    v_cvt_pk_bf16_f32 v72, v224, v225
    v_cvt_pk_bf16_f32 v73, v226, v227
    v_pk_fma_f32 v[224:225], v[48:49], v[18:19], v[52:53] op_sel:[0,0,0] op_sel_hi:[1,0,1] neg_lo:[0,1,0] neg_hi:[0,1,0]
    v_pk_fma_f32 v[226:227], v[50:51], v[18:19], v[54:55] op_sel:[0,0,0] op_sel_hi:[1,0,1] neg_lo:[0,1,0] neg_hi:[0,1,0]
    v_pk_fma_f32 v[76:77], v[76:77], v[18:19], v[224:225] op_sel:[0,1,0] op_sel_hi:[1,1,1]
    v_pk_fma_f32 v[78:79], v[78:79], v[18:19], v[226:227] op_sel:[0,1,0] op_sel_hi:[1,1,1]
    v_exp_f32 v224, v76
    v_exp_f32 v225, v77
    v_exp_f32 v226, v78
    v_exp_f32 v227, v79
    v_pk_fma_f32 v[232:233], v[224:225], 0.5, 1.0 op_sel:[0,0,0] op_sel_hi:[1,0,0]
    v_pk_fma_f32 v[234:235], v[226:227], 0.5, 1.0 op_sel:[0,0,0] op_sel_hi:[1,0,0]
    v_pk_fma_f32 v[224:225], v[224:225], v[232:233], 1.0 op_sel:[0,0,0] op_sel_hi:[1,1,0]
    v_pk_fma_f32 v[226:227], v[226:227], v[234:235], 1.0 op_sel:[0,0,0] op_sel_hi:[1,1,0]
    v_rcp_f32 v224, v224
    v_rcp_f32 v225, v225
    v_rcp_f32 v226, v226
    v_rcp_f32 v227, v227
    v_pk_fma_f32 v[224:225], v[76:77], v[224:225], v[76:77] op_sel:[0,0,0] op_sel_hi:[1,1,1] neg_lo:[1,0,0] neg_hi:[1,0,0]
    v_pk_fma_f32 v[226:227], v[78:79], v[226:227], v[78:79] op_sel:[0,0,0] op_sel_hi:[1,1,1] neg_lo:[1,0,0] neg_hi:[1,0,0]
    v_cvt_pk_bf16_f32 v76, v224, v225
    v_cvt_pk_bf16_f32 v77, v226, v227
    v_pk_fma_f32 v[224:225], v[48:49], v[20:21], v[52:53] op_sel:[0,0,0] op_sel_hi:[1,0,1] neg_lo:[0,1,0] neg_hi:[0,1,0]
    v_pk_fma_f32 v[226:227], v[50:51], v[20:21], v[54:55] op_sel:[0,0,0] op_sel_hi:[1,0,1] neg_lo:[0,1,0] neg_hi:[0,1,0]
    v_pk_fma_f32 v[80:81], v[80:81], v[20:21], v[224:225] op_sel:[0,1,0] op_sel_hi:[1,1,1]
    v_pk_fma_f32 v[82:83], v[82:83], v[20:21], v[226:227] op_sel:[0,1,0] op_sel_hi:[1,1,1]
    v_exp_f32 v224, v80
    v_exp_f32 v225, v81
    v_exp_f32 v226, v82
    v_exp_f32 v227, v83
    v_pk_fma_f32 v[232:233], v[224:225], 0.5, 1.0 op_sel:[0,0,0] op_sel_hi:[1,0,0]
    v_pk_fma_f32 v[234:235], v[226:227], 0.5, 1.0 op_sel:[0,0,0] op_sel_hi:[1,0,0]
    s_add_u32 m0, s37, 2048
    s_nop 0
    buffer_load_dwordx4 v8, s[92:95], s38 offen lds
    s_add_u32 s38, s38, 16384
    v_pk_fma_f32 v[224:225], v[224:225], v[232:233], 1.0 op_sel:[0,0,0] op_sel_hi:[1,1,0]
    v_pk_fma_f32 v[226:227], v[226:227], v[234:235], 1.0 op_sel:[0,0,0] op_sel_hi:[1,1,0]
    v_rcp_f32 v224, v224
    v_rcp_f32 v225, v225
    v_rcp_f32 v226, v226
    v_rcp_f32 v227, v227
    v_pk_fma_f32 v[224:225], v[80:81], v[224:225], v[80:81] op_sel:[0,0,0] op_sel_hi:[1,1,1] neg_lo:[1,0,0] neg_hi:[1,0,0]
    v_pk_fma_f32 v[226:227], v[82:83], v[226:227], v[82:83] op_sel:[0,0,0] op_sel_hi:[1,1,1] neg_lo:[1,0,0] neg_hi:[1,0,0]
    v_cvt_pk_bf16_f32 v80, v224, v225
    v_cvt_pk_bf16_f32 v81, v226, v227
    v_pk_fma_f32 v[224:225], v[48:49], v[22:23], v[52:53] op_sel:[0,0,0] op_sel_hi:[1,0,1] neg_lo:[0,1,0] neg_hi:[0,1,0]
    v_pk_fma_f32 v[226:227], v[50:51], v[22:23], v[54:55] op_sel:[0,0,0] op_sel_hi:[1,0,1] neg_lo:[0,1,0] neg_hi:[0,1,0]
    v_pk_fma_f32 v[84:85], v[84:85], v[22:23], v[224:225] op_sel:[0,1,0] op_sel_hi:[1,1,1]
    v_pk_fma_f32 v[86:87], v[86:87], v[22:23], v[226:227] op_sel:[0,1,0] op_sel_hi:[1,1,1]
    v_exp_f32 v224, v84
    v_exp_f32 v225, v85
    v_exp_f32 v226, v86
    v_exp_f32 v227, v87
    v_pk_fma_f32 v[232:233], v[224:225], 0.5, 1.0 op_sel:[0,0,0] op_sel_hi:[1,0,0]
    v_pk_fma_f32 v[234:235], v[226:227], 0.5, 1.0 op_sel:[0,0,0] op_sel_hi:[1,0,0]
    v_pk_fma_f32 v[224:225], v[224:225], v[232:233], 1.0 op_sel:[0,0,0] op_sel_hi:[1,1,0]
    v_pk_fma_f32 v[226:227], v[226:227], v[234:235], 1.0 op_sel:[0,0,0] op_sel_hi:[1,1,0]
    v_rcp_f32 v224, v224
    v_rcp_f32 v225, v225
    v_rcp_f32 v226, v226
    v_rcp_f32 v227, v227
    v_pk_fma_f32 v[224:225], v[84:85], v[224:225], v[84:85] op_sel:[0,0,0] op_sel_hi:[1,1,1] neg_lo:[1,0,0] neg_hi:[1,0,0]
    v_pk_fma_f32 v[226:227], v[86:87], v[226:227], v[86:87] op_sel:[0,0,0] op_sel_hi:[1,1,1] neg_lo:[1,0,0] neg_hi:[1,0,0]
    v_cvt_pk_bf16_f32 v84, v224, v225
    v_cvt_pk_bf16_f32 v85, v226, v227
    v_pk_fma_f32 v[224:225], v[48:49], v[24:25], v[52:53] op_sel:[0,0,0] op_sel_hi:[1,0,1] neg_lo:[0,1,0] neg_hi:[0,1,0]
    v_pk_fma_f32 v[226:227], v[50:51], v[24:25], v[54:55] op_sel:[0,0,0] op_sel_hi:[1,0,1] neg_lo:[0,1,0] neg_hi:[0,1,0]
    v_pk_fma_f32 v[88:89], v[88:89], v[24:25], v[224:225] op_sel:[0,1,0] op_sel_hi:[1,1,1]
    v_pk_fma_f32 v[90:91], v[90:91], v[24:25], v[226:227] op_sel:[0,1,0] op_sel_hi:[1,1,1]
    v_exp_f32 v224, v88
    v_exp_f32 v225, v89
    v_exp_f32 v226, v90
    v_exp_f32 v227, v91
    v_pk_fma_f32 v[232:233], v[224:225], 0.5, 1.0 op_sel:[0,0,0] op_sel_hi:[1,0,0]
    v_pk_fma_f32 v[234:235], v[226:227], 0.5, 1.0 op_sel:[0,0,0] op_sel_hi:[1,0,0]
    s_add_u32 m0, s37, 3072
    s_nop 0
    buffer_load_dwordx4 v8, s[92:95], s38 offen lds
    s_add_u32 s38, s38, 16384
    v_pk_fma_f32 v[224:225], v[224:225], v[232:233], 1.0 op_sel:[0,0,0] op_sel_hi:[1,1,0]
    v_pk_fma_f32 v[226:227], v[226:227], v[234:235], 1.0 op_sel:[0,0,0] op_sel_hi:[1,1,0]
    v_rcp_f32 v224, v224
    v_rcp_f32 v225, v225
    v_rcp_f32 v226, v226
    v_rcp_f32 v227, v227
    v_pk_fma_f32 v[224:225], v[88:89], v[224:225], v[88:89] op_sel:[0,0,0] op_sel_hi:[1,1,1] neg_lo:[1,0,0] neg_hi:[1,0,0]
    v_pk_fma_f32 v[226:227], v[90:91], v[226:227], v[90:91] op_sel:[0,0,0] op_sel_hi:[1,1,1] neg_lo:[1,0,0] neg_hi:[1,0,0]
    v_cvt_pk_bf16_f32 v88, v224, v225
    v_cvt_pk_bf16_f32 v89, v226, v227
    v_pk_fma_f32 v[224:225], v[48:49], v[26:27], v[52:53] op_sel:[0,0,0] op_sel_hi:[1,0,1] neg_lo:[0,1,0] neg_hi:[0,1,0]
    v_pk_fma_f32 v[226:227], v[50:51], v[26:27], v[54:55] op_sel:[0,0,0] op_sel_hi:[1,0,1] neg_lo:[0,1,0] neg_hi:[0,1,0]
    v_pk_fma_f32 v[92:93], v[92:93], v[26:27], v[224:225] op_sel:[0,1,0] op_sel_hi:[1,1,1]
    v_pk_fma_f32 v[94:95], v[94:95], v[26:27], v[226:227] op_sel:[0,1,0] op_sel_hi:[1,1,1]
    v_exp_f32 v224, v92
    v_exp_f32 v225, v93
    v_exp_f32 v226, v94
    v_exp_f32 v227, v95
    v_pk_fma_f32 v[232:233], v[224:225], 0.5, 1.0 op_sel:[0,0,0] op_sel_hi:[1,0,0]
    v_pk_fma_f32 v[234:235], v[226:227], 0.5, 1.0 op_sel:[0,0,0] op_sel_hi:[1,0,0]
    v_pk_fma_f32 v[224:225], v[224:225], v[232:233], 1.0 op_sel:[0,0,0] op_sel_hi:[1,1,0]
    v_pk_fma_f32 v[226:227], v[226:227], v[234:235], 1.0 op_sel:[0,0,0] op_sel_hi:[1,1,0]
    v_rcp_f32 v224, v224
    v_rcp_f32 v225, v225
    v_rcp_f32 v226, v226
    v_rcp_f32 v227, v227
    v_pk_fma_f32 v[224:225], v[92:93], v[224:225], v[92:93] op_sel:[0,0,0] op_sel_hi:[1,1,1] neg_lo:[1,0,0] neg_hi:[1,0,0]
    v_pk_fma_f32 v[226:227], v[94:95], v[226:227], v[94:95] op_sel:[0,0,0] op_sel_hi:[1,1,1] neg_lo:[1,0,0] neg_hi:[1,0,0]
    v_cvt_pk_bf16_f32 v92, v224, v225
    v_cvt_pk_bf16_f32 v93, v226, v227
    s_lshl_b32 s40, s18, 11
    s_add_u32 s40, s40, 106496
    s_xor_b32 s41, s40, 4096
    v_lshlrev_b32 v9, 3, v1
    v_add_u32 v10, s41, v9
    v_add_u32 v9, s40, v9
    s_mul_i32 s40, s20, 589824
    s_add_u32 s28, s28, s40
    s_cmp_eq_u32 s20, 0
    s_cbranch_scc0 P1_od1
    ds_write_b64 v10, v[80:81] offset:0
    ds_write_b64 v10, v[84:85] offset:512
    ds_write_b64 v10, v[88:89] offset:1024
    ds_write_b64 v10, v[92:93] offset:1536
    s_branch P1_od2
P1_od1:
    ds_write_b64 v10, v[64:65] offset:0
    v_mov_b64 v[66:67], v[80:81]
    ds_write_b64 v10, v[68:69] offset:512
    v_mov_b64 v[70:71], v[84:85]
    ds_write_b64 v10, v[72:73] offset:1024
    v_mov_b64 v[74:75], v[88:89]
    ds_write_b64 v10, v[76:77] offset:1536
    v_mov_b64 v[78:79], v[92:93]
P1_od2:
    v_mov_b64 v[96:97], 0
    v_mov_b64 v[98:99], 0
    v_mov_b64 v[100:101], 0
    v_mov_b64 v[102:103], 0
    v_mov_b64 v[104:105], 0
    v_mov_b64 v[106:107], 0
    v_mov_b64 v[108:109], 0
    v_mov_b64 v[110:111], 0
    v_mov_b64 v[112:113], 0
    v_mov_b64 v[114:115], 0
    v_mov_b64 v[116:117], 0
    v_mov_b64 v[118:119], 0
    v_mov_b64 v[120:121], 0
    v_mov_b64 v[122:123], 0
    v_mov_b64 v[124:125], 0
    v_mov_b64 v[126:127], 0
    v_mov_b64 v[128:129], 0
    v_mov_b64 v[130:131], 0
    v_mov_b64 v[132:133], 0
    v_mov_b64 v[134:135], 0
    v_mov_b64 v[136:137], 0
    v_mov_b64 v[138:139], 0
    v_mov_b64 v[140:141], 0
    v_mov_b64 v[142:143], 0
    v_mov_b64 v[144:145], 0
    v_mov_b64 v[146:147], 0
    v_mov_b64 v[148:149], 0
    v_mov_b64 v[150:151], 0
    v_mov_b64 v[152:153], 0
    v_mov_b64 v[154:155], 0
    v_mov_b64 v[156:157], 0
    v_mov_b64 v[158:159], 0
    v_mov_b64 v[160:161], 0
    v_mov_b64 v[162:163], 0
    v_mov_b64 v[164:165], 0
    v_mov_b64 v[166:167], 0
    v_mov_b64 v[168:169], 0
    v_mov_b64 v[170:171], 0
    v_mov_b64 v[172:173], 0
    v_mov_b64 v[174:175], 0
    v_mov_b64 v[176:177], 0
    v_mov_b64 v[178:179], 0
    v_mov_b64 v[180:181], 0
    v_mov_b64 v[182:183], 0
    v_mov_b64 v[184:185], 0
    v_mov_b64 v[186:187], 0
    v_mov_b64 v[188:189], 0
    v_mov_b64 v[190:191], 0
    v_mov_b64 v[192:193], 0
    v_mov_b64 v[194:195], 0
    v_mov_b64 v[196:197], 0
    v_mov_b64 v[198:199], 0
    v_mov_b64 v[200:201], 0
    v_mov_b64 v[202:203], 0
    v_mov_b64 v[204:205], 0
    v_mov_b64 v[206:207], 0
    v_mov_b64 v[208:209], 0
    v_mov_b64 v[210:211], 0
    v_mov_b64 v[212:213], 0
    v_mov_b64 v[214:215], 0
    v_mov_b64 v[216:217], 0
    v_mov_b64 v[218:219], 0
    v_mov_b64 v[220:221], 0
    v_mov_b64 v[222:223], 0
    v_mov_b64 v[224:225], 0
    v_mov_b64 v[226:227], 0
    v_mov_b64 v[228:229], 0
    v_mov_b64 v[230:231], 0
    v_mov_b64 v[232:233], 0
    v_mov_b64 v[234:235], 0
    v_mov_b64 v[236:237], 0
    v_mov_b64 v[238:239], 0
    v_mov_b64 v[240:241], 0
    v_mov_b64 v[242:243], 0
    v_mov_b64 v[244:245], 0
    v_mov_b64 v[246:247], 0
    v_mov_b64 v[248:249], 0
    v_mov_b64 v[250:251], 0
    v_mov_b64 v[252:253], 0
    v_mov_b64 v[254:255], 0
    s_waitcnt vmcnt(5) lgkmcnt(0)
    s_barrier
    s_cmp_eq_u32 s20, 0
    s_cbranch_scc0 P1_od3
    ds_read_b64 v[66:67], v9 offset:0
    ds_read_b64 v[70:71], v9 offset:512
    ds_read_b64 v[74:75], v9 offset:1024
    ds_read_b64 v[78:79], v9 offset:1536
    s_branch P1_od4
P1_od3:
    ds_read_b64 v[64:65], v9 offset:0
    ds_read_b64 v[68:69], v9 offset:512
    ds_read_b64 v[72:73], v9 offset:1024
    ds_read_b64 v[76:77], v9 offset:1536
P1_od4:
    v_readfirstlane_b32 s45, v30
    s_nop 1
    s_cmp_ge_u32 s45, 16
    s_cbranch_scc0 P1_w1_slow
P1_w1_ok:
    s_waitcnt lgkmcnt(0)
    buffer_store_dwordx4 v[64:67], v6, s[12:15], s28 offen sc1
    s_add_u32 s28, s28, 147456
    buffer_store_dwordx4 v[68:71], v6, s[12:15], s28 offen sc1
    s_add_u32 s28, s28, 147456
    buffer_store_dwordx4 v[72:75], v6, s[12:15], s28 offen sc1
    s_add_u32 s28, s28, 147456
    buffer_store_dwordx4 v[76:79], v6, s[12:15], s28 offen sc1
    s_mul_i32 s26, s3, 294912
    s_add_u32 s36, s36, s26
    s_lshl_b32 s43, s26, 1
    s_sub_u32 s43, 294912, s43
    s_add_u32 s42, s36, s43
    buffer_load_dwordx4 a[160:163], v2, s[4:7], s36 offen offset:0 sc1
    buffer_load_dwordx4 a[164:167], v3, s[4:7], s36 offen offset:0 sc1
    buffer_load_dwordx4 a[168:171], v2, s[4:7], s42 offen offset:0 sc1
    buffer_load_dwordx4 a[172:175], v3, s[4:7], s42 offen offset:0 sc1
    buffer_load_dwordx4 a[176:179], v2, s[4:7], s36 offen offset:1024 sc1
    buffer_load_dwordx4 a[180:183], v3, s[4:7], s36 offen offset:1024 sc1
    buffer_load_dwordx4 a[184:187], v2, s[4:7], s42 offen offset:1024 sc1
    buffer_load_dwordx4 a[188:191], v3, s[4:7], s42 offen offset:1024 sc1
    s_add_u32 s36, s36, 2048
    ds_read_b64_tr_b16 a[64:65], v7 offset:16896
    ds_read_b64_tr_b16 a[66:67], v7 offset:17408
    ds_read_b64_tr_b16 a[68:69], v7 offset:16928
    ds_read_b64_tr_b16 a[70:71], v7 offset:17440
    ds_read_b64_tr_b16 a[72:73], v7 offset:16960
    ds_read_b64_tr_b16 a[74:75], v7 offset:17472
    ds_read_b64_tr_b16 a[76:77], v7 offset:16992
    ds_read_b64_tr_b16 a[78:79], v7 offset:17504
    ds_read_b64_tr_b16 a[80:81], v7 offset:17024
    s_add_u32 s42, s36, s43
    ds_read_b64_tr_b16 a[82:83], v7 offset:17536
    ds_read_b64_tr_b16 a[84:85], v7 offset:17056
    ds_read_b64_tr_b16 a[86:87], v7 offset:17568
    ds_read_b64_tr_b16 a[88:89], v7 offset:17088
    ds_read_b64_tr_b16 a[90:91], v7 offset:17600
    ds_read_b64_tr_b16 a[92:93], v7 offset:17120
    ds_read_b64_tr_b16 a[94:95], v7 offset:17632
    ds_read_b64_tr_b16 a[96:97], v7 offset:25344
    buffer_load_dwordx4 a[192:195], v2, s[4:7], s36 offen offset:0 sc1
    ds_read_b64_tr_b16 a[98:99], v7 offset:25856
    ds_read_b64_tr_b16 a[100:101], v7 offset:25376
    ds_read_b64_tr_b16 a[102:103], v7 offset:25888
    ds_read_b64_tr_b16 a[104:105], v7 offset:25408
    ds_read_b64_tr_b16 a[106:107], v7 offset:25920
    ds_read_b64_tr_b16 a[108:109], v7 offset:25440
    ds_read_b64_tr_b16 a[110:111], v7 offset:25952
    ds_read_b64_tr_b16 a[112:113], v7 offset:25472
    ds_read_b64_tr_b16 a[114:115], v7 offset:25984
    buffer_load_dwordx4 a[196:199], v3, s[4:7], s36 offen offset:0 sc1
    ds_read_b64_tr_b16 a[116:117], v7 offset:25504
    ds_read_b64_tr_b16 a[118:119], v7 offset:26016
    ds_read_b64_tr_b16 a[120:121], v7 offset:25536
    ds_read_b64_tr_b16 a[122:123], v7 offset:26048
    ds_read_b64_tr_b16 a[124:125], v7 offset:25568
    ds_read_b64_tr_b16 a[126:127], v7 offset:26080
    v_and_b32 v9, 15, v1
    v_lshrrev_b32 v10, 5, v1
    buffer_load_dwordx4 a[200:203], v2, s[4:7], s42 offen offset:0 sc1
    v_and_b32 v0, 7, v1
    v_xor_b32 v0, v0, v10
    v_lshlrev_b32 v0, 4, v0
    v_lshl_add_u32 v0, v9, 7, v0
    v_bfe_u32 v8, v1, 4, 1
    v_lshl_add_u32 v0, v8, 3, v0
    v_add_u32 v0, s37, v0
    v_lshlrev_b32 v9, 11, v9
    buffer_load_dwordx4 a[204:207], v3, s[4:7], s42 offen offset:0 sc1
    v_lshl_add_u32 v9, v8, 5, v9
    v_lshl_add_u32 v8, v10, 4, v9
    v_lshrrev_b32 v18, 3, v1
    v_lshlrev_b32 v18, 14, v18
    v_and_b32 v19, 7, v1
    v_lshl_add_u32 v18, v19, 4, v18
    s_lshl_b32 s40, s18, 12
    s_and_b32 s44, s32, 0x7ff
    s_add_u32 s40, s40, s44
    buffer_load_dwordx4 a[208:211], v2, s[4:7], s36 offen offset:1024 sc1
    v_add_u32 v18, s40, v18
    v_lshlrev_b32 v20, 7, v10
    v_sub_u32 v20, v7, v20
    v_add_u32 v27, 1966080, v18
    v_add_u32 v28, 992, v27
    v_add_u32 v18, 524288, v18
    v_add_u32 v19, 992, v18
    v_add_u32 v29, 67584, v20
    buffer_load_dwordx4 a[212:215], v3, s[4:7], s36 offen offset:1024 sc1
    v_add_u32 v30, 126720, v20
    s_add_u32 s46, s39, 67584
    s_mov_b32 s92, s54
    s_and_b32 s93, s55, 0xffff
    s_mov_b32 s94, 1966080
    s_mov_b32 s95, 0x20000
    s_lshl_b32 s40, s100, 3
    s_add_u32 s40, s40, s101
    buffer_load_dwordx4 a[216:219], v2, s[4:7], s42 offen offset:1024 sc1
    s_add_u32 s41, s40, 48
    s_lshl_b32 s41, s41, 8
    s_lshl_b32 s40, s40, 2
    s_lshl_b32 s44, s23, 1
    s_add_u32 s40, s40, s44
    s_add_u32 s40, s40, s3
    s_lshl_b32 s45, s18, 12
    s_add_u32 s45, s45, 29360128
    s_mul_i32 s38, s40, 49152
    buffer_load_dwordx4 a[220:223], v3, s[4:7], s42 offen offset:1024 sc1
    s_add_u32 s38, s38, s45
    s_xor_b32 s44, s40, 1
    s_mul_i32 s44, s44, 49152
    s_add_u32 s44, s44, s45
    s_add_u32 s44, s44, 0
    v_add_u32 v21, s44, v6
    s_xor_b32 s44, s40, 2
    s_mul_i32 s44, s44, 49152
    s_add_u32 s36, s36, 2048
    s_add_u32 s44, s44, s45
    s_add_u32 s44, s44, 16384
    v_add_u32 v22, s44, v6
    s_xor_b32 s44, s40, 3
    s_mul_i32 s44, s44, 49152
    s_add_u32 s44, s44, s45
    s_add_u32 s44, s44, 32768
    v_add_u32 v23, s44, v6
    s_mov_b32 s28, 2048
    s_mov_b32 s34, 2048
    s_mov_b32 s19, s43
    s_mov_b32 s20, s43
    s_waitcnt vmcnt(8)
    s_add_u32 s40, s25, 6144
    v_mov_b32 v12, s40
    ds_read_b64 v[80:81], v0 offset:0
    ds_read_b64 v[88:89], v0 offset:2048
    v_xor_b32 v0, 32, v0
    ds_read_b64 v[82:83], v0 offset:0
    ds_read_b64 v[90:91], v0 offset:2048
    v_xor_b32 v0, 96, v0
    ds_read_b64 v[84:85], v0 offset:0
    ds_read_b64 v[92:93], v0 offset:2048
    v_xor_b32 v0, 32, v0
    ds_read_b64 v[86:87], v0 offset:0
    ds_read_b64 v[94:95], v0 offset:2048
    s_branch P2_Y1
P1_hookW:
    s_cmp_lt_u32 s37, 10
    s_cbranch_scc0 P1_h1W
    v_mov_b32 v12, 0
    v_mov_b32 v13, 1
    s_mov_b64 exec, 1
    global_atomic_add v12, v13, s[64:65] sc1
    s_mov_b64 exec, -1
    s_cbranch_vccnz P1_backW1
    s_branch P1_backW0
P1_h1W:
    s_cmp_eq_u32 s37, 10
    s_cbranch_scc0 P1_h2W
    v_mov_b32 v14, 0
    global_load_dword v12, v14, s[64:65] sc1
    s_cbranch_vccnz P1_backW1
    s_branch P1_backW0
P1_h2W:
    v_readfirstlane_b32 s45, v12
    s_nop 1
    s_cmp_ge_u32 s45, 256
    s_cbranch_scc0 P1_stW_slow
P1_stW_ok:
    buffer_load_dwordx2 v[12:13], v29, s[12:15], s96 offen offset:0 sc1
    buffer_load_dwordx2 v[14:15], v29, s[12:15], s96 offen offset:128 sc1
    buffer_load_dwordx2 v[16:17], v29, s[12:15], s96 offen offset:256 sc1
    buffer_load_dwordx2 v[18:19], v29, s[12:15], s96 offen offset:384 sc1
    buffer_load_dwordx2 v[20:21], v29, s[12:15], s96 offen offset:512 sc1
    buffer_load_dwordx2 v[22:23], v29, s[12:15], s96 offen offset:640 sc1
    buffer_load_dwordx2 v[24:25], v29, s[12:15], s96 offen offset:768 sc1
    buffer_load_dwordx2 v[26:27], v29, s[12:15], s96 offen offset:896 sc1
    s_mov_b32 s92, s54
    s_and_b32 s93, s55, 0xffff
    s_mov_b32 s94, 2097152
    v_mov_b32 v0, v30
    v_bfrev_b32 v10, 1
    buffer_load_dword v11, v31, s[88:91], 0 offen
    s_cbranch_vccnz P1_backW1
    s_branch P1_backW0
P1_hookQ:
    s_cmp_lt_u32 s37, 10
    s_cbranch_scc0 P1_h1Q
    v_mov_b32 v12, 0
    v_mov_b32 v13, 1
    s_mov_b64 exec, 1
    global_atomic_add v12, v13, s[64:65] sc1
    s_mov_b64 exec, -1
    s_cbranch_vccnz P1_backQ1
    s_branch P1_backQ0
P1_h1Q:
    s_cmp_eq_u32 s37, 10
    s_cbranch_scc0 P1_h2Q
    v_mov_b32 v14, 0
    global_load_dword v12, v14, s[64:65] sc1
    s_cbranch_vccnz P1_backQ1
    s_branch P1_backQ0
P1_h2Q:
    v_readfirstlane_b32 s45, v12
    s_nop 1
    s_cmp_ge_u32 s45, 256
    s_cbranch_scc0 P1_stQ_slow
P1_stQ_ok:
    buffer_load_dwordx2 v[12:13], v29, s[12:15], s96 offen offset:0 sc1
    buffer_load_dwordx2 v[14:15], v29, s[12:15], s96 offen offset:128 sc1
    buffer_load_dwordx2 v[16:17], v29, s[12:15], s96 offen offset:256 sc1
    buffer_load_dwordx2 v[18:19], v29, s[12:15], s96 offen offset:384 sc1
    buffer_load_dwordx2 v[20:21], v29, s[12:15], s96 offen offset:512 sc1
    buffer_load_dwordx2 v[22:23], v29, s[12:15], s96 offen offset:640 sc1
    buffer_load_dwordx2 v[24:25], v29, s[12:15], s96 offen offset:768 sc1
    buffer_load_dwordx2 v[26:27], v29, s[12:15], s96 offen offset:896 sc1
    s_mov_b32 s92, s54
    s_and_b32 s93, s55, 0xffff
    s_mov_b32 s94, 2097152
    v_mov_b32 v0, v30
    v_bfrev_b32 v10, 1
    buffer_load_dword v11, v31, s[88:91], 0 offen
    s_cbranch_vccnz P1_backQ1
    s_branch P1_backQ0
P1_six:
    s_waitcnt vmcnt(21)
    s_barrier
    v_add_u32 v8, s30, v5
    ds_read_b64_tr_b16 a[0:1], v7 offset:0
    ds_read_b64_tr_b16 a[2:3], v7 offset:1808
    ds_read_b64_tr_b16 a[4:5], v7 offset:32
    ds_read_b64_tr_b16 a[6:7], v7 offset:1840
    ds_read_b64_tr_b16 a[8:9], v7 offset:64
    ds_read_b64_tr_b16 a[10:11], v7 offset:1872
    ds_read_b64_tr_b16 a[12:13], v7 offset:96
    ds_read_b64_tr_b16 a[14:15], v7 offset:1904
    ds_read_b64_tr_b16 a[16:17], v7 offset:128
    ds_read_b64_tr_b16 a[18:19], v7 offset:1936
    ds_read_b64_tr_b16 a[20:21], v7 offset:160
    ds_read_b64_tr_b16 a[22:23], v7 offset:1968
    ds_read_b128 a[56:59], v8 offset:0
    ds_read_b128 a[60:63], v8 offset:2048
    ds_read_b128 a[64:67], v8 offset:4096
    ds_read_b128 a[68:71], v8 offset:6144
    ds_read_b128 a[72:75], v8 offset:8192
    ds_read_b128 a[76:79], v8 offset:10240
    ds_read_b128 a[80:83], v8 offset:12288
    ds_read_b128 a[84:87], v8 offset:14336
    v_add_u32 v8, s30, v6
    v_add_u32 v9, s33, v7
    s_cbranch_vccnz P1_loopQ1
.p2align 6
P1_loopQ0:
    s_waitcnt vmcnt(12) lgkmcnt(0)
    s_barrier
    v_mfma_f32_16x16x32_bf16 v[32:35], a[0:3], a[56:59], v[32:35]
    s_bitcmp1_b32 s47, s37
    s_cbranch_scc1 P1_hookQ
P1_backQ0:
    v_mfma_f32_16x16x32_bf16 v[64:67], a[4:7], a[56:59], v[64:67]
    buffer_load_dword v11, v10, s[8:11], 0 offen
    v_mfma_f32_16x16x32_bf16 v[96:99], a[8:11], a[56:59], v[96:99]
    v_add_u32 v10, s46, v10
    v_mfma_f32_16x16x32_bf16 v[128:131], a[12:15], a[56:59], v[128:131]
    buffer_load_dword v11, v0, s[92:95], 0 offen
    v_mfma_f32_16x16x32_bf16 v[160:163], a[16:19], a[56:59], v[160:163]
    v_add_u32 v0, 917504, v0
    v_mfma_f32_16x16x32_bf16 v[192:195], a[20:23], a[56:59], v[192:195]
    s_cmp_ge_u32 s37, 14
    s_cselect_b32 s6, 0, s6
    v_mfma_f32_16x16x32_bf16 v[196:199], a[20:23], a[60:63], v[196:199]
    ds_read_b64_tr_b16 a[28:29], v9 offset:14464
    v_mfma_f32_16x16x32_bf16 v[164:167], a[16:19], a[60:63], v[164:167]
    ds_read_b64_tr_b16 a[30:31], v9 offset:16272
    v_mfma_f32_16x16x32_bf16 v[132:135], a[12:15], a[60:63], v[132:135]
    v_mfma_f32_16x16x32_bf16 v[100:103], a[8:11], a[60:63], v[100:103]
    ds_read_b128 a[88:91], v8 offset:0
    v_mfma_f32_16x16x32_bf16 v[68:71], a[4:7], a[60:63], v[68:71]
    ds_read_b64_tr_b16 a[32:33], v9 offset:14496
    v_mfma_f32_16x16x32_bf16 v[36:39], a[0:3], a[60:63], v[36:39]
    ds_read_b64_tr_b16 a[34:35], v9 offset:16304
    v_mfma_f32_16x16x32_bf16 v[40:43], a[0:3], a[64:67], v[40:43]
    ds_read_b128 a[92:95], v8 offset:2048
    v_mfma_f32_16x16x32_bf16 v[72:75], a[4:7], a[64:67], v[72:75]
    ds_read_b64_tr_b16 a[36:37], v9 offset:14528
    v_mfma_f32_16x16x32_bf16 v[104:107], a[8:11], a[64:67], v[104:107]
    ds_read_b64_tr_b16 a[38:39], v9 offset:16336
    v_mfma_f32_16x16x32_bf16 v[136:139], a[12:15], a[64:67], v[136:139]
    ds_read_b128 a[96:99], v8 offset:4096
    v_mfma_f32_16x16x32_bf16 v[168:171], a[16:19], a[64:67], v[168:171]
    v_mfma_f32_16x16x32_bf16 v[200:203], a[20:23], a[64:67], v[200:203]
    ds_read_b64_tr_b16 a[40:41], v9 offset:14560
    v_mfma_f32_16x16x32_bf16 v[204:207], a[20:23], a[68:71], v[204:207]
    ds_read_b64_tr_b16 a[42:43], v9 offset:16368
    v_mfma_f32_16x16x32_bf16 v[172:175], a[16:19], a[68:71], v[172:175]
    ds_read_b128 a[100:103], v8 offset:6144
    v_mfma_f32_16x16x32_bf16 v[140:143], a[12:15], a[68:71], v[140:143]
    s_add_u32 m0, s34, s43
    s_mov_b64 exec, s[28:29]
    v_mfma_f32_16x16x32_bf16 v[108:111], a[8:11], a[68:71], v[108:111]
    buffer_load_dwordx4 v4, s[8:11], s35 offen offset:0 lds
    v_mfma_f32_16x16x32_bf16 v[76:79], a[4:7], a[68:71], v[76:79]
    s_add_u32 s35, s35, 11456
    v_mfma_f32_16x16x32_bf16 v[44:47], a[0:3], a[68:71], v[44:47]
    buffer_load_dwordx4 v4, s[8:11], s35 offen offset:832 lds
    v_mfma_f32_16x16x32_bf16 v[48:51], a[0:3], a[72:75], v[48:51]
    v_mfma_f32_16x16x32_bf16 v[80:83], a[4:7], a[72:75], v[80:83]
    s_add_u32 s35, s35, 11312
    v_mfma_f32_16x16x32_bf16 v[112:115], a[8:11], a[72:75], v[112:115]
    buffer_load_dwordx4 v4, s[8:11], s35 offen offset:1808 lds
    v_mfma_f32_16x16x32_bf16 v[144:147], a[12:15], a[72:75], v[144:147]
    s_add_u32 s35, s35, 11456
    v_mfma_f32_16x16x32_bf16 v[176:179], a[16:19], a[72:75], v[176:179]
    buffer_load_dwordx4 v4, s[8:11], s35 offen offset:2640 lds
    v_mfma_f32_16x16x32_bf16 v[208:211], a[20:23], a[72:75], v[208:211]
    s_mov_b64 exec, -1
    s_add_u32 s35, s35, 162384
    v_mfma_f32_16x16x32_bf16 v[212:215], a[20:23], a[76:79], v[212:215]
    ds_read_b64_tr_b16 a[44:45], v9 offset:14592
    v_mfma_f32_16x16x32_bf16 v[180:183], a[16:19], a[76:79], v[180:183]
    ds_read_b64_tr_b16 a[46:47], v9 offset:16400
    v_mfma_f32_16x16x32_bf16 v[148:151], a[12:15], a[76:79], v[148:151]
    s_add_u32 m0, s32, s38
    v_mfma_f32_16x16x32_bf16 v[116:119], a[8:11], a[76:79], v[116:119]
    v_mfma_f32_16x16x32_bf16 v[84:87], a[4:7], a[76:79], v[84:87]
    s_mov_b32 s40, s36
    v_mfma_f32_16x16x32_bf16 v[52:55], a[0:3], a[76:79], v[52:55]
    buffer_load_dwordx4 v2, s[4:7], s40 offen offset:0 lds
    v_mfma_f32_16x16x32_bf16 v[56:59], a[0:3], a[80:83], v[56:59]
    ds_read_b128 a[104:107], v8 offset:8192
    v_mfma_f32_16x16x32_bf16 v[88:91], a[4:7], a[80:83], v[88:91]
    ds_read_b64_tr_b16 a[48:49], v9 offset:14624
    v_mfma_f32_16x16x32_bf16 v[120:123], a[8:11], a[80:83], v[120:123]
    buffer_load_dwordx4 v3, s[4:7], s40 offen offset:1024 lds
    v_mfma_f32_16x16x32_bf16 v[152:155], a[12:15], a[80:83], v[152:155]
    ds_read_b64_tr_b16 a[50:51], v9 offset:16432
    v_mfma_f32_16x16x32_bf16 v[184:187], a[16:19], a[80:83], v[184:187]
    ds_read_b128 a[108:111], v8 offset:10240
    v_mfma_f32_16x16x32_bf16 v[216:219], a[20:23], a[80:83], v[216:219]
    v_mfma_f32_16x16x32_bf16 v[220:223], a[20:23], a[84:87], v[220:223]
    s_add_u32 s40, s40, 30720
    v_mfma_f32_16x16x32_bf16 v[188:191], a[16:19], a[84:87], v[188:191]
    buffer_load_dwordx4 v2, s[4:7], s40 offen offset:2048 lds
    v_mfma_f32_16x16x32_bf16 v[156:159], a[12:15], a[84:87], v[156:159]
    ds_read_b128 a[112:115], v8 offset:12288
    v_mfma_f32_16x16x32_bf16 v[124:127], a[8:11], a[84:87], v[124:127]
    ds_read_b128 a[116:119], v8 offset:14336
    v_mfma_f32_16x16x32_bf16 v[92:95], a[4:7], a[84:87], v[92:95]
    buffer_load_dwordx4 v3, s[4:7], s40 offen offset:3072 lds
    v_mfma_f32_16x16x32_bf16 v[60:63], a[0:3], a[84:87], v[60:63]
    v_add_u32 v8, s31, v5
    v_mfma_f32_16x16x32_bf16 a[120:123], a[0:3], a[148:151], a[120:123]
    v_add_u32 v9, s34, v7
    v_mfma_f32_16x16x32_bf16 a[124:127], a[4:7], a[148:151], a[124:127]
    v_mfma_f32_16x16x32_bf16 a[128:131], a[8:11], a[148:151], a[128:131]
    s_waitcnt vmcnt(10) lgkmcnt(0)
    s_barrier
    v_mfma_f32_16x16x32_bf16 v[32:35], a[28:31], a[88:91], v[32:35]
    s_cmp_ge_u32 s37, 14
    s_cselect_b32 s10, 0, s10
    v_mfma_f32_16x16x32_bf16 v[64:67], a[32:35], a[88:91], v[64:67]
    ds_read_b64_tr_b16 a[0:1], v9 offset:0
    v_mfma_f32_16x16x32_bf16 v[96:99], a[36:39], a[88:91], v[96:99]
    ds_read_b64_tr_b16 a[2:3], v9 offset:1808
    v_mfma_f32_16x16x32_bf16 v[128:131], a[40:43], a[88:91], v[128:131]
    ds_read_b128 a[56:59], v8 offset:0
    v_mfma_f32_16x16x32_bf16 v[160:163], a[44:47], a[88:91], v[160:163]
    ds_read_b64_tr_b16 a[4:5], v9 offset:32
    v_mfma_f32_16x16x32_bf16 v[192:195], a[48:51], a[88:91], v[192:195]
    ds_read_b64_tr_b16 a[6:7], v9 offset:1840
    v_mfma_f32_16x16x32_bf16 v[196:199], a[48:51], a[92:95], v[196:199]
    ds_read_b128 a[60:63], v8 offset:2048
    v_mfma_f32_16x16x32_bf16 v[164:167], a[44:47], a[92:95], v[164:167]
    v_mfma_f32_16x16x32_bf16 v[132:135], a[40:43], a[92:95], v[132:135]
    ds_read_b64_tr_b16 a[8:9], v9 offset:64
    v_mfma_f32_16x16x32_bf16 v[100:103], a[36:39], a[92:95], v[100:103]
    ds_read_b64_tr_b16 a[10:11], v9 offset:1872
    v_mfma_f32_16x16x32_bf16 v[68:71], a[32:35], a[92:95], v[68:71]
    ds_read_b128 a[64:67], v8 offset:4096
    v_mfma_f32_16x16x32_bf16 v[36:39], a[28:31], a[92:95], v[36:39]
    ds_read_b64_tr_b16 a[12:13], v9 offset:96
    v_mfma_f32_16x16x32_bf16 v[40:43], a[28:31], a[96:99], v[40:43]
    ds_read_b64_tr_b16 a[14:15], v9 offset:1904
    v_mfma_f32_16x16x32_bf16 v[72:75], a[32:35], a[96:99], v[72:75]
    ds_read_b128 a[68:71], v8 offset:6144
    v_mfma_f32_16x16x32_bf16 v[104:107], a[36:39], a[96:99], v[104:107]
    v_mfma_f32_16x16x32_bf16 v[136:139], a[40:43], a[96:99], v[136:139]
    s_add_u32 m0, s33, s39
    s_mov_b64 exec, s[28:29]
    v_mfma_f32_16x16x32_bf16 v[168:171], a[44:47], a[96:99], v[168:171]
    buffer_load_dwordx4 v4, s[8:11], s35 offen offset:0 lds
    v_mfma_f32_16x16x32_bf16 v[200:203], a[48:51], a[96:99], v[200:203]
    s_add_u32 s35, s35, 11456
    v_mfma_f32_16x16x32_bf16 v[204:207], a[48:51], a[100:103], v[204:207]
    buffer_load_dwordx4 v4, s[8:11], s35 offen offset:832 lds
    v_mfma_f32_16x16x32_bf16 v[172:175], a[44:47], a[100:103], v[172:175]
    s_add_u32 s35, s35, 11312
    v_mfma_f32_16x16x32_bf16 v[140:143], a[40:43], a[100:103], v[140:143]
    buffer_load_dwordx4 v4, s[8:11], s35 offen offset:1808 lds
    v_mfma_f32_16x16x32_bf16 v[108:111], a[36:39], a[100:103], v[108:111]
    v_mfma_f32_16x16x32_bf16 v[76:79], a[32:35], a[100:103], v[76:79]
    s_add_u32 s35, s35, 11456
    v_mfma_f32_16x16x32_bf16 v[44:47], a[28:31], a[100:103], v[44:47]
    buffer_load_dwordx4 v4, s[8:11], s35 offen offset:2640 lds
    v_mfma_f32_16x16x32_bf16 v[48:51], a[28:31], a[104:107], v[48:51]
    s_mov_b64 exec, -1
    s_add_u32 s35, s35, 162384
    v_mfma_f32_16x16x32_bf16 v[80:83], a[32:35], a[104:107], v[80:83]
    ds_read_b64_tr_b16 a[16:17], v9 offset:128
    v_mfma_f32_16x16x32_bf16 v[112:115], a[36:39], a[104:107], v[112:115]
    ds_read_b64_tr_b16 a[18:19], v9 offset:1936
    v_mfma_f32_16x16x32_bf16 v[144:147], a[40:43], a[104:107], v[144:147]
    s_add_u32 m0, s32, s42
    v_mfma_f32_16x16x32_bf16 v[176:179], a[44:47], a[104:107], v[176:179]
    v_mfma_f32_16x16x32_bf16 v[208:211], a[48:51], a[104:107], v[208:211]
    s_add_u32 s40, s36, 65536
    v_mfma_f32_16x16x32_bf16 v[212:215], a[48:51], a[108:111], v[212:215]
    buffer_load_dwordx4 v2, s[4:7], s40 offen offset:0 lds
    v_mfma_f32_16x16x32_bf16 v[180:183], a[44:47], a[108:111], v[180:183]
    ds_read_b128 a[72:75], v8 offset:8192
    v_mfma_f32_16x16x32_bf16 v[148:151], a[40:43], a[108:111], v[148:151]
    ds_read_b64_tr_b16 a[20:21], v9 offset:160
    v_mfma_f32_16x16x32_bf16 v[116:119], a[36:39], a[108:111], v[116:119]
    buffer_load_dwordx4 v3, s[4:7], s40 offen offset:1024 lds
    v_mfma_f32_16x16x32_bf16 v[84:87], a[32:35], a[108:111], v[84:87]
    ds_read_b64_tr_b16 a[22:23], v9 offset:1968
    v_mfma_f32_16x16x32_bf16 v[52:55], a[28:31], a[108:111], v[52:55]
    v_mfma_f32_16x16x32_bf16 v[56:59], a[28:31], a[112:115], v[56:59]
    ds_read_b128 a[76:79], v8 offset:10240
    v_mfma_f32_16x16x32_bf16 v[88:91], a[32:35], a[112:115], v[88:91]
    s_add_u32 s40, s40, 30720
    v_mfma_f32_16x16x32_bf16 v[120:123], a[36:39], a[112:115], v[120:123]
    buffer_load_dwordx4 v2, s[4:7], s40 offen offset:2048 lds
    v_mfma_f32_16x16x32_bf16 v[152:155], a[40:43], a[112:115], v[152:155]
    ds_read_b128 a[80:83], v8 offset:12288
    v_mfma_f32_16x16x32_bf16 v[184:187], a[44:47], a[112:115], v[184:187]
    ds_read_b128 a[84:87], v8 offset:14336
    v_mfma_f32_16x16x32_bf16 v[216:219], a[48:51], a[112:115], v[216:219]
    buffer_load_dwordx4 v3, s[4:7], s40 offen offset:3072 lds
    v_mfma_f32_16x16x32_bf16 v[220:223], a[48:51], a[116:119], v[220:223]
    v_mfma_f32_16x16x32_bf16 v[188:191], a[44:47], a[116:119], v[188:191]
    s_mov_b32 s40, s30
    s_mov_b32 s30, s31
    v_mfma_f32_16x16x32_bf16 v[156:159], a[40:43], a[116:119], v[156:159]
    s_mov_b32 s31, s32
    s_mov_b32 s32, s40
    v_mfma_f32_16x16x32_bf16 v[124:127], a[36:39], a[116:119], v[124:127]
    s_xor_b32 s33, s33, 28928
    s_xor_b32 s34, s34, 28928
    v_mfma_f32_16x16x32_bf16 v[92:95], a[32:35], a[116:119], v[92:95]
    s_add_u32 s36, s36, 128
    s_add_u32 s37, s37, 1
    v_mfma_f32_16x16x32_bf16 v[60:63], a[28:31], a[116:119], v[60:63]
    v_add_u32 v8, s30, v6
    v_mfma_f32_16x16x32_bf16 a[120:123], a[28:31], a[148:151], a[120:123]
    v_add_u32 v9, s33, v7
    v_mfma_f32_16x16x32_bf16 a[124:127], a[32:35], a[148:151], a[124:127]
    v_mfma_f32_16x16x32_bf16 a[128:131], a[36:39], a[148:151], a[128:131]
    s_cmp_lt_u32 s37, 16
    s_cbranch_scc1 P1_loopQ0
    s_branch P1_endQ
.p2align 6
P1_loopQ1:
    s_waitcnt vmcnt(12) lgkmcnt(0)
    s_barrier
    v_mfma_f32_16x16x32_bf16 v[32:35], a[0:3], a[56:59], v[32:35]
    s_bitcmp1_b32 s47, s37
    s_cbranch_scc1 P1_hookQ
P1_backQ1:
    v_mfma_f32_16x16x32_bf16 v[64:67], a[4:7], a[56:59], v[64:67]
    buffer_load_dword v11, v10, s[8:11], 0 offen
    v_mfma_f32_16x16x32_bf16 v[96:99], a[8:11], a[56:59], v[96:99]
    v_add_u32 v10, s46, v10
    v_mfma_f32_16x16x32_bf16 v[128:131], a[12:15], a[56:59], v[128:131]
    buffer_load_dword v11, v0, s[92:95], 0 offen
    v_mfma_f32_16x16x32_bf16 v[160:163], a[16:19], a[56:59], v[160:163]
    v_add_u32 v0, 917504, v0
    v_mfma_f32_16x16x32_bf16 v[192:195], a[20:23], a[56:59], v[192:195]
    s_cmp_ge_u32 s37, 14
    s_cselect_b32 s6, 0, s6
    v_mfma_f32_16x16x32_bf16 v[196:199], a[20:23], a[60:63], v[196:199]
    ds_read_b64_tr_b16 a[28:29], v9 offset:14464
    v_mfma_f32_16x16x32_bf16 v[164:167], a[16:19], a[60:63], v[164:167]
    ds_read_b64_tr_b16 a[30:31], v9 offset:16272
    v_mfma_f32_16x16x32_bf16 v[132:135], a[12:15], a[60:63], v[132:135]
    v_mfma_f32_16x16x32_bf16 v[100:103], a[8:11], a[60:63], v[100:103]
    ds_read_b128 a[88:91], v8 offset:0
    v_mfma_f32_16x16x32_bf16 v[68:71], a[4:7], a[60:63], v[68:71]
    ds_read_b64_tr_b16 a[32:33], v9 offset:14496
    v_mfma_f32_16x16x32_bf16 v[36:39], a[0:3], a[60:63], v[36:39]
    ds_read_b64_tr_b16 a[34:35], v9 offset:16304
    v_mfma_f32_16x16x32_bf16 v[40:43], a[0:3], a[64:67], v[40:43]
    ds_read_b128 a[92:95], v8 offset:2048
    v_mfma_f32_16x16x32_bf16 v[72:75], a[4:7], a[64:67], v[72:75]
    ds_read_b64_tr_b16 a[36:37], v9 offset:14528
    v_mfma_f32_16x16x32_bf16 v[104:107], a[8:11], a[64:67], v[104:107]
    ds_read_b64_tr_b16 a[38:39], v9 offset:16336
    v_mfma_f32_16x16x32_bf16 v[136:139], a[12:15], a[64:67], v[136:139]
    ds_read_b128 a[96:99], v8 offset:4096
    v_mfma_f32_16x16x32_bf16 v[168:171], a[16:19], a[64:67], v[168:171]
    v_mfma_f32_16x16x32_bf16 v[200:203], a[20:23], a[64:67], v[200:203]
    ds_read_b64_tr_b16 a[40:41], v9 offset:14560
    v_mfma_f32_16x16x32_bf16 v[204:207], a[20:23], a[68:71], v[204:207]
    ds_read_b64_tr_b16 a[42:43], v9 offset:16368
    v_mfma_f32_16x16x32_bf16 v[172:175], a[16:19], a[68:71], v[172:175]
    ds_read_b128 a[100:103], v8 offset:6144
    v_mfma_f32_16x16x32_bf16 v[140:143], a[12:15], a[68:71], v[140:143]
    s_add_u32 m0, s34, s43
    s_mov_b64 exec, s[28:29]
    v_mfma_f32_16x16x32_bf16 v[108:111], a[8:11], a[68:71], v[108:111]
    buffer_load_dwordx4 v4, s[8:11], s35 offen offset:0 lds
    v_mfma_f32_16x16x32_bf16 v[76:79], a[4:7], a[68:71], v[76:79]
    s_add_u32 s35, s35, 11456
    v_mfma_f32_16x16x32_bf16 v[44:47], a[0:3], a[68:71], v[44:47]
    buffer_load_dwordx4 v4, s[8:11], s35 offen offset:832 lds
    v_mfma_f32_16x16x32_bf16 v[48:51], a[0:3], a[72:75], v[48:51]
    v_mfma_f32_16x16x32_bf16 v[80:83], a[4:7], a[72:75], v[80:83]
    s_add_u32 s35, s35, 11312
    v_mfma_f32_16x16x32_bf16 v[112:115], a[8:11], a[72:75], v[112:115]
    buffer_load_dwordx4 v4, s[8:11], s35 offen offset:1808 lds
    v_mfma_f32_16x16x32_bf16 v[144:147], a[12:15], a[72:75], v[144:147]
    s_add_u32 s35, s35, 11456
    v_mfma_f32_16x16x32_bf16 v[176:179], a[16:19], a[72:75], v[176:179]
    buffer_load_dwordx4 v4, s[8:11], s35 offen offset:2640 lds
    v_mfma_f32_16x16x32_bf16 v[208:211], a[20:23], a[72:75], v[208:211]
    s_mov_b64 exec, -1
    s_add_u32 s35, s35, 162384
    v_mfma_f32_16x16x32_bf16 v[212:215], a[20:23], a[76:79], v[212:215]
    ds_read_b64_tr_b16 a[44:45], v9 offset:14592
    v_mfma_f32_16x16x32_bf16 v[180:183], a[16:19], a[76:79], v[180:183]
    ds_read_b64_tr_b16 a[46:47], v9 offset:16400
    v_mfma_f32_16x16x32_bf16 v[148:151], a[12:15], a[76:79], v[148:151]
    s_add_u32 m0, s32, s38
    v_mfma_f32_16x16x32_bf16 v[116:119], a[8:11], a[76:79], v[116:119]
    v_mfma_f32_16x16x32_bf16 v[84:87], a[4:7], a[76:79], v[84:87]
    s_mov_b32 s40, s36
    v_mfma_f32_16x16x32_bf16 v[52:55], a[0:3], a[76:79], v[52:55]
    buffer_load_dwordx4 v2, s[4:7], s40 offen offset:0 lds
    v_mfma_f32_16x16x32_bf16 v[56:59], a[0:3], a[80:83], v[56:59]
    ds_read_b128 a[104:107], v8 offset:8192
    v_mfma_f32_16x16x32_bf16 v[88:91], a[4:7], a[80:83], v[88:91]
    ds_read_b64_tr_b16 a[48:49], v9 offset:14624
    v_mfma_f32_16x16x32_bf16 v[120:123], a[8:11], a[80:83], v[120:123]
    buffer_load_dwordx4 v3, s[4:7], s40 offen offset:1024 lds
    v_mfma_f32_16x16x32_bf16 v[152:155], a[12:15], a[80:83], v[152:155]
    ds_read_b64_tr_b16 a[50:51], v9 offset:16432
    v_mfma_f32_16x16x32_bf16 v[184:187], a[16:19], a[80:83], v[184:187]
    ds_read_b128 a[108:111], v8 offset:10240
    v_mfma_f32_16x16x32_bf16 v[216:219], a[20:23], a[80:83], v[216:219]
    v_mfma_f32_16x16x32_bf16 v[220:223], a[20:23], a[84:87], v[220:223]
    s_add_u32 s40, s40, 30720
    v_mfma_f32_16x16x32_bf16 v[188:191], a[16:19], a[84:87], v[188:191]
    buffer_load_dwordx4 v2, s[4:7], s40 offen offset:2048 lds
    v_mfma_f32_16x16x32_bf16 v[156:159], a[12:15], a[84:87], v[156:159]
    ds_read_b128 a[112:115], v8 offset:12288
    v_mfma_f32_16x16x32_bf16 v[124:127], a[8:11], a[84:87], v[124:127]
    ds_read_b128 a[116:119], v8 offset:14336
    v_mfma_f32_16x16x32_bf16 v[92:95], a[4:7], a[84:87], v[92:95]
    buffer_load_dwordx4 v3, s[4:7], s40 offen offset:3072 lds
    v_mfma_f32_16x16x32_bf16 v[60:63], a[0:3], a[84:87], v[60:63]
    v_add_u32 v8, s31, v5
    v_mfma_f32_16x16x32_bf16 a[132:135], a[12:15], a[148:151], a[132:135]
    v_add_u32 v9, s34, v7
    v_mfma_f32_16x16x32_bf16 a[136:139], a[16:19], a[148:151], a[136:139]
    v_mfma_f32_16x16x32_bf16 a[140:143], a[20:23], a[148:151], a[140:143]
    s_waitcnt vmcnt(10) lgkmcnt(0)
    s_barrier
    v_mfma_f32_16x16x32_bf16 v[32:35], a[28:31], a[88:91], v[32:35]
    s_cmp_ge_u32 s37, 14
    s_cselect_b32 s10, 0, s10
    v_mfma_f32_16x16x32_bf16 v[64:67], a[32:35], a[88:91], v[64:67]
    ds_read_b64_tr_b16 a[0:1], v9 offset:0
    v_mfma_f32_16x16x32_bf16 v[96:99], a[36:39], a[88:91], v[96:99]
    ds_read_b64_tr_b16 a[2:3], v9 offset:1808
    v_mfma_f32_16x16x32_bf16 v[128:131], a[40:43], a[88:91], v[128:131]
    ds_read_b128 a[56:59], v8 offset:0
    v_mfma_f32_16x16x32_bf16 v[160:163], a[44:47], a[88:91], v[160:163]
    ds_read_b64_tr_b16 a[4:5], v9 offset:32
    v_mfma_f32_16x16x32_bf16 v[192:195], a[48:51], a[88:91], v[192:195]
    ds_read_b64_tr_b16 a[6:7], v9 offset:1840
    v_mfma_f32_16x16x32_bf16 v[196:199], a[48:51], a[92:95], v[196:199]
    ds_read_b128 a[60:63], v8 offset:2048
    v_mfma_f32_16x16x32_bf16 v[164:167], a[44:47], a[92:95], v[164:167]
    v_mfma_f32_16x16x32_bf16 v[132:135], a[40:43], a[92:95], v[132:135]
    ds_read_b64_tr_b16 a[8:9], v9 offset:64
    v_mfma_f32_16x16x32_bf16 v[100:103], a[36:39], a[92:95], v[100:103]
    ds_read_b64_tr_b16 a[10:11], v9 offset:1872
    v_mfma_f32_16x16x32_bf16 v[68:71], a[32:35], a[92:95], v[68:71]
    ds_read_b128 a[64:67], v8 offset:4096
    v_mfma_f32_16x16x32_bf16 v[36:39], a[28:31], a[92:95], v[36:39]
    ds_read_b64_tr_b16 a[12:13], v9 offset:96
    v_mfma_f32_16x16x32_bf16 v[40:43], a[28:31], a[96:99], v[40:43]
    ds_read_b64_tr_b16 a[14:15], v9 offset:1904
    v_mfma_f32_16x16x32_bf16 v[72:75], a[32:35], a[96:99], v[72:75]
    ds_read_b128 a[68:71], v8 offset:6144
    v_mfma_f32_16x16x32_bf16 v[104:107], a[36:39], a[96:99], v[104:107]
    v_mfma_f32_16x16x32_bf16 v[136:139], a[40:43], a[96:99], v[136:139]
    s_add_u32 m0, s33, s39
    s_mov_b64 exec, s[28:29]
    v_mfma_f32_16x16x32_bf16 v[168:171], a[44:47], a[96:99], v[168:171]
    buffer_load_dwordx4 v4, s[8:11], s35 offen offset:0 lds
    v_mfma_f32_16x16x32_bf16 v[200:203], a[48:51], a[96:99], v[200:203]
    s_add_u32 s35, s35, 11456
    v_mfma_f32_16x16x32_bf16 v[204:207], a[48:51], a[100:103], v[204:207]
    buffer_load_dwordx4 v4, s[8:11], s35 offen offset:832 lds
    v_mfma_f32_16x16x32_bf16 v[172:175], a[44:47], a[100:103], v[172:175]
    s_add_u32 s35, s35, 11312
    v_mfma_f32_16x16x32_bf16 v[140:143], a[40:43], a[100:103], v[140:143]
    buffer_load_dwordx4 v4, s[8:11], s35 offen offset:1808 lds
    v_mfma_f32_16x16x32_bf16 v[108:111], a[36:39], a[100:103], v[108:111]
    v_mfma_f32_16x16x32_bf16 v[76:79], a[32:35], a[100:103], v[76:79]
    s_add_u32 s35, s35, 11456
    v_mfma_f32_16x16x32_bf16 v[44:47], a[28:31], a[100:103], v[44:47]
    buffer_load_dwordx4 v4, s[8:11], s35 offen offset:2640 lds
    v_mfma_f32_16x16x32_bf16 v[48:51], a[28:31], a[104:107], v[48:51]
    s_mov_b64 exec, -1
    s_add_u32 s35, s35, 162384
    v_mfma_f32_16x16x32_bf16 v[80:83], a[32:35], a[104:107], v[80:83]
    ds_read_b64_tr_b16 a[16:17], v9 offset:128
    v_mfma_f32_16x16x32_bf16 v[112:115], a[36:39], a[104:107], v[112:115]
    ds_read_b64_tr_b16 a[18:19], v9 offset:1936
    v_mfma_f32_16x16x32_bf16 v[144:147], a[40:43], a[104:107], v[144:147]
    s_add_u32 m0, s32, s42
    v_mfma_f32_16x16x32_bf16 v[176:179], a[44:47], a[104:107], v[176:179]
    v_mfma_f32_16x16x32_bf16 v[208:211], a[48:51], a[104:107], v[208:211]
    s_add_u32 s40, s36, 65536
    v_mfma_f32_16x16x32_bf16 v[212:215], a[48:51], a[108:111], v[212:215]
    buffer_load_dwordx4 v2, s[4:7], s40 offen offset:0 lds
    v_mfma_f32_16x16x32_bf16 v[180:183], a[44:47], a[108:111], v[180:183]
    ds_read_b128 a[72:75], v8 offset:8192
    v_mfma_f32_16x16x32_bf16 v[148:151], a[40:43], a[108:111], v[148:151]
    ds_read_b64_tr_b16 a[20:21], v9 offset:160
    v_mfma_f32_16x16x32_bf16 v[116:119], a[36:39], a[108:111], v[116:119]
    buffer_load_dwordx4 v3, s[4:7], s40 offen offset:1024 lds
    v_mfma_f32_16x16x32_bf16 v[84:87], a[32:35], a[108:111], v[84:87]
    ds_read_b64_tr_b16 a[22:23], v9 offset:1968
    v_mfma_f32_16x16x32_bf16 v[52:55], a[28:31], a[108:111], v[52:55]
    v_mfma_f32_16x16x32_bf16 v[56:59], a[28:31], a[112:115], v[56:59]
    ds_read_b128 a[76:79], v8 offset:10240
    v_mfma_f32_16x16x32_bf16 v[88:91], a[32:35], a[112:115], v[88:91]
    s_add_u32 s40, s40, 30720
    v_mfma_f32_16x16x32_bf16 v[120:123], a[36:39], a[112:115], v[120:123]
    buffer_load_dwordx4 v2, s[4:7], s40 offen offset:2048 lds
    v_mfma_f32_16x16x32_bf16 v[152:155], a[40:43], a[112:115], v[152:155]
    ds_read_b128 a[80:83], v8 offset:12288
    v_mfma_f32_16x16x32_bf16 v[184:187], a[44:47], a[112:115], v[184:187]
    ds_read_b128 a[84:87], v8 offset:14336
    v_mfma_f32_16x16x32_bf16 v[216:219], a[48:51], a[112:115], v[216:219]
    buffer_load_dwordx4 v3, s[4:7], s40 offen offset:3072 lds
    v_mfma_f32_16x16x32_bf16 v[220:223], a[48:51], a[116:119], v[220:223]
    v_mfma_f32_16x16x32_bf16 v[188:191], a[44:47], a[116:119], v[188:191]
    s_mov_b32 s40, s30
    s_mov_b32 s30, s31
    v_mfma_f32_16x16x32_bf16 v[156:159], a[40:43], a[116:119], v[156:159]
    s_mov_b32 s31, s32
    s_mov_b32 s32, s40
    v_mfma_f32_16x16x32_bf16 v[124:127], a[36:39], a[116:119], v[124:127]
    s_xor_b32 s33, s33, 28928
    s_xor_b32 s34, s34, 28928
    v_mfma_f32_16x16x32_bf16 v[92:95], a[32:35], a[116:119], v[92:95]
    s_add_u32 s36, s36, 128
    s_add_u32 s37, s37, 1
    v_mfma_f32_16x16x32_bf16 v[60:63], a[28:31], a[116:119], v[60:63]
    v_add_u32 v8, s30, v6
    v_mfma_f32_16x16x32_bf16 a[132:135], a[40:43], a[148:151], a[132:135]
    v_add_u32 v9, s33, v7
    v_mfma_f32_16x16x32_bf16 a[136:139], a[44:47], a[148:151], a[136:139]
    v_mfma_f32_16x16x32_bf16 a[140:143], a[48:51], a[148:151], a[140:143]
    s_cmp_lt_u32 s37, 16
    s_cbranch_scc1 P1_loopQ1
P1_endQ:
    v_lshrrev_b32 v10, 4, v1
    v_lshlrev_b32 v10, 4, v10
    s_mul_i32 s40, s20, 384
    s_add_u32 s40, s40, 156160
    v_add_u32 v10, s40, v10
    s_cbranch_vccnz P1_o1Q
    v_accvgpr_read_b32 v240, a120
    v_accvgpr_read_b32 v241, a121
    v_accvgpr_read_b32 v242, a122
    v_accvgpr_read_b32 v243, a123
    ds_write_b128 v10, v[240:243] offset:0
    v_accvgpr_read_b32 v244, a124
    v_accvgpr_read_b32 v245, a125
    v_accvgpr_read_b32 v246, a126
    v_accvgpr_read_b32 v247, a127
    ds_write_b128 v10, v[244:247] offset:64
    v_accvgpr_read_b32 v248, a128
    v_accvgpr_read_b32 v249, a129
    v_accvgpr_read_b32 v250, a130
    v_accvgpr_read_b32 v251, a131
    ds_write_b128 v10, v[248:251] offset:128
    s_branch P1_o2Q
P1_o1Q:
    v_accvgpr_read_b32 v252, a132
    v_accvgpr_read_b32 v253, a133
    v_accvgpr_read_b32 v254, a134
    v_accvgpr_read_b32 v255, a135
    ds_write_b128 v10, v[252:255] offset:192
    v_accvgpr_read_b32 v240, a136
    v_accvgpr_read_b32 v241, a137
    v_accvgpr_read_b32 v242, a138
    v_accvgpr_read_b32 v243, a139
    ds_write_b128 v10, v[240:243] offset:256
    v_accvgpr_read_b32 v244, a140
    v_accvgpr_read_b32 v245, a141
    v_accvgpr_read_b32 v246, a142
    v_accvgpr_read_b32 v247, a143
    ds_write_b128 v10, v[244:247] offset:320
P1_o2Q:
    s_waitcnt vmcnt(0)
    v_lshrrev_b32 v8, 4, v1
    v_and_b32 v9, 15, v1
    v_lshlrev_b32 v6, 4, v1
    s_lshl_b32 s40, s100, 2
    s_add_u32 s40, s40, s18
    s_mul_i32 s40, s40, 589824
    v_add_u32 v2, s40, v6
    v_add_u32 v3, 147456, v2
    v_lshlrev_b32 v4, 14, v8
    v_lshl_add_u32 v4, v9, 4, v4
    s_lshl_b32 s40, s18, 12
    s_lshl_b32 s41, s101, 8
    s_add_u32 s40, s40, s41
    v_add_u32 v4, s40, v4
    s_xor_b32 s41, s23, 1
    s_lshl_b32 s41, s41, 7
    v_xor_b32 v4, s41, v4
    v_and_b32 v5, 1, v8
    v_lshrrev_b32 v9, 2, v9
    v_lshl_add_u32 v5, v5, 2, v9
    v_mul_u32_u24 v7, 1056, v5
    v_lshrrev_b32 v5, 1, v8
    v_lshl_add_u32 v7, v5, 8, v7
    v_and_b32 v5, 3, v1
    v_lshl_add_u32 v7, v5, 3, v7
    v_add_u32 v5, 992, v4
    s_mul_i32 s39, s18, 2112
    s_mov_b32 s86, 0
    s_mov_b32 s8, s60
    s_and_b32 s9, s61, 0xffff
    s_mov_b32 s10, 7340032
    s_mov_b32 s11, 0x20000
    s_add_u32 s4, s66, 4194304
    s_addc_u32 s5, s67, 0
    s_and_b32 s5, s5, 0xffff
    s_mov_b32 s6, 18874368
    s_mov_b32 s7, 0x20000
    s_cmp_eq_u32 s23, 0
    s_cselect_b32 s35, 1441792, 0
    s_cselect_b32 s36, 38912, 0
    s_cselect_b32 s29, 13, 15
    s_mul_i32 s27, s3, 3670016
    s_add_u32 s35, s35, s27
    s_lshl_b32 s40, s3, 14
    s_add_u32 s36, s36, s40
    s_mov_b32 s30, 262144
    s_mov_b32 s31, 458752
    s_lshl_b32 s24, s21, 8
    s_lshl_b32 s25, s100, 8
    s_mov_b32 s47, 35088
    s_cmp_eq_u32 s23, 0
    s_cselect_b32 s47, 6160, s47
    s_waitcnt lgkmcnt(0)
    s_barrier
    v_mov_b32 v0, v10
    ds_read_b128 v[248:251], v0 offset:256
    ds_read_b128 v[252:255], v0 offset:320
    v_lshrrev_b32 v8, 2, v1
    v_and_b32 v9, 3, v1
    v_lshlrev_b32 v8, 6, v8
    v_lshl_add_u32 v8, v9, 3, v8
    s_lshl_b32 s40, s20, 11
    s_add_u32 s40, s40, 158208
    v_add_u32 v8, s40, v8
    ds_read_b64_tr_b16 v[240:241], v8 offset:0
    ds_read_b64_tr_b16 v[242:243], v8 offset:1024
    ds_read_b64_tr_b16 v[244:245], v8 offset:32
    ds_read_b64_tr_b16 v[246:247], v8 offset:1056
    s_mov_b32 s42, 1069066811
    s_mov_b32 s43, 3216550459
    v_and_b32 v28, 15, v1
    v_lshrrev_b32 v29, 4, v1
    s_lshl_b32 s40, s19, 7
    v_add_u32 v30, s40, v28
    v_mul_u32_u24 v31, 72, v30
    v_mul_u32_u24 v30, 136, v30
    v_lshl_add_u32 v30, v29, 3, v30
    v_lshl_add_u32 v31, v29, 3, v31
    s_mul_i32 s40, s20, 34816
    v_add_u32 v30, s40, v30
    s_mul_i32 s40, s20, 18432
    s_add_u32 s40, s40, 69632
    v_add_u32 v31, s40, v31
    s_waitcnt lgkmcnt(0)
    v_pk_mul_f32 v[8:9], v[248:249], v[12:13] op_sel:[0,0] op_sel_hi:[1,0] neg_lo:[0,1] neg_hi:[0,1]
    v_pk_mul_f32 v[10:11], v[250:251], v[12:13] op_sel:[0,0] op_sel_hi:[1,0] neg_lo:[0,1] neg_hi:[0,1]
    v_pk_fma_f32 v[160:161], v[160:161], v[12:13], v[8:9] op_sel:[0,1,0] op_sel_hi:[1,1,1]
    v_pk_fma_f32 v[162:163], v[162:163], v[12:13], v[10:11] op_sel:[0,1,0] op_sel_hi:[1,1,1]
    v_cvt_pk_bf16_f32 v224, v160, v161
    v_cvt_pk_bf16_f32 v225, v162, v163
    ds_write_b64 v31, v[224:225] offset:0
    v_pk_mul_f32 v[8:9], v[252:253], v[12:13] op_sel:[0,0] op_sel_hi:[1,0] neg_lo:[0,1] neg_hi:[0,1]
    v_pk_mul_f32 v[10:11], v[254:255], v[12:13] op_sel:[0,0] op_sel_hi:[1,0] neg_lo:[0,1] neg_hi:[0,1]
    v_pk_fma_f32 v[192:193], v[192:193], v[12:13], v[8:9] op_sel:[0,1,0] op_sel_hi:[1,1,1]
    v_pk_fma_f32 v[194:195], v[194:195], v[12:13], v[10:11] op_sel:[0,1,0] op_sel_hi:[1,1,1]
    v_cvt_pk_bf16_f32 v226, v192, v193
    v_cvt_pk_bf16_f32 v227, v194, v195
    ds_write_b64 v31, v[226:227] offset:32
    v_pk_mul_f32 v[8:9], v[248:249], v[14:15] op_sel:[0,0] op_sel_hi:[1,0] neg_lo:[0,1] neg_hi:[0,1]
    v_pk_mul_f32 v[10:11], v[250:251], v[14:15] op_sel:[0,0] op_sel_hi:[1,0] neg_lo:[0,1] neg_hi:[0,1]
    v_pk_fma_f32 v[164:165], v[164:165], v[14:15], v[8:9] op_sel:[0,1,0] op_sel_hi:[1,1,1]
    v_pk_fma_f32 v[166:167], v[166:167], v[14:15], v[10:11] op_sel:[0,1,0] op_sel_hi:[1,1,1]
    v_cvt_pk_bf16_f32 v228, v164, v165
    v_cvt_pk_bf16_f32 v229, v166, v167
    ds_write_b64 v31, v[228:229] offset:1152
    v_pk_mul_f32 v[8:9], v[252:253], v[14:15] op_sel:[0,0] op_sel_hi:[1,0] neg_lo:[0,1] neg_hi:[0,1]
    v_pk_mul_f32 v[10:11], v[254:255], v[14:15] op_sel:[0,0] op_sel_hi:[1,0] neg_lo:[0,1] neg_hi:[0,1]
    v_pk_fma_f32 v[196:197], v[196:197], v[14:15], v[8:9] op_sel:[0,1,0] op_sel_hi:[1,1,1]
    v_pk_fma_f32 v[198:199], v[198:199], v[14:15], v[10:11] op_sel:[0,1,0] op_sel_hi:[1,1,1]
    v_cvt_pk_bf16_f32 v230, v196, v197
    v_cvt_pk_bf16_f32 v231, v198, v199
    ds_write_b64 v31, v[230:231] offset:1184
    v_pk_mul_f32 v[8:9], v[248:249], v[16:17] op_sel:[0,0] op_sel_hi:[1,0] neg_lo:[0,1] neg_hi:[0,1]
    v_pk_mul_f32 v[10:11], v[250:251], v[16:17] op_sel:[0,0] op_sel_hi:[1,0] neg_lo:[0,1] neg_hi:[0,1]
    v_pk_fma_f32 v[168:169], v[168:169], v[16:17], v[8:9] op_sel:[0,1,0] op_sel_hi:[1,1,1]
    v_pk_fma_f32 v[170:171], v[170:171], v[16:17], v[10:11] op_sel:[0,1,0] op_sel_hi:[1,1,1]
    v_cvt_pk_bf16_f32 v232, v168, v169
    v_cvt_pk_bf16_f32 v233, v170, v171
    ds_write_b64 v31, v[232:233] offset:2304
    v_pk_mul_f32 v[8:9], v[252:253], v[16:17] op_sel:[0,0] op_sel_hi:[1,0] neg_lo:[0,1] neg_hi:[0,1]
    v_pk_mul_f32 v[10:11], v[254:255], v[16:17] op_sel:[0,0] op_sel_hi:[1,0] neg_lo:[0,1] neg_hi:[0,1]
    v_pk_fma_f32 v[200:201], v[200:201], v[16:17], v[8:9] op_sel:[0,1,0] op_sel_hi:[1,1,1]
    v_pk_fma_f32 v[202:203], v[202:203], v[16:17], v[10:11] op_sel:[0,1,0] op_sel_hi:[1,1,1]
    v_cvt_pk_bf16_f32 v234, v200, v201
    v_cvt_pk_bf16_f32 v235, v202, v203
    ds_write_b64 v31, v[234:235] offset:2336
    v_pk_mul_f32 v[8:9], v[248:249], v[18:19] op_sel:[0,0] op_sel_hi:[1,0] neg_lo:[0,1] neg_hi:[0,1]
    v_pk_mul_f32 v[10:11], v[250:251], v[18:19] op_sel:[0,0] op_sel_hi:[1,0] neg_lo:[0,1] neg_hi:[0,1]
    v_pk_fma_f32 v[172:173], v[172:173], v[18:19], v[8:9] op_sel:[0,1,0] op_sel_hi:[1,1,1]
    v_pk_fma_f32 v[174:175], v[174:175], v[18:19], v[10:11] op_sel:[0,1,0] op_sel_hi:[1,1,1]
    v_cvt_pk_bf16_f32 v236, v172, v173
    v_cvt_pk_bf16_f32 v237, v174, v175
    ds_write_b64 v31, v[236:237] offset:3456
    v_pk_mul_f32 v[8:9], v[252:253], v[18:19] op_sel:[0,0] op_sel_hi:[1,0] neg_lo:[0,1] neg_hi:[0,1]
    v_pk_mul_f32 v[10:11], v[254:255], v[18:19] op_sel:[0,0] op_sel_hi:[1,0] neg_lo:[0,1] neg_hi:[0,1]
    v_pk_fma_f32 v[204:205], v[204:205], v[18:19], v[8:9] op_sel:[0,1,0] op_sel_hi:[1,1,1]
    v_pk_fma_f32 v[206:207], v[206:207], v[18:19], v[10:11] op_sel:[0,1,0] op_sel_hi:[1,1,1]
    v_cvt_pk_bf16_f32 v238, v204, v205
    v_cvt_pk_bf16_f32 v239, v206, v207
    ds_write_b64 v31, v[238:239] offset:3488
    v_pk_mul_f32 v[8:9], v[248:249], v[20:21] op_sel:[0,0] op_sel_hi:[1,0] neg_lo:[0,1] neg_hi:[0,1]
    v_pk_mul_f32 v[10:11], v[250:251], v[20:21] op_sel:[0,0] op_sel_hi:[1,0] neg_lo:[0,1] neg_hi:[0,1]
    v_pk_fma_f32 v[176:177], v[176:177], v[20:21], v[8:9] op_sel:[0,1,0] op_sel_hi:[1,1,1]
    v_pk_fma_f32 v[178:179], v[178:179], v[20:21], v[10:11] op_sel:[0,1,0] op_sel_hi:[1,1,1]
    v_cvt_pk_bf16_f32 v224, v176, v177
    v_cvt_pk_bf16_f32 v225, v178, v179
    ds_write_b64 v31, v[224:225] offset:4608
    v_pk_mul_f32 v[8:9], v[252:253], v[20:21] op_sel:[0,0] op_sel_hi:[1,0] neg_lo:[0,1] neg_hi:[0,1]
    v_pk_mul_f32 v[10:11], v[254:255], v[20:21] op_sel:[0,0] op_sel_hi:[1,0] neg_lo:[0,1] neg_hi:[0,1]
    v_pk_fma_f32 v[208:209], v[208:209], v[20:21], v[8:9] op_sel:[0,1,0] op_sel_hi:[1,1,1]
    v_pk_fma_f32 v[210:211], v[210:211], v[20:21], v[10:11] op_sel:[0,1,0] op_sel_hi:[1,1,1]
    v_cvt_pk_bf16_f32 v226, v208, v209
    v_cvt_pk_bf16_f32 v227, v210, v211
    ds_write_b64 v31, v[226:227] offset:4640
    v_pk_mul_f32 v[8:9], v[248:249], v[22:23] op_sel:[0,0] op_sel_hi:[1,0] neg_lo:[0,1] neg_hi:[0,1]
    v_pk_mul_f32 v[10:11], v[250:251], v[22:23] op_sel:[0,0] op_sel_hi:[1,0] neg_lo:[0,1] neg_hi:[0,1]
    v_pk_fma_f32 v[180:181], v[180:181], v[22:23], v[8:9] op_sel:[0,1,0] op_sel_hi:[1,1,1]
    v_pk_fma_f32 v[182:183], v[182:183], v[22:23], v[10:11] op_sel:[0,1,0] op_sel_hi:[1,1,1]
    v_cvt_pk_bf16_f32 v228, v180, v181
    v_cvt_pk_bf16_f32 v229, v182, v183
    ds_write_b64 v31, v[228:229] offset:5760
    v_pk_mul_f32 v[8:9], v[252:253], v[22:23] op_sel:[0,0] op_sel_hi:[1,0] neg_lo:[0,1] neg_hi:[0,1]
    v_pk_mul_f32 v[10:11], v[254:255], v[22:23] op_sel:[0,0] op_sel_hi:[1,0] neg_lo:[0,1] neg_hi:[0,1]
    v_pk_fma_f32 v[212:213], v[212:213], v[22:23], v[8:9] op_sel:[0,1,0] op_sel_hi:[1,1,1]
    v_pk_fma_f32 v[214:215], v[214:215], v[22:23], v[10:11] op_sel:[0,1,0] op_sel_hi:[1,1,1]
    v_cvt_pk_bf16_f32 v230, v212, v213
    v_cvt_pk_bf16_f32 v231, v214, v215
    ds_write_b64 v31, v[230:231] offset:5792
    v_pk_mul_f32 v[8:9], v[248:249], v[24:25] op_sel:[0,0] op_sel_hi:[1,0] neg_lo:[0,1] neg_hi:[0,1]
    v_pk_mul_f32 v[10:11], v[250:251], v[24:25] op_sel:[0,0] op_sel_hi:[1,0] neg_lo:[0,1] neg_hi:[0,1]
    v_pk_fma_f32 v[184:185], v[184:185], v[24:25], v[8:9] op_sel:[0,1,0] op_sel_hi:[1,1,1]
    v_pk_fma_f32 v[186:187], v[186:187], v[24:25], v[10:11] op_sel:[0,1,0] op_sel_hi:[1,1,1]
    v_cvt_pk_bf16_f32 v232, v184, v185
    v_cvt_pk_bf16_f32 v233, v186, v187
    ds_write_b64 v31, v[232:233] offset:6912
    v_pk_mul_f32 v[8:9], v[252:253], v[24:25] op_sel:[0,0] op_sel_hi:[1,0] neg_lo:[0,1] neg_hi:[0,1]
    v_pk_mul_f32 v[10:11], v[254:255], v[24:25] op_sel:[0,0] op_sel_hi:[1,0] neg_lo:[0,1] neg_hi:[0,1]
    v_pk_fma_f32 v[216:217], v[216:217], v[24:25], v[8:9] op_sel:[0,1,0] op_sel_hi:[1,1,1]
    v_pk_fma_f32 v[218:219], v[218:219], v[24:25], v[10:11] op_sel:[0,1,0] op_sel_hi:[1,1,1]
    v_cvt_pk_bf16_f32 v234, v216, v217
    v_cvt_pk_bf16_f32 v235, v218, v219
    ds_write_b64 v31, v[234:235] offset:6944
    v_pk_mul_f32 v[8:9], v[248:249], v[26:27] op_sel:[0,0] op_sel_hi:[1,0] neg_lo:[0,1] neg_hi:[0,1]
    v_pk_mul_f32 v[10:11], v[250:251], v[26:27] op_sel:[0,0] op_sel_hi:[1,0] neg_lo:[0,1] neg_hi:[0,1]
    v_pk_fma_f32 v[188:189], v[188:189], v[26:27], v[8:9] op_sel:[0,1,0] op_sel_hi:[1,1,1]
    v_pk_fma_f32 v[190:191], v[190:191], v[26:27], v[10:11] op_sel:[0,1,0] op_sel_hi:[1,1,1]
    v_cvt_pk_bf16_f32 v236, v188, v189
    v_cvt_pk_bf16_f32 v237, v190, v191
    ds_write_b64 v31, v[236:237] offset:8064
    v_pk_mul_f32 v[8:9], v[252:253], v[26:27] op_sel:[0,0] op_sel_hi:[1,0] neg_lo:[0,1] neg_hi:[0,1]
    v_pk_mul_f32 v[10:11], v[254:255], v[26:27] op_sel:[0,0] op_sel_hi:[1,0] neg_lo:[0,1] neg_hi:[0,1]
    v_pk_fma_f32 v[220:221], v[220:221], v[26:27], v[8:9] op_sel:[0,1,0] op_sel_hi:[1,1,1]
    v_pk_fma_f32 v[222:223], v[222:223], v[26:27], v[10:11] op_sel:[0,1,0] op_sel_hi:[1,1,1]
    v_cvt_pk_bf16_f32 v238, v220, v221
    v_cvt_pk_bf16_f32 v239, v222, v223
    ds_write_b64 v31, v[238:239] offset:8096
    ds_read_b128 v[248:251], v0 offset:128
    ds_read_b128 v[252:255], v0 offset:192
    s_waitcnt lgkmcnt(0)
    v_pk_mul_f32 v[8:9], v[248:249], v[12:13] op_sel:[0,0] op_sel_hi:[1,0] neg_lo:[0,1] neg_hi:[0,1]
    v_pk_mul_f32 v[10:11], v[250:251], v[12:13] op_sel:[0,0] op_sel_hi:[1,0] neg_lo:[0,1] neg_hi:[0,1]
    v_pk_fma_f32 v[96:97], v[96:97], v[12:13], v[8:9] op_sel:[0,1,0] op_sel_hi:[1,1,1]
    v_pk_fma_f32 v[98:99], v[98:99], v[12:13], v[10:11] op_sel:[0,1,0] op_sel_hi:[1,1,1]
    v_cvt_pk_bf16_f32 v224, v96, v97
    v_cvt_pk_bf16_f32 v225, v98, v99
    v_pk_mul_f32 v[8:9], v[252:253], v[12:13] op_sel:[0,0] op_sel_hi:[1,0] neg_lo:[0,1] neg_hi:[0,1]
    v_pk_mul_f32 v[10:11], v[254:255], v[12:13] op_sel:[0,0] op_sel_hi:[1,0] neg_lo:[0,1] neg_hi:[0,1]
    v_pk_fma_f32 v[128:129], v[128:129], v[12:13], v[8:9] op_sel:[0,1,0] op_sel_hi:[1,1,1]
    v_pk_fma_f32 v[130:131], v[130:131], v[12:13], v[10:11] op_sel:[0,1,0] op_sel_hi:[1,1,1]
    v_cvt_pk_bf16_f32 v226, v128, v129
    v_cvt_pk_bf16_f32 v227, v130, v131
    v_pk_mul_f32 v[8:9], v[248:249], v[14:15] op_sel:[0,0] op_sel_hi:[1,0] neg_lo:[0,1] neg_hi:[0,1]
    v_pk_mul_f32 v[10:11], v[250:251], v[14:15] op_sel:[0,0] op_sel_hi:[1,0] neg_lo:[0,1] neg_hi:[0,1]
    v_pk_fma_f32 v[100:101], v[100:101], v[14:15], v[8:9] op_sel:[0,1,0] op_sel_hi:[1,1,1]
    v_pk_fma_f32 v[102:103], v[102:103], v[14:15], v[10:11] op_sel:[0,1,0] op_sel_hi:[1,1,1]
    v_cvt_pk_bf16_f32 v228, v100, v101
    v_cvt_pk_bf16_f32 v229, v102, v103
    v_pk_mul_f32 v[8:9], v[252:253], v[14:15] op_sel:[0,0] op_sel_hi:[1,0] neg_lo:[0,1] neg_hi:[0,1]
    v_pk_mul_f32 v[10:11], v[254:255], v[14:15] op_sel:[0,0] op_sel_hi:[1,0] neg_lo:[0,1] neg_hi:[0,1]
    v_pk_fma_f32 v[132:133], v[132:133], v[14:15], v[8:9] op_sel:[0,1,0] op_sel_hi:[1,1,1]
    v_pk_fma_f32 v[134:135], v[134:135], v[14:15], v[10:11] op_sel:[0,1,0] op_sel_hi:[1,1,1]
    v_cvt_pk_bf16_f32 v230, v132, v133
    v_cvt_pk_bf16_f32 v231, v134, v135
    v_pk_mul_f32 v[8:9], v[248:249], v[16:17] op_sel:[0,0] op_sel_hi:[1,0] neg_lo:[0,1] neg_hi:[0,1]
    v_pk_mul_f32 v[10:11], v[250:251], v[16:17] op_sel:[0,0] op_sel_hi:[1,0] neg_lo:[0,1] neg_hi:[0,1]
    v_pk_fma_f32 v[104:105], v[104:105], v[16:17], v[8:9] op_sel:[0,1,0] op_sel_hi:[1,1,1]
    v_pk_fma_f32 v[106:107], v[106:107], v[16:17], v[10:11] op_sel:[0,1,0] op_sel_hi:[1,1,1]
    v_cvt_pk_bf16_f32 v232, v104, v105
    v_cvt_pk_bf16_f32 v233, v106, v107
    v_pk_mul_f32 v[8:9], v[252:253], v[16:17] op_sel:[0,0] op_sel_hi:[1,0] neg_lo:[0,1] neg_hi:[0,1]
    v_pk_mul_f32 v[10:11], v[254:255], v[16:17] op_sel:[0,0] op_sel_hi:[1,0] neg_lo:[0,1] neg_hi:[0,1]
    v_pk_fma_f32 v[136:137], v[136:137], v[16:17], v[8:9] op_sel:[0,1,0] op_sel_hi:[1,1,1]
    v_pk_fma_f32 v[138:139], v[138:139], v[16:17], v[10:11] op_sel:[0,1,0] op_sel_hi:[1,1,1]
    v_cvt_pk_bf16_f32 v234, v136, v137
    v_cvt_pk_bf16_f32 v235, v138, v139
    v_pk_mul_f32 v[8:9], v[248:249], v[18:19] op_sel:[0,0] op_sel_hi:[1,0] neg_lo:[0,1] neg_hi:[0,1]
    v_pk_mul_f32 v[10:11], v[250:251], v[18:19] op_sel:[0,0] op_sel_hi:[1,0] neg_lo:[0,1] neg_hi:[0,1]
    v_pk_fma_f32 v[108:109], v[108:109], v[18:19], v[8:9] op_sel:[0,1,0] op_sel_hi:[1,1,1]
    v_pk_fma_f32 v[110:111], v[110:111], v[18:19], v[10:11] op_sel:[0,1,0] op_sel_hi:[1,1,1]
    v_cvt_pk_bf16_f32 v236, v108, v109
    v_cvt_pk_bf16_f32 v237, v110, v111
    v_pk_mul_f32 v[8:9], v[252:253], v[18:19] op_sel:[0,0] op_sel_hi:[1,0] neg_lo:[0,1] neg_hi:[0,1]
    v_pk_mul_f32 v[10:11], v[254:255], v[18:19] op_sel:[0,0] op_sel_hi:[1,0] neg_lo:[0,1] neg_hi:[0,1]
    v_pk_fma_f32 v[140:141], v[140:141], v[18:19], v[8:9] op_sel:[0,1,0] op_sel_hi:[1,1,1]
    v_pk_fma_f32 v[142:143], v[142:143], v[18:19], v[10:11] op_sel:[0,1,0] op_sel_hi:[1,1,1]
    v_cvt_pk_bf16_f32 v238, v140, v141
    v_cvt_pk_bf16_f32 v239, v142, v143
    v_mfma_f32_16x16x32_bf16 v[160:163], v[240:243], v[224:227], 0
    v_mfma_f32_16x16x32_bf16 v[164:167], v[244:247], v[224:227], 0
    v_mfma_f32_16x16x32_bf16 v[176:179], v[240:243], v[228:231], 0
    v_mfma_f32_16x16x32_bf16 v[180:183], v[244:247], v[228:231], 0
    v_mfma_f32_16x16x32_bf16 v[192:195], v[240:243], v[232:235], 0
    v_mfma_f32_16x16x32_bf16 v[196:199], v[244:247], v[232:235], 0
    v_mfma_f32_16x16x32_bf16 v[208:211], v[240:243], v[236:239], 0
    v_mfma_f32_16x16x32_bf16 v[212:215], v[244:247], v[236:239], 0
    s_nop 0
    v_max3_f32 v224, v160, v161, v162
    v_max3_f32 v225, -v160, -v161, -v162
    v_max3_f32 v228, v176, v177, v178
    v_max3_f32 v229, -v176, -v177, -v178
    v_max3_f32 v232, v192, v193, v194
    v_max3_f32 v233, -v192, -v193, -v194
    v_max3_f32 v236, v208, v209, v210
    v_max3_f32 v237, -v208, -v209, -v210
    v_max3_f32 v224, v224, v163, v164
    v_max3_f32 v225, v225, -v163, -v164
    v_max3_f32 v228, v228, v179, v180
    v_max3_f32 v229, v229, -v179, -v180
    v_max3_f32 v232, v232, v195, v196
    v_max3_f32 v233, v233, -v195, -v196
    v_max3_f32 v236, v236, v211, v212
    v_max3_f32 v237, v237, -v211, -v212
    v_max3_f32 v224, v224, v165, v166
    v_max3_f32 v225, v225, -v165, -v166
    v_max3_f32 v228, v228, v181, v182
    v_max3_f32 v229, v229, -v181, -v182
    v_max3_f32 v232, v232, v197, v198
    v_max3_f32 v233, v233, -v197, -v198
    v_max3_f32 v236, v236, v213, v214
    v_max3_f32 v237, v237, -v213, -v214
    v_max_f32 v224, v224, v167
    v_max_f32_e64 v225, v225, -v167
    v_max_f32 v228, v228, v183
    v_max_f32_e64 v229, v229, -v183
    v_max_f32 v232, v232, v199
    v_max_f32_e64 v233, v233, -v199
    v_max_f32 v236, v236, v215
    v_max_f32_e64 v237, v237, -v215
    v_permlane32_swap_b32 v224, v225
    v_permlane32_swap_b32 v228, v229
    v_permlane32_swap_b32 v232, v233
    v_permlane32_swap_b32 v236, v237
    v_max_f32 v224, v224, v225
    v_max_f32 v228, v228, v229
    v_max_f32 v232, v232, v233
    v_max_f32 v236, v236, v237
    v_mov_b32 v225, v224
    v_mov_b32 v229, v228
    v_mov_b32 v233, v232
    v_mov_b32 v237, v236
    v_permlane16_swap_b32 v224, v225
    v_permlane16_swap_b32 v228, v229
    v_permlane16_swap_b32 v232, v233
    v_permlane16_swap_b32 v236, v237
    v_max_f32 v224, v224, v225
    v_max_f32 v228, v228, v229
    v_max_f32 v232, v232, v233
    v_max_f32 v236, v236, v237
    v_mov_b32 v226, v224
    v_mov_b32 v230, v228
    v_mov_b32 v234, v232
    v_mov_b32 v238, v236
    v_permlane32_swap_b32 v224, v226
    v_permlane32_swap_b32 v228, v230
    v_permlane32_swap_b32 v232, v234
    v_permlane32_swap_b32 v236, v238
    v_mul_f32 v224, s43, v224
    v_mul_f32 v226, s43, v226
    v_mul_f32 v228, s43, v228
    v_mul_f32 v230, s43, v230
    v_mul_f32 v232, s43, v232
    v_mul_f32 v234, s43, v234
    v_mul_f32 v236, s43, v236
    v_mul_f32 v238, s43, v238
    v_pk_fma_f32 v[168:169], v[160:161], s[42:43], v[226:227] op_sel:[0,1,0] op_sel_hi:[1,1,0]
    v_pk_fma_f32 v[170:171], v[162:163], s[42:43], v[226:227] op_sel:[0,1,0] op_sel_hi:[1,1,0]
    v_pk_fma_f32 v[172:173], v[164:165], s[42:43], v[226:227] op_sel:[0,1,0] op_sel_hi:[1,1,0]
    v_pk_fma_f32 v[174:175], v[166:167], s[42:43], v[226:227] op_sel:[0,1,0] op_sel_hi:[1,1,0]
    v_pk_fma_f32 v[160:161], v[160:161], s[42:43], v[224:225] op_sel:[0,0,0] op_sel_hi:[1,0,0]
    v_pk_fma_f32 v[162:163], v[162:163], s[42:43], v[224:225] op_sel:[0,0,0] op_sel_hi:[1,0,0]
    v_pk_fma_f32 v[164:165], v[164:165], s[42:43], v[224:225] op_sel:[0,0,0] op_sel_hi:[1,0,0]
    v_pk_fma_f32 v[166:167], v[166:167], s[42:43], v[224:225] op_sel:[0,0,0] op_sel_hi:[1,0,0]
    v_pk_fma_f32 v[184:185], v[176:177], s[42:43], v[230:231] op_sel:[0,1,0] op_sel_hi:[1,1,0]
    v_pk_fma_f32 v[186:187], v[178:179], s[42:43], v[230:231] op_sel:[0,1,0] op_sel_hi:[1,1,0]
    v_pk_fma_f32 v[188:189], v[180:181], s[42:43], v[230:231] op_sel:[0,1,0] op_sel_hi:[1,1,0]
    v_pk_fma_f32 v[190:191], v[182:183], s[42:43], v[230:231] op_sel:[0,1,0] op_sel_hi:[1,1,0]
    v_pk_fma_f32 v[176:177], v[176:177], s[42:43], v[228:229] op_sel:[0,0,0] op_sel_hi:[1,0,0]
    v_pk_fma_f32 v[178:179], v[178:179], s[42:43], v[228:229] op_sel:[0,0,0] op_sel_hi:[1,0,0]
    v_pk_fma_f32 v[180:181], v[180:181], s[42:43], v[228:229] op_sel:[0,0,0] op_sel_hi:[1,0,0]
    v_pk_fma_f32 v[182:183], v[182:183], s[42:43], v[228:229] op_sel:[0,0,0] op_sel_hi:[1,0,0]
    v_pk_fma_f32 v[200:201], v[192:193], s[42:43], v[234:235] op_sel:[0,1,0] op_sel_hi:[1,1,0]
    v_pk_fma_f32 v[202:203], v[194:195], s[42:43], v[234:235] op_sel:[0,1,0] op_sel_hi:[1,1,0]
    v_pk_fma_f32 v[204:205], v[196:197], s[42:43], v[234:235] op_sel:[0,1,0] op_sel_hi:[1,1,0]
    v_pk_fma_f32 v[206:207], v[198:199], s[42:43], v[234:235] op_sel:[0,1,0] op_sel_hi:[1,1,0]
    v_pk_fma_f32 v[192:193], v[192:193], s[42:43], v[232:233] op_sel:[0,0,0] op_sel_hi:[1,0,0]
    v_pk_fma_f32 v[194:195], v[194:195], s[42:43], v[232:233] op_sel:[0,0,0] op_sel_hi:[1,0,0]
    v_pk_fma_f32 v[196:197], v[196:197], s[42:43], v[232:233] op_sel:[0,0,0] op_sel_hi:[1,0,0]
    v_pk_fma_f32 v[198:199], v[198:199], s[42:43], v[232:233] op_sel:[0,0,0] op_sel_hi:[1,0,0]
    v_pk_fma_f32 v[216:217], v[208:209], s[42:43], v[238:239] op_sel:[0,1,0] op_sel_hi:[1,1,0]
    v_pk_fma_f32 v[218:219], v[210:211], s[42:43], v[238:239] op_sel:[0,1,0] op_sel_hi:[1,1,0]
    v_pk_fma_f32 v[220:221], v[212:213], s[42:43], v[238:239] op_sel:[0,1,0] op_sel_hi:[1,1,0]
    v_pk_fma_f32 v[222:223], v[214:215], s[42:43], v[238:239] op_sel:[0,1,0] op_sel_hi:[1,1,0]
    v_pk_fma_f32 v[208:209], v[208:209], s[42:43], v[236:237] op_sel:[0,0,0] op_sel_hi:[1,0,0]
    v_pk_fma_f32 v[210:211], v[210:211], s[42:43], v[236:237] op_sel:[0,0,0] op_sel_hi:[1,0,0]
    v_pk_fma_f32 v[212:213], v[212:213], s[42:43], v[236:237] op_sel:[0,0,0] op_sel_hi:[1,0,0]
    v_pk_fma_f32 v[214:215], v[214:215], s[42:43], v[236:237] op_sel:[0,0,0] op_sel_hi:[1,0,0]
    v_exp_f32 v160, v160
    v_exp_f32 v161, v161
    v_exp_f32 v162, v162
    v_exp_f32 v163, v163
    v_exp_f32 v164, v164
    v_exp_f32 v165, v165
    v_exp_f32 v166, v166
    v_exp_f32 v167, v167
    v_exp_f32 v168, v168
    v_exp_f32 v169, v169
    v_exp_f32 v170, v170
    v_exp_f32 v171, v171
    v_exp_f32 v172, v172
    v_exp_f32 v173, v173
    v_exp_f32 v174, v174
    v_exp_f32 v175, v175
    v_exp_f32 v176, v176
    v_exp_f32 v177, v177
    v_exp_f32 v178, v178
    v_exp_f32 v179, v179
    v_exp_f32 v180, v180
    v_exp_f32 v181, v181
    v_exp_f32 v182, v182
    v_exp_f32 v183, v183
    v_exp_f32 v184, v184
    v_exp_f32 v185, v185
    v_exp_f32 v186, v186
    v_exp_f32 v187, v187
    v_exp_f32 v188, v188
    v_exp_f32 v189, v189
    v_exp_f32 v190, v190
    v_exp_f32 v191, v191
    v_exp_f32 v192, v192
    v_exp_f32 v193, v193
    v_exp_f32 v194, v194
    v_exp_f32 v195, v195
    v_exp_f32 v196, v196
    v_exp_f32 v197, v197
    v_exp_f32 v198, v198
    v_exp_f32 v199, v199
    v_exp_f32 v200, v200
    v_exp_f32 v201, v201
    v_exp_f32 v202, v202
    v_exp_f32 v203, v203
    v_exp_f32 v204, v204
    v_exp_f32 v205, v205
    v_exp_f32 v206, v206
    v_exp_f32 v207, v207
    v_exp_f32 v208, v208
    v_exp_f32 v209, v209
    v_exp_f32 v210, v210
    v_exp_f32 v211, v211
    v_exp_f32 v212, v212
    v_exp_f32 v213, v213
    v_exp_f32 v214, v214
    v_exp_f32 v215, v215
    v_exp_f32 v216, v216
    v_exp_f32 v217, v217
    v_exp_f32 v218, v218
    v_exp_f32 v219, v219
    v_exp_f32 v220, v220
    v_exp_f32 v221, v221
    v_exp_f32 v222, v222
    v_exp_f32 v223, v223
    v_pk_add_f32 v[224:225], v[160:161], v[162:163] op_sel:[0,0] op_sel_hi:[1,1]
    v_pk_add_f32 v[226:227], v[168:169], v[170:171] op_sel:[0,0] op_sel_hi:[1,1]
    v_pk_add_f32 v[228:229], v[176:177], v[178:179] op_sel:[0,0] op_sel_hi:[1,1]
    v_pk_add_f32 v[230:231], v[184:185], v[186:187] op_sel:[0,0] op_sel_hi:[1,1]
    v_pk_add_f32 v[232:233], v[192:193], v[194:195] op_sel:[0,0] op_sel_hi:[1,1]
    v_pk_add_f32 v[234:235], v[200:201], v[202:203] op_sel:[0,0] op_sel_hi:[1,1]
    v_pk_add_f32 v[236:237], v[208:209], v[210:211] op_sel:[0,0] op_sel_hi:[1,1]
    v_pk_add_f32 v[238:239], v[216:217], v[218:219] op_sel:[0,0] op_sel_hi:[1,1]
    v_pk_add_f32 v[224:225], v[224:225], v[164:165] op_sel:[0,0] op_sel_hi:[1,1]
    v_pk_add_f32 v[226:227], v[226:227], v[172:173] op_sel:[0,0] op_sel_hi:[1,1]
    v_pk_add_f32 v[228:229], v[228:229], v[180:181] op_sel:[0,0] op_sel_hi:[1,1]
    v_pk_add_f32 v[230:231], v[230:231], v[188:189] op_sel:[0,0] op_sel_hi:[1,1]
    v_pk_add_f32 v[232:233], v[232:233], v[196:197] op_sel:[0,0] op_sel_hi:[1,1]
    v_pk_add_f32 v[234:235], v[234:235], v[204:205] op_sel:[0,0] op_sel_hi:[1,1]
    v_pk_add_f32 v[236:237], v[236:237], v[212:213] op_sel:[0,0] op_sel_hi:[1,1]
    v_pk_add_f32 v[238:239], v[238:239], v[220:221] op_sel:[0,0] op_sel_hi:[1,1]
    v_pk_add_f32 v[224:225], v[224:225], v[166:167] op_sel:[0,0] op_sel_hi:[1,1]
    v_pk_add_f32 v[226:227], v[226:227], v[174:175] op_sel:[0,0] op_sel_hi:[1,1]
    v_pk_add_f32 v[228:229], v[228:229], v[182:183] op_sel:[0,0] op_sel_hi:[1,1]
    v_pk_add_f32 v[230:231], v[230:231], v[190:191] op_sel:[0,0] op_sel_hi:[1,1]
    v_pk_add_f32 v[232:233], v[232:233], v[198:199] op_sel:[0,0] op_sel_hi:[1,1]
    v_pk_add_f32 v[234:235], v[234:235], v[206:207] op_sel:[0,0] op_sel_hi:[1,1]
    v_pk_add_f32 v[236:237], v[236:237], v[214:215] op_sel:[0,0] op_sel_hi:[1,1]
    v_pk_add_f32 v[238:239], v[238:239], v[222:223] op_sel:[0,0] op_sel_hi:[1,1]
    v_add_f32 v224, v224, v225
    v_add_f32 v228, v228, v229
    v_add_f32 v232, v232, v233
    v_add_f32 v236, v236, v237
    v_add_f32 v225, v226, v227
    v_add_f32 v229, v230, v231
    v_add_f32 v233, v234, v235
    v_add_f32 v237, v238, v239
    v_permlane32_swap_b32 v224, v225
    v_permlane32_swap_b32 v228, v229
    v_permlane32_swap_b32 v232, v233
    v_permlane32_swap_b32 v236, v237
    v_add_f32 v224, v224, v225
    v_add_f32 v228, v228, v229
    v_add_f32 v232, v232, v233
    v_add_f32 v236, v236, v237
    v_mov_b32 v225, v224
    v_mov_b32 v229, v228
    v_mov_b32 v233, v232
    v_mov_b32 v237, v236
    v_permlane16_swap_b32 v224, v225
    v_permlane16_swap_b32 v228, v229
    v_permlane16_swap_b32 v232, v233
    v_permlane16_swap_b32 v236, v237
    v_add_f32 v224, v224, v225
    v_add_f32 v228, v228, v229
    v_add_f32 v232, v232, v233
    v_add_f32 v236, v236, v237
    v_mov_b32 v226, v224
    v_mov_b32 v230, v228
    v_mov_b32 v234, v232
    v_mov_b32 v238, v236
    v_permlane32_swap_b32 v224, v226
    v_permlane32_swap_b32 v228, v230
    v_permlane32_swap_b32 v232, v234
    v_permlane32_swap_b32 v236, v238
    v_rcp_f32 v224, v224
    v_rcp_f32 v226, v226
    v_rcp_f32 v228, v228
    v_rcp_f32 v230, v230
    v_rcp_f32 v232, v232
    v_rcp_f32 v234, v234
    v_rcp_f32 v236, v236
    v_rcp_f32 v238, v238
    v_pk_mul_f32 v[160:161], v[160:161], v[224:225] op_sel:[0,0] op_sel_hi:[1,0]
    v_pk_mul_f32 v[162:163], v[162:163], v[224:225] op_sel:[0,0] op_sel_hi:[1,0]
    v_pk_mul_f32 v[164:165], v[164:165], v[224:225] op_sel:[0,0] op_sel_hi:[1,0]
    v_pk_mul_f32 v[166:167], v[166:167], v[224:225] op_sel:[0,0] op_sel_hi:[1,0]
    v_pk_mul_f32 v[168:169], v[168:169], v[226:227] op_sel:[0,0] op_sel_hi:[1,0]
    v_pk_mul_f32 v[170:171], v[170:171], v[226:227] op_sel:[0,0] op_sel_hi:[1,0]
    v_pk_mul_f32 v[172:173], v[172:173], v[226:227] op_sel:[0,0] op_sel_hi:[1,0]
    v_pk_mul_f32 v[174:175], v[174:175], v[226:227] op_sel:[0,0] op_sel_hi:[1,0]
    v_cvt_pk_bf16_f32 v160, v160, v161
    v_cvt_pk_bf16_f32 v161, v162, v163
    v_cvt_pk_bf16_f32 v162, v164, v165
    v_cvt_pk_bf16_f32 v163, v166, v167
    v_cvt_pk_bf16_f32 v168, v168, v169
    v_cvt_pk_bf16_f32 v169, v170, v171
    v_cvt_pk_bf16_f32 v170, v172, v173
    v_cvt_pk_bf16_f32 v171, v174, v175
    v_pk_mul_f32 v[176:177], v[176:177], v[228:229] op_sel:[0,0] op_sel_hi:[1,0]
    v_pk_mul_f32 v[178:179], v[178:179], v[228:229] op_sel:[0,0] op_sel_hi:[1,0]
    v_pk_mul_f32 v[180:181], v[180:181], v[228:229] op_sel:[0,0] op_sel_hi:[1,0]
    v_pk_mul_f32 v[182:183], v[182:183], v[228:229] op_sel:[0,0] op_sel_hi:[1,0]
    v_pk_mul_f32 v[184:185], v[184:185], v[230:231] op_sel:[0,0] op_sel_hi:[1,0]
    v_pk_mul_f32 v[186:187], v[186:187], v[230:231] op_sel:[0,0] op_sel_hi:[1,0]
    v_pk_mul_f32 v[188:189], v[188:189], v[230:231] op_sel:[0,0] op_sel_hi:[1,0]
    v_pk_mul_f32 v[190:191], v[190:191], v[230:231] op_sel:[0,0] op_sel_hi:[1,0]
    v_cvt_pk_bf16_f32 v176, v176, v177
    v_cvt_pk_bf16_f32 v177, v178, v179
    v_cvt_pk_bf16_f32 v178, v180, v181
    v_cvt_pk_bf16_f32 v179, v182, v183
    v_cvt_pk_bf16_f32 v184, v184, v185
    v_cvt_pk_bf16_f32 v185, v186, v187
    v_cvt_pk_bf16_f32 v186, v188, v189
    v_cvt_pk_bf16_f32 v187, v190, v191
    v_pk_mul_f32 v[192:193], v[192:193], v[232:233] op_sel:[0,0] op_sel_hi:[1,0]
    v_pk_mul_f32 v[194:195], v[194:195], v[232:233] op_sel:[0,0] op_sel_hi:[1,0]
    v_pk_mul_f32 v[196:197], v[196:197], v[232:233] op_sel:[0,0] op_sel_hi:[1,0]
    v_pk_mul_f32 v[198:199], v[198:199], v[232:233] op_sel:[0,0] op_sel_hi:[1,0]
    v_pk_mul_f32 v[200:201], v[200:201], v[234:235] op_sel:[0,0] op_sel_hi:[1,0]
    v_pk_mul_f32 v[202:203], v[202:203], v[234:235] op_sel:[0,0] op_sel_hi:[1,0]
    v_pk_mul_f32 v[204:205], v[204:205], v[234:235] op_sel:[0,0] op_sel_hi:[1,0]
    v_pk_mul_f32 v[206:207], v[206:207], v[234:235] op_sel:[0,0] op_sel_hi:[1,0]
    v_cvt_pk_bf16_f32 v192, v192, v193
    v_cvt_pk_bf16_f32 v193, v194, v195
    v_cvt_pk_bf16_f32 v194, v196, v197
    v_cvt_pk_bf16_f32 v195, v198, v199
    v_cvt_pk_bf16_f32 v200, v200, v201
    v_cvt_pk_bf16_f32 v201, v202, v203
    v_cvt_pk_bf16_f32 v202, v204, v205
    v_cvt_pk_bf16_f32 v203, v206, v207
    v_pk_mul_f32 v[208:209], v[208:209], v[236:237] op_sel:[0,0] op_sel_hi:[1,0]
    v_pk_mul_f32 v[210:211], v[210:211], v[236:237] op_sel:[0,0] op_sel_hi:[1,0]
    v_pk_mul_f32 v[212:213], v[212:213], v[236:237] op_sel:[0,0] op_sel_hi:[1,0]
    v_pk_mul_f32 v[214:215], v[214:215], v[236:237] op_sel:[0,0] op_sel_hi:[1,0]
    v_pk_mul_f32 v[216:217], v[216:217], v[238:239] op_sel:[0,0] op_sel_hi:[1,0]
    v_pk_mul_f32 v[218:219], v[218:219], v[238:239] op_sel:[0,0] op_sel_hi:[1,0]
    v_pk_mul_f32 v[220:221], v[220:221], v[238:239] op_sel:[0,0] op_sel_hi:[1,0]
    v_pk_mul_f32 v[222:223], v[222:223], v[238:239] op_sel:[0,0] op_sel_hi:[1,0]
    v_cvt_pk_bf16_f32 v208, v208, v209
    v_cvt_pk_bf16_f32 v209, v210, v211
    v_cvt_pk_bf16_f32 v210, v212, v213
    v_cvt_pk_bf16_f32 v211, v214, v215
    v_cvt_pk_bf16_f32 v216, v216, v217
    v_cvt_pk_bf16_f32 v217, v218, v219
    v_cvt_pk_bf16_f32 v218, v220, v221
    v_cvt_pk_bf16_f32 v219, v222, v223
    ds_write_b64 v30, v[160:161] offset:0
    ds_write_b64 v30, v[162:163] offset:32
    ds_write_b64 v30, v[168:169] offset:64
    ds_write_b64 v30, v[170:171] offset:96
    ds_write_b64 v30, v[176:177] offset:2176
    ds_write_b64 v30, v[178:179] offset:2208
    ds_write_b64 v30, v[184:185] offset:2240
    ds_write_b64 v30, v[186:187] offset:2272
    ds_write_b64 v30, v[192:193] offset:4352
    ds_write_b64 v30, v[194:195] offset:4384
    ds_write_b64 v30, v[200:201] offset:4416
    ds_write_b64 v30, v[202:203] offset:4448
    ds_write_b64 v30, v[208:209] offset:6528
    ds_write_b64 v30, v[210:211] offset:6560
    ds_write_b64 v30, v[216:217] offset:6592
    ds_write_b64 v30, v[218:219] offset:6624
    v_pk_mul_f32 v[8:9], v[248:249], v[20:21] op_sel:[0,0] op_sel_hi:[1,0] neg_lo:[0,1] neg_hi:[0,1]
    v_pk_mul_f32 v[10:11], v[250:251], v[20:21] op_sel:[0,0] op_sel_hi:[1,0] neg_lo:[0,1] neg_hi:[0,1]
    v_pk_fma_f32 v[112:113], v[112:113], v[20:21], v[8:9] op_sel:[0,1,0] op_sel_hi:[1,1,1]
    v_pk_fma_f32 v[114:115], v[114:115], v[20:21], v[10:11] op_sel:[0,1,0] op_sel_hi:[1,1,1]
    v_cvt_pk_bf16_f32 v224, v112, v113
    v_cvt_pk_bf16_f32 v225, v114, v115
    v_pk_mul_f32 v[8:9], v[252:253], v[20:21] op_sel:[0,0] op_sel_hi:[1,0] neg_lo:[0,1] neg_hi:[0,1]
    v_pk_mul_f32 v[10:11], v[254:255], v[20:21] op_sel:[0,0] op_sel_hi:[1,0] neg_lo:[0,1] neg_hi:[0,1]
    v_pk_fma_f32 v[144:145], v[144:145], v[20:21], v[8:9] op_sel:[0,1,0] op_sel_hi:[1,1,1]
    v_pk_fma_f32 v[146:147], v[146:147], v[20:21], v[10:11] op_sel:[0,1,0] op_sel_hi:[1,1,1]
    v_cvt_pk_bf16_f32 v226, v144, v145
    v_cvt_pk_bf16_f32 v227, v146, v147
    v_pk_mul_f32 v[8:9], v[248:249], v[22:23] op_sel:[0,0] op_sel_hi:[1,0] neg_lo:[0,1] neg_hi:[0,1]
    v_pk_mul_f32 v[10:11], v[250:251], v[22:23] op_sel:[0,0] op_sel_hi:[1,0] neg_lo:[0,1] neg_hi:[0,1]
    v_pk_fma_f32 v[116:117], v[116:117], v[22:23], v[8:9] op_sel:[0,1,0] op_sel_hi:[1,1,1]
    v_pk_fma_f32 v[118:119], v[118:119], v[22:23], v[10:11] op_sel:[0,1,0] op_sel_hi:[1,1,1]
    v_cvt_pk_bf16_f32 v228, v116, v117
    v_cvt_pk_bf16_f32 v229, v118, v119
    v_pk_mul_f32 v[8:9], v[252:253], v[22:23] op_sel:[0,0] op_sel_hi:[1,0] neg_lo:[0,1] neg_hi:[0,1]
    v_pk_mul_f32 v[10:11], v[254:255], v[22:23] op_sel:[0,0] op_sel_hi:[1,0] neg_lo:[0,1] neg_hi:[0,1]
    v_pk_fma_f32 v[148:149], v[148:149], v[22:23], v[8:9] op_sel:[0,1,0] op_sel_hi:[1,1,1]
    v_pk_fma_f32 v[150:151], v[150:151], v[22:23], v[10:11] op_sel:[0,1,0] op_sel_hi:[1,1,1]
    v_cvt_pk_bf16_f32 v230, v148, v149
    v_cvt_pk_bf16_f32 v231, v150, v151
    v_pk_mul_f32 v[8:9], v[248:249], v[24:25] op_sel:[0,0] op_sel_hi:[1,0] neg_lo:[0,1] neg_hi:[0,1]
    v_pk_mul_f32 v[10:11], v[250:251], v[24:25] op_sel:[0,0] op_sel_hi:[1,0] neg_lo:[0,1] neg_hi:[0,1]
    v_pk_fma_f32 v[120:121], v[120:121], v[24:25], v[8:9] op_sel:[0,1,0] op_sel_hi:[1,1,1]
    v_pk_fma_f32 v[122:123], v[122:123], v[24:25], v[10:11] op_sel:[0,1,0] op_sel_hi:[1,1,1]
    v_cvt_pk_bf16_f32 v232, v120, v121
    v_cvt_pk_bf16_f32 v233, v122, v123
    v_pk_mul_f32 v[8:9], v[252:253], v[24:25] op_sel:[0,0] op_sel_hi:[1,0] neg_lo:[0,1] neg_hi:[0,1]
    v_pk_mul_f32 v[10:11], v[254:255], v[24:25] op_sel:[0,0] op_sel_hi:[1,0] neg_lo:[0,1] neg_hi:[0,1]
    v_pk_fma_f32 v[152:153], v[152:153], v[24:25], v[8:9] op_sel:[0,1,0] op_sel_hi:[1,1,1]
    v_pk_fma_f32 v[154:155], v[154:155], v[24:25], v[10:11] op_sel:[0,1,0] op_sel_hi:[1,1,1]
    v_cvt_pk_bf16_f32 v234, v152, v153
    v_cvt_pk_bf16_f32 v235, v154, v155
    v_pk_mul_f32 v[8:9], v[248:249], v[26:27] op_sel:[0,0] op_sel_hi:[1,0] neg_lo:[0,1] neg_hi:[0,1]
    v_pk_mul_f32 v[10:11], v[250:251], v[26:27] op_sel:[0,0] op_sel_hi:[1,0] neg_lo:[0,1] neg_hi:[0,1]
    v_pk_fma_f32 v[124:125], v[124:125], v[26:27], v[8:9] op_sel:[0,1,0] op_sel_hi:[1,1,1]
    v_pk_fma_f32 v[126:127], v[126:127], v[26:27], v[10:11] op_sel:[0,1,0] op_sel_hi:[1,1,1]
    v_cvt_pk_bf16_f32 v236, v124, v125
    v_cvt_pk_bf16_f32 v237, v126, v127
    v_pk_mul_f32 v[8:9], v[252:253], v[26:27] op_sel:[0,0] op_sel_hi:[1,0] neg_lo:[0,1] neg_hi:[0,1]
    v_pk_mul_f32 v[10:11], v[254:255], v[26:27] op_sel:[0,0] op_sel_hi:[1,0] neg_lo:[0,1] neg_hi:[0,1]
    v_pk_fma_f32 v[156:157], v[156:157], v[26:27], v[8:9] op_sel:[0,1,0] op_sel_hi:[1,1,1]
    v_pk_fma_f32 v[158:159], v[158:159], v[26:27], v[10:11] op_sel:[0,1,0] op_sel_hi:[1,1,1]
    v_cvt_pk_bf16_f32 v238, v156, v157
    v_cvt_pk_bf16_f32 v239, v158, v159
    v_mfma_f32_16x16x32_bf16 v[160:163], v[240:243], v[224:227], 0
    v_mfma_f32_16x16x32_bf16 v[164:167], v[244:247], v[224:227], 0
    v_mfma_f32_16x16x32_bf16 v[176:179], v[240:243], v[228:231], 0
    v_mfma_f32_16x16x32_bf16 v[180:183], v[244:247], v[228:231], 0
    v_mfma_f32_16x16x32_bf16 v[192:195], v[240:243], v[232:235], 0
    v_mfma_f32_16x16x32_bf16 v[196:199], v[244:247], v[232:235], 0
    v_mfma_f32_16x16x32_bf16 v[208:211], v[240:243], v[236:239], 0
    v_mfma_f32_16x16x32_bf16 v[212:215], v[244:247], v[236:239], 0
    s_nop 0
    v_max3_f32 v224, v160, v161, v162
    v_max3_f32 v225, -v160, -v161, -v162
    v_max3_f32 v228, v176, v177, v178
    v_max3_f32 v229, -v176, -v177, -v178
    v_max3_f32 v232, v192, v193, v194
    v_max3_f32 v233, -v192, -v193, -v194
    v_max3_f32 v236, v208, v209, v210
    v_max3_f32 v237, -v208, -v209, -v210
    v_max3_f32 v224, v224, v163, v164
    v_max3_f32 v225, v225, -v163, -v164
    v_max3_f32 v228, v228, v179, v180
    v_max3_f32 v229, v229, -v179, -v180
    v_max3_f32 v232, v232, v195, v196
    v_max3_f32 v233, v233, -v195, -v196
    v_max3_f32 v236, v236, v211, v212
    v_max3_f32 v237, v237, -v211, -v212
    v_max3_f32 v224, v224, v165, v166
    v_max3_f32 v225, v225, -v165, -v166
    v_max3_f32 v228, v228, v181, v182
    v_max3_f32 v229, v229, -v181, -v182
    v_max3_f32 v232, v232, v197, v198
    v_max3_f32 v233, v233, -v197, -v198
    v_max3_f32 v236, v236, v213, v214
    v_max3_f32 v237, v237, -v213, -v214
    v_max_f32 v224, v224, v167
    v_max_f32_e64 v225, v225, -v167
    v_max_f32 v228, v228, v183
    v_max_f32_e64 v229, v229, -v183
    v_max_f32 v232, v232, v199
    v_max_f32_e64 v233, v233, -v199
    v_max_f32 v236, v236, v215
    v_max_f32_e64 v237, v237, -v215
    v_permlane32_swap_b32 v224, v225
    v_permlane32_swap_b32 v228, v229
    v_permlane32_swap_b32 v232, v233
    v_permlane32_swap_b32 v236, v237
    v_max_f32 v224, v224, v225
    v_max_f32 v228, v228, v229
    v_max_f32 v232, v232, v233
    v_max_f32 v236, v236, v237
    v_mov_b32 v225, v224
    v_mov_b32 v229, v228
    v_mov_b32 v233, v232
    v_mov_b32 v237, v236
    v_permlane16_swap_b32 v224, v225
    v_permlane16_swap_b32 v228, v229
    v_permlane16_swap_b32 v232, v233
    v_permlane16_swap_b32 v236, v237
    v_max_f32 v224, v224, v225
    v_max_f32 v228, v228, v229
    v_max_f32 v232, v232, v233
    v_max_f32 v236, v236, v237
    v_mov_b32 v226, v224
    v_mov_b32 v230, v228
    v_mov_b32 v234, v232
    v_mov_b32 v238, v236
    v_permlane32_swap_b32 v224, v226
    v_permlane32_swap_b32 v228, v230
    v_permlane32_swap_b32 v232, v234
    v_permlane32_swap_b32 v236, v238
    v_mul_f32 v224, s43, v224
    v_mul_f32 v226, s43, v226
    v_mul_f32 v228, s43, v228
    v_mul_f32 v230, s43, v230
    v_mul_f32 v232, s43, v232
    v_mul_f32 v234, s43, v234
    v_mul_f32 v236, s43, v236
    v_mul_f32 v238, s43, v238
    v_pk_fma_f32 v[168:169], v[160:161], s[42:43], v[226:227] op_sel:[0,1,0] op_sel_hi:[1,1,0]
    v_pk_fma_f32 v[170:171], v[162:163], s[42:43], v[226:227] op_sel:[0,1,0] op_sel_hi:[1,1,0]
    v_pk_fma_f32 v[172:173], v[164:165], s[42:43], v[226:227] op_sel:[0,1,0] op_sel_hi:[1,1,0]
    v_pk_fma_f32 v[174:175], v[166:167], s[42:43], v[226:227] op_sel:[0,1,0] op_sel_hi:[1,1,0]
    v_pk_fma_f32 v[160:161], v[160:161], s[42:43], v[224:225] op_sel:[0,0,0] op_sel_hi:[1,0,0]
    v_pk_fma_f32 v[162:163], v[162:163], s[42:43], v[224:225] op_sel:[0,0,0] op_sel_hi:[1,0,0]
    v_pk_fma_f32 v[164:165], v[164:165], s[42:43], v[224:225] op_sel:[0,0,0] op_sel_hi:[1,0,0]
    v_pk_fma_f32 v[166:167], v[166:167], s[42:43], v[224:225] op_sel:[0,0,0] op_sel_hi:[1,0,0]
    v_pk_fma_f32 v[184:185], v[176:177], s[42:43], v[230:231] op_sel:[0,1,0] op_sel_hi:[1,1,0]
    v_pk_fma_f32 v[186:187], v[178:179], s[42:43], v[230:231] op_sel:[0,1,0] op_sel_hi:[1,1,0]
    v_pk_fma_f32 v[188:189], v[180:181], s[42:43], v[230:231] op_sel:[0,1,0] op_sel_hi:[1,1,0]
    v_pk_fma_f32 v[190:191], v[182:183], s[42:43], v[230:231] op_sel:[0,1,0] op_sel_hi:[1,1,0]
    v_pk_fma_f32 v[176:177], v[176:177], s[42:43], v[228:229] op_sel:[0,0,0] op_sel_hi:[1,0,0]
    v_pk_fma_f32 v[178:179], v[178:179], s[42:43], v[228:229] op_sel:[0,0,0] op_sel_hi:[1,0,0]
    v_pk_fma_f32 v[180:181], v[180:181], s[42:43], v[228:229] op_sel:[0,0,0] op_sel_hi:[1,0,0]
    v_pk_fma_f32 v[182:183], v[182:183], s[42:43], v[228:229] op_sel:[0,0,0] op_sel_hi:[1,0,0]
    v_pk_fma_f32 v[200:201], v[192:193], s[42:43], v[234:235] op_sel:[0,1,0] op_sel_hi:[1,1,0]
    v_pk_fma_f32 v[202:203], v[194:195], s[42:43], v[234:235] op_sel:[0,1,0] op_sel_hi:[1,1,0]
    v_pk_fma_f32 v[204:205], v[196:197], s[42:43], v[234:235] op_sel:[0,1,0] op_sel_hi:[1,1,0]
    v_pk_fma_f32 v[206:207], v[198:199], s[42:43], v[234:235] op_sel:[0,1,0] op_sel_hi:[1,1,0]
    v_pk_fma_f32 v[192:193], v[192:193], s[42:43], v[232:233] op_sel:[0,0,0] op_sel_hi:[1,0,0]
    v_pk_fma_f32 v[194:195], v[194:195], s[42:43], v[232:233] op_sel:[0,0,0] op_sel_hi:[1,0,0]
    v_pk_fma_f32 v[196:197], v[196:197], s[42:43], v[232:233] op_sel:[0,0,0] op_sel_hi:[1,0,0]
    v_pk_fma_f32 v[198:199], v[198:199], s[42:43], v[232:233] op_sel:[0,0,0] op_sel_hi:[1,0,0]
    v_pk_fma_f32 v[216:217], v[208:209], s[42:43], v[238:239] op_sel:[0,1,0] op_sel_hi:[1,1,0]
    v_pk_fma_f32 v[218:219], v[210:211], s[42:43], v[238:239] op_sel:[0,1,0] op_sel_hi:[1,1,0]
    v_pk_fma_f32 v[220:221], v[212:213], s[42:43], v[238:239] op_sel:[0,1,0] op_sel_hi:[1,1,0]
    v_pk_fma_f32 v[222:223], v[214:215], s[42:43], v[238:239] op_sel:[0,1,0] op_sel_hi:[1,1,0]
    v_pk_fma_f32 v[208:209], v[208:209], s[42:43], v[236:237] op_sel:[0,0,0] op_sel_hi:[1,0,0]
    v_pk_fma_f32 v[210:211], v[210:211], s[42:43], v[236:237] op_sel:[0,0,0] op_sel_hi:[1,0,0]
    v_pk_fma_f32 v[212:213], v[212:213], s[42:43], v[236:237] op_sel:[0,0,0] op_sel_hi:[1,0,0]
    v_pk_fma_f32 v[214:215], v[214:215], s[42:43], v[236:237] op_sel:[0,0,0] op_sel_hi:[1,0,0]
    v_exp_f32 v160, v160
    v_exp_f32 v161, v161
    v_exp_f32 v162, v162
    v_exp_f32 v163, v163
    v_exp_f32 v164, v164
    v_exp_f32 v165, v165
    v_exp_f32 v166, v166
    v_exp_f32 v167, v167
    v_exp_f32 v168, v168
    v_exp_f32 v169, v169
    v_exp_f32 v170, v170
    v_exp_f32 v171, v171
    v_exp_f32 v172, v172
    v_exp_f32 v173, v173
    v_exp_f32 v174, v174
    v_exp_f32 v175, v175
    v_exp_f32 v176, v176
    v_exp_f32 v177, v177
    v_exp_f32 v178, v178
    v_exp_f32 v179, v179
    v_exp_f32 v180, v180
    v_exp_f32 v181, v181
    v_exp_f32 v182, v182
    v_exp_f32 v183, v183
    v_exp_f32 v184, v184
    v_exp_f32 v185, v185
    v_exp_f32 v186, v186
    v_exp_f32 v187, v187
    v_exp_f32 v188, v188
    v_exp_f32 v189, v189
    v_exp_f32 v190, v190
    v_exp_f32 v191, v191
    v_exp_f32 v192, v192
    v_exp_f32 v193, v193
    v_exp_f32 v194, v194
    v_exp_f32 v195, v195
    v_exp_f32 v196, v196
    v_exp_f32 v197, v197
    v_exp_f32 v198, v198
    v_exp_f32 v199, v199
    v_exp_f32 v200, v200
    v_exp_f32 v201, v201
    v_exp_f32 v202, v202
    v_exp_f32 v203, v203
    v_exp_f32 v204, v204
    v_exp_f32 v205, v205
    v_exp_f32 v206, v206
    v_exp_f32 v207, v207
    v_exp_f32 v208, v208
    v_exp_f32 v209, v209
    v_exp_f32 v210, v210
    v_exp_f32 v211, v211
    v_exp_f32 v212, v212
    v_exp_f32 v213, v213
    v_exp_f32 v214, v214
    v_exp_f32 v215, v215
    v_exp_f32 v216, v216
    v_exp_f32 v217, v217
    v_exp_f32 v218, v218
    v_exp_f32 v219, v219
    v_exp_f32 v220, v220
    v_exp_f32 v221, v221
    v_exp_f32 v222, v222
    v_exp_f32 v223, v223
    v_pk_add_f32 v[224:225], v[160:161], v[162:163] op_sel:[0,0] op_sel_hi:[1,1]
    v_pk_add_f32 v[226:227], v[168:169], v[170:171] op_sel:[0,0] op_sel_hi:[1,1]
    v_pk_add_f32 v[228:229], v[176:177], v[178:179] op_sel:[0,0] op_sel_hi:[1,1]
    v_pk_add_f32 v[230:231], v[184:185], v[186:187] op_sel:[0,0] op_sel_hi:[1,1]
    v_pk_add_f32 v[232:233], v[192:193], v[194:195] op_sel:[0,0] op_sel_hi:[1,1]
    v_pk_add_f32 v[234:235], v[200:201], v[202:203] op_sel:[0,0] op_sel_hi:[1,1]
    v_pk_add_f32 v[236:237], v[208:209], v[210:211] op_sel:[0,0] op_sel_hi:[1,1]
    v_pk_add_f32 v[238:239], v[216:217], v[218:219] op_sel:[0,0] op_sel_hi:[1,1]
    v_pk_add_f32 v[224:225], v[224:225], v[164:165] op_sel:[0,0] op_sel_hi:[1,1]
    v_pk_add_f32 v[226:227], v[226:227], v[172:173] op_sel:[0,0] op_sel_hi:[1,1]
    v_pk_add_f32 v[228:229], v[228:229], v[180:181] op_sel:[0,0] op_sel_hi:[1,1]
    v_pk_add_f32 v[230:231], v[230:231], v[188:189] op_sel:[0,0] op_sel_hi:[1,1]
    v_pk_add_f32 v[232:233], v[232:233], v[196:197] op_sel:[0,0] op_sel_hi:[1,1]
    v_pk_add_f32 v[234:235], v[234:235], v[204:205] op_sel:[0,0] op_sel_hi:[1,1]
    v_pk_add_f32 v[236:237], v[236:237], v[212:213] op_sel:[0,0] op_sel_hi:[1,1]
    v_pk_add_f32 v[238:239], v[238:239], v[220:221] op_sel:[0,0] op_sel_hi:[1,1]
    v_pk_add_f32 v[224:225], v[224:225], v[166:167] op_sel:[0,0] op_sel_hi:[1,1]
    v_pk_add_f32 v[226:227], v[226:227], v[174:175] op_sel:[0,0] op_sel_hi:[1,1]
    v_pk_add_f32 v[228:229], v[228:229], v[182:183] op_sel:[0,0] op_sel_hi:[1,1]
    v_pk_add_f32 v[230:231], v[230:231], v[190:191] op_sel:[0,0] op_sel_hi:[1,1]
    v_pk_add_f32 v[232:233], v[232:233], v[198:199] op_sel:[0,0] op_sel_hi:[1,1]
    v_pk_add_f32 v[234:235], v[234:235], v[206:207] op_sel:[0,0] op_sel_hi:[1,1]
    v_pk_add_f32 v[236:237], v[236:237], v[214:215] op_sel:[0,0] op_sel_hi:[1,1]
    v_pk_add_f32 v[238:239], v[238:239], v[222:223] op_sel:[0,0] op_sel_hi:[1,1]
    v_add_f32 v224, v224, v225
    v_add_f32 v228, v228, v229
    v_add_f32 v232, v232, v233
    v_add_f32 v236, v236, v237
    v_add_f32 v225, v226, v227
    v_add_f32 v229, v230, v231
    v_add_f32 v233, v234, v235
    v_add_f32 v237, v238, v239
    v_permlane32_swap_b32 v224, v225
    v_permlane32_swap_b32 v228, v229
    v_permlane32_swap_b32 v232, v233
    v_permlane32_swap_b32 v236, v237
    v_add_f32 v224, v224, v225
    v_add_f32 v228, v228, v229
    v_add_f32 v232, v232, v233
    v_add_f32 v236, v236, v237
    v_mov_b32 v225, v224
    v_mov_b32 v229, v228
    v_mov_b32 v233, v232
    v_mov_b32 v237, v236
    v_permlane16_swap_b32 v224, v225
    v_permlane16_swap_b32 v228, v229
    v_permlane16_swap_b32 v232, v233
    v_permlane16_swap_b32 v236, v237
    v_add_f32 v224, v224, v225
    v_add_f32 v228, v228, v229
    v_add_f32 v232, v232, v233
    v_add_f32 v236, v236, v237
    v_mov_b32 v226, v224
    v_mov_b32 v230, v228
    v_mov_b32 v234, v232
    v_mov_b32 v238, v236
    v_permlane32_swap_b32 v224, v226
    v_permlane32_swap_b32 v228, v230
    v_permlane32_swap_b32 v232, v234
    v_permlane32_swap_b32 v236, v238
    v_rcp_f32 v224, v224
    v_rcp_f32 v226, v226
    v_rcp_f32 v228, v228
    v_rcp_f32 v230, v230
    v_rcp_f32 v232, v232
    v_rcp_f32 v234, v234
    v_rcp_f32 v236, v236
    v_rcp_f32 v238, v238
    v_pk_mul_f32 v[160:161], v[160:161], v[224:225] op_sel:[0,0] op_sel_hi:[1,0]
    v_pk_mul_f32 v[162:163], v[162:163], v[224:225] op_sel:[0,0] op_sel_hi:[1,0]
    v_pk_mul_f32 v[164:165], v[164:165], v[224:225] op_sel:[0,0] op_sel_hi:[1,0]
    v_pk_mul_f32 v[166:167], v[166:167], v[224:225] op_sel:[0,0] op_sel_hi:[1,0]
    v_pk_mul_f32 v[168:169], v[168:169], v[226:227] op_sel:[0,0] op_sel_hi:[1,0]
    v_pk_mul_f32 v[170:171], v[170:171], v[226:227] op_sel:[0,0] op_sel_hi:[1,0]
    v_pk_mul_f32 v[172:173], v[172:173], v[226:227] op_sel:[0,0] op_sel_hi:[1,0]
    v_pk_mul_f32 v[174:175], v[174:175], v[226:227] op_sel:[0,0] op_sel_hi:[1,0]
    v_cvt_pk_bf16_f32 v160, v160, v161
    v_cvt_pk_bf16_f32 v161, v162, v163
    v_cvt_pk_bf16_f32 v162, v164, v165
    v_cvt_pk_bf16_f32 v163, v166, v167
    v_cvt_pk_bf16_f32 v168, v168, v169
    v_cvt_pk_bf16_f32 v169, v170, v171
    v_cvt_pk_bf16_f32 v170, v172, v173
    v_cvt_pk_bf16_f32 v171, v174, v175
    v_pk_mul_f32 v[176:177], v[176:177], v[228:229] op_sel:[0,0] op_sel_hi:[1,0]
    v_pk_mul_f32 v[178:179], v[178:179], v[228:229] op_sel:[0,0] op_sel_hi:[1,0]
    v_pk_mul_f32 v[180:181], v[180:181], v[228:229] op_sel:[0,0] op_sel_hi:[1,0]
    v_pk_mul_f32 v[182:183], v[182:183], v[228:229] op_sel:[0,0] op_sel_hi:[1,0]
    v_pk_mul_f32 v[184:185], v[184:185], v[230:231] op_sel:[0,0] op_sel_hi:[1,0]
    v_pk_mul_f32 v[186:187], v[186:187], v[230:231] op_sel:[0,0] op_sel_hi:[1,0]
    v_pk_mul_f32 v[188:189], v[188:189], v[230:231] op_sel:[0,0] op_sel_hi:[1,0]
    v_pk_mul_f32 v[190:191], v[190:191], v[230:231] op_sel:[0,0] op_sel_hi:[1,0]
    v_cvt_pk_bf16_f32 v176, v176, v177
    v_cvt_pk_bf16_f32 v177, v178, v179
    v_cvt_pk_bf16_f32 v178, v180, v181
    v_cvt_pk_bf16_f32 v179, v182, v183
    v_cvt_pk_bf16_f32 v184, v184, v185
    v_cvt_pk_bf16_f32 v185, v186, v187
    v_cvt_pk_bf16_f32 v186, v188, v189
    v_cvt_pk_bf16_f32 v187, v190, v191
    v_pk_mul_f32 v[192:193], v[192:193], v[232:233] op_sel:[0,0] op_sel_hi:[1,0]
    v_pk_mul_f32 v[194:195], v[194:195], v[232:233] op_sel:[0,0] op_sel_hi:[1,0]
    v_pk_mul_f32 v[196:197], v[196:197], v[232:233] op_sel:[0,0] op_sel_hi:[1,0]
    v_pk_mul_f32 v[198:199], v[198:199], v[232:233] op_sel:[0,0] op_sel_hi:[1,0]
    v_pk_mul_f32 v[200:201], v[200:201], v[234:235] op_sel:[0,0] op_sel_hi:[1,0]
    v_pk_mul_f32 v[202:203], v[202:203], v[234:235] op_sel:[0,0] op_sel_hi:[1,0]
    v_pk_mul_f32 v[204:205], v[204:205], v[234:235] op_sel:[0,0] op_sel_hi:[1,0]
    v_pk_mul_f32 v[206:207], v[206:207], v[234:235] op_sel:[0,0] op_sel_hi:[1,0]
    v_cvt_pk_bf16_f32 v192, v192, v193
    v_cvt_pk_bf16_f32 v193, v194, v195
    v_cvt_pk_bf16_f32 v194, v196, v197
    v_cvt_pk_bf16_f32 v195, v198, v199
    v_cvt_pk_bf16_f32 v200, v200, v201
    v_cvt_pk_bf16_f32 v201, v202, v203
    v_cvt_pk_bf16_f32 v202, v204, v205
    v_cvt_pk_bf16_f32 v203, v206, v207
    v_pk_mul_f32 v[208:209], v[208:209], v[236:237] op_sel:[0,0] op_sel_hi:[1,0]
    v_pk_mul_f32 v[210:211], v[210:211], v[236:237] op_sel:[0,0] op_sel_hi:[1,0]
    v_pk_mul_f32 v[212:213], v[212:213], v[236:237] op_sel:[0,0] op_sel_hi:[1,0]
    v_pk_mul_f32 v[214:215], v[214:215], v[236:237] op_sel:[0,0] op_sel_hi:[1,0]
    v_pk_mul_f32 v[216:217], v[216:217], v[238:239] op_sel:[0,0] op_sel_hi:[1,0]
    v_pk_mul_f32 v[218:219], v[218:219], v[238:239] op_sel:[0,0] op_sel_hi:[1,0]
    v_pk_mul_f32 v[220:221], v[220:221], v[238:239] op_sel:[0,0] op_sel_hi:[1,0]
    v_pk_mul_f32 v[222:223], v[222:223], v[238:239] op_sel:[0,0] op_sel_hi:[1,0]
    v_cvt_pk_bf16_f32 v208, v208, v209
    v_cvt_pk_bf16_f32 v209, v210, v211
    v_cvt_pk_bf16_f32 v210, v212, v213
    v_cvt_pk_bf16_f32 v211, v214, v215
    v_cvt_pk_bf16_f32 v216, v216, v217
    v_cvt_pk_bf16_f32 v217, v218, v219
    v_cvt_pk_bf16_f32 v218, v220, v221
    v_cvt_pk_bf16_f32 v219, v222, v223
    ds_write_b64 v30, v[160:161] offset:8704
    ds_write_b64 v30, v[162:163] offset:8736
    ds_write_b64 v30, v[168:169] offset:8768
    ds_write_b64 v30, v[170:171] offset:8800
    ds_write_b64 v30, v[176:177] offset:10880
    ds_write_b64 v30, v[178:179] offset:10912
    ds_write_b64 v30, v[184:185] offset:10944
    ds_write_b64 v30, v[186:187] offset:10976
    ds_write_b64 v30, v[192:193] offset:13056
    ds_write_b64 v30, v[194:195] offset:13088
    ds_write_b64 v30, v[200:201] offset:13120
    ds_write_b64 v30, v[202:203] offset:13152
    ds_write_b64 v30, v[208:209] offset:15232
    ds_write_b64 v30, v[210:211] offset:15264
    ds_write_b64 v30, v[216:217] offset:15296
    ds_write_b64 v30, v[218:219] offset:15328
    ds_read_b128 v[248:251], v0 offset:0
    ds_read_b128 v[252:255], v0 offset:64
    v_lshrrev_b32 v30, 2, v28
    v_lshl_add_u32 v30, v29, 3, v30
    v_and_b32 v8, 3, v1
    v_mul_u32_u24 v31, 72, v30
    v_mul_u32_u24 v30, 136, v30
    v_lshl_add_u32 v30, v8, 3, v30
    v_lshl_add_u32 v31, v8, 3, v31
    s_mul_i32 s40, s20, 34816
    s_lshl_b32 s41, s19, 6
    s_add_u32 s40, s40, s41
    v_add_u32 v30, s40, v30
    s_mul_i32 s40, s20, 18432
    s_add_u32 s40, s40, 69632
    v_add_u32 v31, s40, v31
    s_waitcnt lgkmcnt(0)
    s_barrier
    ds_read_b64_tr_b16 a[0:1], v30 offset:0
    ds_read_b64_tr_b16 a[2:3], v30 offset:544
    ds_read_b64_tr_b16 a[4:5], v30 offset:32
    ds_read_b64_tr_b16 a[6:7], v30 offset:576
    ds_read_b64_tr_b16 a[8:9], v31 offset:0
    ds_read_b64_tr_b16 a[10:11], v31 offset:288
    ds_read_b64_tr_b16 a[12:13], v31 offset:32
    ds_read_b64_tr_b16 a[14:15], v31 offset:320
    ds_read_b64_tr_b16 a[16:17], v30 offset:4352
    ds_read_b64_tr_b16 a[18:19], v30 offset:4896
    ds_read_b64_tr_b16 a[20:21], v30 offset:4384
    ds_read_b64_tr_b16 a[22:23], v30 offset:4928
    ds_read_b64_tr_b16 a[24:25], v31 offset:2304
    ds_read_b64_tr_b16 a[26:27], v31 offset:2592
    ds_read_b64_tr_b16 a[28:29], v31 offset:2336
    ds_read_b64_tr_b16 a[30:31], v31 offset:2624
    s_waitcnt lgkmcnt(8)
    v_mfma_f32_16x16x32_bf16 v[96:99], a[0:3], a[8:11], 0
    v_mfma_f32_16x16x32_bf16 v[100:103], a[0:3], a[12:15], 0
    v_mfma_f32_16x16x32_bf16 v[104:107], a[0:3], a[148:151], 0
    v_mfma_f32_16x16x32_bf16 v[108:111], a[4:7], a[8:11], 0
    v_mfma_f32_16x16x32_bf16 v[112:115], a[4:7], a[12:15], 0
    v_mfma_f32_16x16x32_bf16 v[116:119], a[4:7], a[148:151], 0
    ds_read_b64_tr_b16 a[32:33], v30 offset:8704
    ds_read_b64_tr_b16 a[34:35], v30 offset:9248
    ds_read_b64_tr_b16 a[36:37], v30 offset:8736
    ds_read_b64_tr_b16 a[38:39], v30 offset:9280
    ds_read_b64_tr_b16 a[40:41], v31 offset:4608
    ds_read_b64_tr_b16 a[42:43], v31 offset:4896
    ds_read_b64_tr_b16 a[44:45], v31 offset:4640
    ds_read_b64_tr_b16 a[46:47], v31 offset:4928
    s_waitcnt lgkmcnt(8)
    v_mfma_f32_16x16x32_bf16 v[96:99], a[16:19], a[24:27], v[96:99]
    v_mfma_f32_16x16x32_bf16 v[100:103], a[16:19], a[28:31], v[100:103]
    v_mfma_f32_16x16x32_bf16 v[104:107], a[16:19], a[148:151], v[104:107]
    v_mfma_f32_16x16x32_bf16 v[108:111], a[20:23], a[24:27], v[108:111]
    v_mfma_f32_16x16x32_bf16 v[112:115], a[20:23], a[28:31], v[112:115]
    v_mfma_f32_16x16x32_bf16 v[116:119], a[20:23], a[148:151], v[116:119]
    ds_read_b64_tr_b16 a[48:49], v30 offset:13056
    ds_read_b64_tr_b16 a[50:51], v30 offset:13600
    ds_read_b64_tr_b16 a[52:53], v30 offset:13088
    ds_read_b64_tr_b16 a[54:55], v30 offset:13632
    ds_read_b64_tr_b16 a[56:57], v31 offset:6912
    ds_read_b64_tr_b16 a[58:59], v31 offset:7200
    ds_read_b64_tr_b16 a[60:61], v31 offset:6944
    ds_read_b64_tr_b16 a[62:63], v31 offset:7232
    s_waitcnt lgkmcnt(8)
    v_mfma_f32_16x16x32_bf16 v[96:99], a[32:35], a[40:43], v[96:99]
    v_mfma_f32_16x16x32_bf16 v[100:103], a[32:35], a[44:47], v[100:103]
    v_mfma_f32_16x16x32_bf16 v[104:107], a[32:35], a[148:151], v[104:107]
    v_mfma_f32_16x16x32_bf16 v[108:111], a[36:39], a[40:43], v[108:111]
    v_mfma_f32_16x16x32_bf16 v[112:115], a[36:39], a[44:47], v[112:115]
    v_mfma_f32_16x16x32_bf16 v[116:119], a[36:39], a[148:151], v[116:119]
    ds_read_b64_tr_b16 a[0:1], v30 offset:17408
    ds_read_b64_tr_b16 a[2:3], v30 offset:17952
    ds_read_b64_tr_b16 a[4:5], v30 offset:17440
    ds_read_b64_tr_b16 a[6:7], v30 offset:17984
    ds_read_b64_tr_b16 a[8:9], v31 offset:9216
    ds_read_b64_tr_b16 a[10:11], v31 offset:9504
    ds_read_b64_tr_b16 a[12:13], v31 offset:9248
    ds_read_b64_tr_b16 a[14:15], v31 offset:9536
    s_waitcnt lgkmcnt(8)
    v_mfma_f32_16x16x32_bf16 v[96:99], a[48:51], a[56:59], v[96:99]
    v_mfma_f32_16x16x32_bf16 v[100:103], a[48:51], a[60:63], v[100:103]
    v_mfma_f32_16x16x32_bf16 v[104:107], a[48:51], a[148:151], v[104:107]
    v_mfma_f32_16x16x32_bf16 v[108:111], a[52:55], a[56:59], v[108:111]
    v_mfma_f32_16x16x32_bf16 v[112:115], a[52:55], a[60:63], v[112:115]
    v_mfma_f32_16x16x32_bf16 v[116:119], a[52:55], a[148:151], v[116:119]
    ds_read_b64_tr_b16 a[16:17], v30 offset:21760
    ds_read_b64_tr_b16 a[18:19], v30 offset:22304
    ds_read_b64_tr_b16 a[20:21], v30 offset:21792
    ds_read_b64_tr_b16 a[22:23], v30 offset:22336
    ds_read_b64_tr_b16 a[24:25], v31 offset:11520
    ds_read_b64_tr_b16 a[26:27], v31 offset:11808
    ds_read_b64_tr_b16 a[28:29], v31 offset:11552
    ds_read_b64_tr_b16 a[30:31], v31 offset:11840
    s_waitcnt lgkmcnt(8)
    v_mfma_f32_16x16x32_bf16 v[96:99], a[0:3], a[8:11], v[96:99]
    v_mfma_f32_16x16x32_bf16 v[100:103], a[0:3], a[12:15], v[100:103]
    v_mfma_f32_16x16x32_bf16 v[104:107], a[0:3], a[148:151], v[104:107]
    v_mfma_f32_16x16x32_bf16 v[108:111], a[4:7], a[8:11], v[108:111]
    v_mfma_f32_16x16x32_bf16 v[112:115], a[4:7], a[12:15], v[112:115]
    v_mfma_f32_16x16x32_bf16 v[116:119], a[4:7], a[148:151], v[116:119]
    ds_read_b64_tr_b16 a[32:33], v30 offset:26112
    ds_read_b64_tr_b16 a[34:35], v30 offset:26656
    ds_read_b64_tr_b16 a[36:37], v30 offset:26144
    ds_read_b64_tr_b16 a[38:39], v30 offset:26688
    ds_read_b64_tr_b16 a[40:41], v31 offset:13824
    ds_read_b64_tr_b16 a[42:43], v31 offset:14112
    ds_read_b64_tr_b16 a[44:45], v31 offset:13856
    ds_read_b64_tr_b16 a[46:47], v31 offset:14144
    s_waitcnt lgkmcnt(8)
    v_mfma_f32_16x16x32_bf16 v[96:99], a[16:19], a[24:27], v[96:99]
    v_mfma_f32_16x16x32_bf16 v[100:103], a[16:19], a[28:31], v[100:103]
    v_mfma_f32_16x16x32_bf16 v[104:107], a[16:19], a[148:151], v[104:107]
    v_mfma_f32_16x16x32_bf16 v[108:111], a[20:23], a[24:27], v[108:111]
    v_mfma_f32_16x16x32_bf16 v[112:115], a[20:23], a[28:31], v[112:115]
    v_mfma_f32_16x16x32_bf16 v[116:119], a[20:23], a[148:151], v[116:119]
    ds_read_b64_tr_b16 a[48:49], v30 offset:30464
    ds_read_b64_tr_b16 a[50:51], v30 offset:31008
    ds_read_b64_tr_b16 a[52:53], v30 offset:30496
    ds_read_b64_tr_b16 a[54:55], v30 offset:31040
    ds_read_b64_tr_b16 a[56:57], v31 offset:16128
    ds_read_b64_tr_b16 a[58:59], v31 offset:16416
    ds_read_b64_tr_b16 a[60:61], v31 offset:16160
    ds_read_b64_tr_b16 a[62:63], v31 offset:16448
    s_waitcnt lgkmcnt(8)
    v_mfma_f32_16x16x32_bf16 v[96:99], a[32:35], a[40:43], v[96:99]
    v_mfma_f32_16x16x32_bf16 v[100:103], a[32:35], a[44:47], v[100:103]
    v_mfma_f32_16x16x32_bf16 v[104:107], a[32:35], a[148:151], v[104:107]
    v_mfma_f32_16x16x32_bf16 v[108:111], a[36:39], a[40:43], v[108:111]
    v_mfma_f32_16x16x32_bf16 v[112:115], a[36:39], a[44:47], v[112:115]
    v_mfma_f32_16x16x32_bf16 v[116:119], a[36:39], a[148:151], v[116:119]
    s_waitcnt lgkmcnt(0)
    v_mfma_f32_16x16x32_bf16 v[96:99], a[48:51], a[56:59], v[96:99]
    v_mfma_f32_16x16x32_bf16 v[100:103], a[48:51], a[60:63], v[100:103]
    v_mfma_f32_16x16x32_bf16 v[104:107], a[48:51], a[148:151], v[104:107]
    v_mfma_f32_16x16x32_bf16 v[108:111], a[52:55], a[56:59], v[108:111]
    v_mfma_f32_16x16x32_bf16 v[112:115], a[52:55], a[60:63], v[112:115]
    v_mfma_f32_16x16x32_bf16 v[116:119], a[52:55], a[148:151], v[116:119]
    s_lshl_b32 s40, s22, 3
    s_add_u32 s40, s40, s21
    s_lshl_b32 s40, s40, 2
    s_add_u32 s40, s40, s18
    s_lshl_b32 s41, s40, 11
    s_add_u32 s41, s41, 25165824
    s_lshl_b32 s40, s40, 7
    s_add_u32 s40, s40, 28311552
    v_lshlrev_b32 v8, 4, v29
    v_cvt_pk_bf16_f32 v120, v96, v97
    v_cvt_pk_bf16_f32 v121, v98, v99
    v_cvt_pk_bf16_f32 v122, v108, v109
    v_cvt_pk_bf16_f32 v123, v110, v111
    buffer_store_dwordx4 v[120:123], v6, s[12:15], s41 offen offset:0 sc1
    v_cvt_pk_bf16_f32 v124, v100, v101
    v_cvt_pk_bf16_f32 v125, v102, v103
    v_cvt_pk_bf16_f32 v126, v112, v113
    v_cvt_pk_bf16_f32 v127, v114, v115
    buffer_store_dwordx4 v[124:127], v6, s[12:15], s41 offen offset:1024 sc1
    v_cmp_eq_u32 s[44:45], 0, v28
    s_nop 1
    s_mov_b64 exec, s[44:45]
    buffer_store_dwordx4 v[104:107], v8, s[12:15], s40 offen offset:0 sc1
    buffer_store_dwordx4 v[116:119], v8, s[12:15], s40 offen offset:64 sc1
    s_mov_b64 exec, -1
    s_add_u32 s46, s22, 0
    s_lshl_b32 s46, s46, 8
    v_pk_mul_f32 v[8:9], v[248:249], v[12:13] op_sel:[0,0] op_sel_hi:[1,0] neg_lo:[0,1] neg_hi:[0,1]
    v_pk_mul_f32 v[10:11], v[250:251], v[12:13] op_sel:[0,0] op_sel_hi:[1,0] neg_lo:[0,1] neg_hi:[0,1]
    v_pk_fma_f32 v[32:33], v[32:33], v[12:13], v[8:9] op_sel:[0,1,0] op_sel_hi:[1,1,1]
    v_pk_fma_f32 v[34:35], v[34:35], v[12:13], v[10:11] op_sel:[0,1,0] op_sel_hi:[1,1,1]
    v_cvt_pk_bf16_f32 v224, v32, v33
    v_cvt_pk_bf16_f32 v225, v34, v35
    v_pk_mul_f32 v[8:9], v[252:253], v[12:13] op_sel:[0,0] op_sel_hi:[1,0] neg_lo:[0,1] neg_hi:[0,1]
    v_pk_mul_f32 v[10:11], v[254:255], v[12:13] op_sel:[0,0] op_sel_hi:[1,0] neg_lo:[0,1] neg_hi:[0,1]
    v_pk_fma_f32 v[64:65], v[64:65], v[12:13], v[8:9] op_sel:[0,1,0] op_sel_hi:[1,1,1]
    v_pk_fma_f32 v[66:67], v[66:67], v[12:13], v[10:11] op_sel:[0,1,0] op_sel_hi:[1,1,1]
    v_cvt_pk_bf16_f32 v226, v64, v65
    v_cvt_pk_bf16_f32 v227, v66, v67
    v_pk_mul_f32 v[8:9], v[248:249], v[14:15] op_sel:[0,0] op_sel_hi:[1,0] neg_lo:[0,1] neg_hi:[0,1]
    v_pk_mul_f32 v[10:11], v[250:251], v[14:15] op_sel:[0,0] op_sel_hi:[1,0] neg_lo:[0,1] neg_hi:[0,1]
    v_pk_fma_f32 v[36:37], v[36:37], v[14:15], v[8:9] op_sel:[0,1,0] op_sel_hi:[1,1,1]
    v_pk_fma_f32 v[38:39], v[38:39], v[14:15], v[10:11] op_sel:[0,1,0] op_sel_hi:[1,1,1]
    v_cvt_pk_bf16_f32 v228, v36, v37
    v_cvt_pk_bf16_f32 v229, v38, v39
    v_pk_mul_f32 v[8:9], v[252:253], v[14:15] op_sel:[0,0] op_sel_hi:[1,0] neg_lo:[0,1] neg_hi:[0,1]
    v_pk_mul_f32 v[10:11], v[254:255], v[14:15] op_sel:[0,0] op_sel_hi:[1,0] neg_lo:[0,1] neg_hi:[0,1]
    v_pk_fma_f32 v[68:69], v[68:69], v[14:15], v[8:9] op_sel:[0,1,0] op_sel_hi:[1,1,1]
    v_pk_fma_f32 v[70:71], v[70:71], v[14:15], v[10:11] op_sel:[0,1,0] op_sel_hi:[1,1,1]
    v_cvt_pk_bf16_f32 v230, v68, v69
    v_cvt_pk_bf16_f32 v231, v70, v71
    v_pk_mul_f32 v[8:9], v[248:249], v[16:17] op_sel:[0,0] op_sel_hi:[1,0] neg_lo:[0,1] neg_hi:[0,1]
    v_pk_mul_f32 v[10:11], v[250:251], v[16:17] op_sel:[0,0] op_sel_hi:[1,0] neg_lo:[0,1] neg_hi:[0,1]
    v_pk_fma_f32 v[40:41], v[40:41], v[16:17], v[8:9] op_sel:[0,1,0] op_sel_hi:[1,1,1]
    v_pk_fma_f32 v[42:43], v[42:43], v[16:17], v[10:11] op_sel:[0,1,0] op_sel_hi:[1,1,1]
    v_cvt_pk_bf16_f32 v232, v40, v41
    v_cvt_pk_bf16_f32 v233, v42, v43
    v_pk_mul_f32 v[8:9], v[252:253], v[16:17] op_sel:[0,0] op_sel_hi:[1,0] neg_lo:[0,1] neg_hi:[0,1]
    v_pk_mul_f32 v[10:11], v[254:255], v[16:17] op_sel:[0,0] op_sel_hi:[1,0] neg_lo:[0,1] neg_hi:[0,1]
    v_pk_fma_f32 v[72:73], v[72:73], v[16:17], v[8:9] op_sel:[0,1,0] op_sel_hi:[1,1,1]
    v_pk_fma_f32 v[74:75], v[74:75], v[16:17], v[10:11] op_sel:[0,1,0] op_sel_hi:[1,1,1]
    v_cvt_pk_bf16_f32 v234, v72, v73
    v_cvt_pk_bf16_f32 v235, v74, v75
    v_pk_mul_f32 v[8:9], v[248:249], v[18:19] op_sel:[0,0] op_sel_hi:[1,0] neg_lo:[0,1] neg_hi:[0,1]
    v_pk_mul_f32 v[10:11], v[250:251], v[18:19] op_sel:[0,0] op_sel_hi:[1,0] neg_lo:[0,1] neg_hi:[0,1]
    v_pk_fma_f32 v[44:45], v[44:45], v[18:19], v[8:9] op_sel:[0,1,0] op_sel_hi:[1,1,1]
    v_pk_fma_f32 v[46:47], v[46:47], v[18:19], v[10:11] op_sel:[0,1,0] op_sel_hi:[1,1,1]
    v_cvt_pk_bf16_f32 v236, v44, v45
    v_cvt_pk_bf16_f32 v237, v46, v47
    v_pk_mul_f32 v[8:9], v[252:253], v[18:19] op_sel:[0,0] op_sel_hi:[1,0] neg_lo:[0,1] neg_hi:[0,1]
    v_pk_mul_f32 v[10:11], v[254:255], v[18:19] op_sel:[0,0] op_sel_hi:[1,0] neg_lo:[0,1] neg_hi:[0,1]
    v_pk_fma_f32 v[76:77], v[76:77], v[18:19], v[8:9] op_sel:[0,1,0] op_sel_hi:[1,1,1]
    v_pk_fma_f32 v[78:79], v[78:79], v[18:19], v[10:11] op_sel:[0,1,0] op_sel_hi:[1,1,1]
    v_cvt_pk_bf16_f32 v238, v76, v77
    v_cvt_pk_bf16_f32 v239, v78, v79
    v_mfma_f32_16x16x32_bf16 v[160:163], v[240:243], v[224:227], 0
    v_mfma_f32_16x16x32_bf16 v[164:167], v[244:247], v[224:227], 0
    v_mfma_f32_16x16x32_bf16 v[176:179], v[240:243], v[228:231], 0
    v_mfma_f32_16x16x32_bf16 v[180:183], v[244:247], v[228:231], 0
    v_mfma_f32_16x16x32_bf16 v[192:195], v[240:243], v[232:235], 0
    v_mfma_f32_16x16x32_bf16 v[196:199], v[244:247], v[232:235], 0
    v_mfma_f32_16x16x32_bf16 v[208:211], v[240:243], v[236:239], 0
    v_mfma_f32_16x16x32_bf16 v[212:215], v[244:247], v[236:239], 0
    s_nop 0
    v_max3_f32 v224, v160, v161, v162
    v_max3_f32 v225, -v160, -v161, -v162
    v_max3_f32 v228, v176, v177, v178
    v_max3_f32 v229, -v176, -v177, -v178
    v_max3_f32 v232, v192, v193, v194
    v_max3_f32 v233, -v192, -v193, -v194
    v_max3_f32 v236, v208, v209, v210
    v_max3_f32 v237, -v208, -v209, -v210
    v_max3_f32 v224, v224, v163, v164
    v_max3_f32 v225, v225, -v163, -v164
    v_max3_f32 v228, v228, v179, v180
    v_max3_f32 v229, v229, -v179, -v180
    v_max3_f32 v232, v232, v195, v196
    v_max3_f32 v233, v233, -v195, -v196
    v_max3_f32 v236, v236, v211, v212
    v_max3_f32 v237, v237, -v211, -v212
    v_max3_f32 v224, v224, v165, v166
    v_max3_f32 v225, v225, -v165, -v166
    v_max3_f32 v228, v228, v181, v182
    v_max3_f32 v229, v229, -v181, -v182
    v_max3_f32 v232, v232, v197, v198
    v_max3_f32 v233, v233, -v197, -v198
    v_max3_f32 v236, v236, v213, v214
    v_max3_f32 v237, v237, -v213, -v214
    v_max_f32 v224, v224, v167
    v_max_f32_e64 v225, v225, -v167
    v_max_f32 v228, v228, v183
    v_max_f32_e64 v229, v229, -v183
    v_max_f32 v232, v232, v199
    v_max_f32_e64 v233, v233, -v199
    v_max_f32 v236, v236, v215
    v_max_f32_e64 v237, v237, -v215
    v_permlane32_swap_b32 v224, v225
    v_permlane32_swap_b32 v228, v229
    v_permlane32_swap_b32 v232, v233
    v_permlane32_swap_b32 v236, v237
    v_max_f32 v224, v224, v225
    v_max_f32 v228, v228, v229
    v_max_f32 v232, v232, v233
    v_max_f32 v236, v236, v237
    v_mov_b32 v225, v224
    v_mov_b32 v229, v228
    v_mov_b32 v233, v232
    v_mov_b32 v237, v236
    v_permlane16_swap_b32 v224, v225
    v_permlane16_swap_b32 v228, v229
    v_permlane16_swap_b32 v232, v233
    v_permlane16_swap_b32 v236, v237
    v_max_f32 v224, v224, v225
    v_max_f32 v228, v228, v229
    v_max_f32 v232, v232, v233
    v_max_f32 v236, v236, v237
    v_mov_b32 v226, v224
    v_mov_b32 v230, v228
    v_mov_b32 v234, v232
    v_mov_b32 v238, v236
    v_permlane32_swap_b32 v224, v226
    v_permlane32_swap_b32 v228, v230
    v_permlane32_swap_b32 v232, v234
    v_permlane32_swap_b32 v236, v238
    v_mul_f32 v224, s43, v224
    v_mul_f32 v226, s43, v226
    v_mul_f32 v228, s43, v228
    v_mul_f32 v230, s43, v230
    v_mul_f32 v232, s43, v232
    v_mul_f32 v234, s43, v234
    v_mul_f32 v236, s43, v236
    v_mul_f32 v238, s43, v238
    v_pk_fma_f32 v[168:169], v[160:161], s[42:43], v[226:227] op_sel:[0,1,0] op_sel_hi:[1,1,0]
    v_pk_fma_f32 v[170:171], v[162:163], s[42:43], v[226:227] op_sel:[0,1,0] op_sel_hi:[1,1,0]
    v_pk_fma_f32 v[172:173], v[164:165], s[42:43], v[226:227] op_sel:[0,1,0] op_sel_hi:[1,1,0]
    v_pk_fma_f32 v[174:175], v[166:167], s[42:43], v[226:227] op_sel:[0,1,0] op_sel_hi:[1,1,0]
    v_pk_fma_f32 v[160:161], v[160:161], s[42:43], v[224:225] op_sel:[0,0,0] op_sel_hi:[1,0,0]
    v_pk_fma_f32 v[162:163], v[162:163], s[42:43], v[224:225] op_sel:[0,0,0] op_sel_hi:[1,0,0]
    v_pk_fma_f32 v[164:165], v[164:165], s[42:43], v[224:225] op_sel:[0,0,0] op_sel_hi:[1,0,0]
    v_pk_fma_f32 v[166:167], v[166:167], s[42:43], v[224:225] op_sel:[0,0,0] op_sel_hi:[1,0,0]
    v_pk_fma_f32 v[184:185], v[176:177], s[42:43], v[230:231] op_sel:[0,1,0] op_sel_hi:[1,1,0]
    v_pk_fma_f32 v[186:187], v[178:179], s[42:43], v[230:231] op_sel:[0,1,0] op_sel_hi:[1,1,0]
    v_pk_fma_f32 v[188:189], v[180:181], s[42:43], v[230:231] op_sel:[0,1,0] op_sel_hi:[1,1,0]
    v_pk_fma_f32 v[190:191], v[182:183], s[42:43], v[230:231] op_sel:[0,1,0] op_sel_hi:[1,1,0]
    v_pk_fma_f32 v[176:177], v[176:177], s[42:43], v[228:229] op_sel:[0,0,0] op_sel_hi:[1,0,0]
    v_pk_fma_f32 v[178:179], v[178:179], s[42:43], v[228:229] op_sel:[0,0,0] op_sel_hi:[1,0,0]
    v_pk_fma_f32 v[180:181], v[180:181], s[42:43], v[228:229] op_sel:[0,0,0] op_sel_hi:[1,0,0]
    v_pk_fma_f32 v[182:183], v[182:183], s[42:43], v[228:229] op_sel:[0,0,0] op_sel_hi:[1,0,0]
    v_pk_fma_f32 v[200:201], v[192:193], s[42:43], v[234:235] op_sel:[0,1,0] op_sel_hi:[1,1,0]
    v_pk_fma_f32 v[202:203], v[194:195], s[42:43], v[234:235] op_sel:[0,1,0] op_sel_hi:[1,1,0]
    v_pk_fma_f32 v[204:205], v[196:197], s[42:43], v[234:235] op_sel:[0,1,0] op_sel_hi:[1,1,0]
    v_pk_fma_f32 v[206:207], v[198:199], s[42:43], v[234:235] op_sel:[0,1,0] op_sel_hi:[1,1,0]
    v_pk_fma_f32 v[192:193], v[192:193], s[42:43], v[232:233] op_sel:[0,0,0] op_sel_hi:[1,0,0]
    v_pk_fma_f32 v[194:195], v[194:195], s[42:43], v[232:233] op_sel:[0,0,0] op_sel_hi:[1,0,0]
    v_pk_fma_f32 v[196:197], v[196:197], s[42:43], v[232:233] op_sel:[0,0,0] op_sel_hi:[1,0,0]
    v_pk_fma_f32 v[198:199], v[198:199], s[42:43], v[232:233] op_sel:[0,0,0] op_sel_hi:[1,0,0]
    v_pk_fma_f32 v[216:217], v[208:209], s[42:43], v[238:239] op_sel:[0,1,0] op_sel_hi:[1,1,0]
    v_pk_fma_f32 v[218:219], v[210:211], s[42:43], v[238:239] op_sel:[0,1,0] op_sel_hi:[1,1,0]
    v_pk_fma_f32 v[220:221], v[212:213], s[42:43], v[238:239] op_sel:[0,1,0] op_sel_hi:[1,1,0]
    v_pk_fma_f32 v[222:223], v[214:215], s[42:43], v[238:239] op_sel:[0,1,0] op_sel_hi:[1,1,0]
    v_pk_fma_f32 v[208:209], v[208:209], s[42:43], v[236:237] op_sel:[0,0,0] op_sel_hi:[1,0,0]
    v_pk_fma_f32 v[210:211], v[210:211], s[42:43], v[236:237] op_sel:[0,0,0] op_sel_hi:[1,0,0]
    v_pk_fma_f32 v[212:213], v[212:213], s[42:43], v[236:237] op_sel:[0,0,0] op_sel_hi:[1,0,0]
    v_pk_fma_f32 v[214:215], v[214:215], s[42:43], v[236:237] op_sel:[0,0,0] op_sel_hi:[1,0,0]
    s_waitcnt vmcnt(0)
    s_barrier
    s_cmp_lg_u32 s18, 0
    s_cbranch_scc1 P1_kvsig
    v_mov_b32 v30, s46
    v_mov_b32 v31, 1
    s_mov_b64 exec, 1
    global_atomic_add v30, v31, s[16:17] sc1
    s_mov_b64 exec, -1
P1_kvsig:
    v_exp_f32 v160, v160
    v_exp_f32 v161, v161
    v_exp_f32 v162, v162
    v_exp_f32 v163, v163
    v_exp_f32 v164, v164
    v_exp_f32 v165, v165
    s_add_u32 m0, s39, 50688
    s_add_u32 s45, s35, s30
    buffer_load_dwordx4 v4, s[8:11], s35 offen lds
    v_exp_f32 v166, v166
    v_exp_f32 v167, v167
    v_exp_f32 v168, v168
    v_exp_f32 v169, v169
    v_exp_f32 v170, v170
    v_exp_f32 v171, v171
    buffer_load_dwordx4 v5, s[8:11], s35 offen offset:1056 lds
    v_exp_f32 v172, v172
    v_exp_f32 v173, v173
    v_exp_f32 v174, v174
    v_exp_f32 v175, v175
    v_exp_f32 v176, v176
    v_exp_f32 v177, v177
    s_add_u32 m0, m0, 8448
    s_add_u32 s35, s35, s31
    buffer_load_dwordx4 v4, s[8:11], s45 offen lds
    v_exp_f32 v178, v178
    v_exp_f32 v179, v179
    v_exp_f32 v180, v180
    v_exp_f32 v181, v181
    v_exp_f32 v182, v182
    v_exp_f32 v183, v183
    buffer_load_dwordx4 v5, s[8:11], s45 offen offset:1056 lds
    v_exp_f32 v184, v184
    v_exp_f32 v185, v185
    v_exp_f32 v186, v186
    v_exp_f32 v187, v187
    v_exp_f32 v188, v188
    v_exp_f32 v189, v189
    s_add_u32 m0, s39, 0
    s_add_u32 s45, s35, s30
    buffer_load_dwordx4 v4, s[8:11], s35 offen lds
    v_exp_f32 v190, v190
    v_exp_f32 v191, v191
    v_exp_f32 v192, v192
    v_exp_f32 v193, v193
    v_exp_f32 v194, v194
    buffer_load_dwordx4 v5, s[8:11], s35 offen offset:1056 lds
    v_exp_f32 v195, v195
    v_exp_f32 v196, v196
    v_exp_f32 v197, v197
    v_exp_f32 v198, v198
    v_exp_f32 v199, v199
    v_exp_f32 v200, v200
    s_add_u32 m0, m0, 8448
    s_add_u32 s35, s35, s31
    buffer_load_dwordx4 v4, s[8:11], s45 offen lds
    v_exp_f32 v201, v201
    v_exp_f32 v202, v202
    v_exp_f32 v203, v203
    v_exp_f32 v204, v204
    v_exp_f32 v205, v205
    v_exp_f32 v206, v206
    buffer_load_dwordx4 v5, s[8:11], s45 offen offset:1056 lds
    v_exp_f32 v207, v207
    v_exp_f32 v208, v208
    v_exp_f32 v209, v209
    v_exp_f32 v210, v210
    v_exp_f32 v211, v211
    v_exp_f32 v212, v212
    s_add_u32 m0, s39, 16896
    s_add_u32 s45, s35, s30
    buffer_load_dwordx4 v4, s[8:11], s35 offen lds
    v_exp_f32 v213, v213
    v_exp_f32 v214, v214
    v_exp_f32 v215, v215
    v_exp_f32 v216, v216
    v_exp_f32 v217, v217
    v_exp_f32 v218, v218
    buffer_load_dwordx4 v5, s[8:11], s35 offen offset:1056 lds
    v_exp_f32 v219, v219
    v_exp_f32 v220, v220
    v_exp_f32 v221, v221
    v_exp_f32 v222, v222
    v_exp_f32 v223, v223
    v_pk_add_f32 v[224:225], v[160:161], v[162:163] op_sel:[0,0] op_sel_hi:[1,1]
    v_pk_add_f32 v[226:227], v[168:169], v[170:171] op_sel:[0,0] op_sel_hi:[1,1]
    v_pk_add_f32 v[228:229], v[176:177], v[178:179] op_sel:[0,0] op_sel_hi:[1,1]
    v_pk_add_f32 v[230:231], v[184:185], v[186:187] op_sel:[0,0] op_sel_hi:[1,1]
    v_pk_add_f32 v[232:233], v[192:193], v[194:195] op_sel:[0,0] op_sel_hi:[1,1]
    v_pk_add_f32 v[234:235], v[200:201], v[202:203] op_sel:[0,0] op_sel_hi:[1,1]
    v_pk_add_f32 v[236:237], v[208:209], v[210:211] op_sel:[0,0] op_sel_hi:[1,1]
    v_pk_add_f32 v[238:239], v[216:217], v[218:219] op_sel:[0,0] op_sel_hi:[1,1]
    v_pk_add_f32 v[224:225], v[224:225], v[164:165] op_sel:[0,0] op_sel_hi:[1,1]
    v_pk_add_f32 v[226:227], v[226:227], v[172:173] op_sel:[0,0] op_sel_hi:[1,1]
    v_pk_add_f32 v[228:229], v[228:229], v[180:181] op_sel:[0,0] op_sel_hi:[1,1]
    v_pk_add_f32 v[230:231], v[230:231], v[188:189] op_sel:[0,0] op_sel_hi:[1,1]
    v_pk_add_f32 v[232:233], v[232:233], v[196:197] op_sel:[0,0] op_sel_hi:[1,1]
    v_pk_add_f32 v[234:235], v[234:235], v[204:205] op_sel:[0,0] op_sel_hi:[1,1]
    v_pk_add_f32 v[236:237], v[236:237], v[212:213] op_sel:[0,0] op_sel_hi:[1,1]
    v_pk_add_f32 v[238:239], v[238:239], v[220:221] op_sel:[0,0] op_sel_hi:[1,1]
    v_pk_add_f32 v[224:225], v[224:225], v[166:167] op_sel:[0,0] op_sel_hi:[1,1]
    v_pk_add_f32 v[226:227], v[226:227], v[174:175] op_sel:[0,0] op_sel_hi:[1,1]
    v_pk_add_f32 v[228:229], v[228:229], v[182:183] op_sel:[0,0] op_sel_hi:[1,1]
    v_pk_add_f32 v[230:231], v[230:231], v[190:191] op_sel:[0,0] op_sel_hi:[1,1]
    v_pk_add_f32 v[232:233], v[232:233], v[198:199] op_sel:[0,0] op_sel_hi:[1,1]
    v_pk_add_f32 v[234:235], v[234:235], v[206:207] op_sel:[0,0] op_sel_hi:[1,1]
    v_pk_add_f32 v[236:237], v[236:237], v[214:215] op_sel:[0,0] op_sel_hi:[1,1]
    v_pk_add_f32 v[238:239], v[238:239], v[222:223] op_sel:[0,0] op_sel_hi:[1,1]
    v_add_f32 v224, v224, v225
    v_add_f32 v228, v228, v229
    v_add_f32 v232, v232, v233
    v_add_f32 v236, v236, v237
    v_add_f32 v225, v226, v227
    v_add_f32 v229, v230, v231
    v_add_f32 v233, v234, v235
    v_add_f32 v237, v238, v239
    v_permlane32_swap_b32 v224, v225
    v_permlane32_swap_b32 v228, v229
    v_permlane32_swap_b32 v232, v233
    v_permlane32_swap_b32 v236, v237
    v_add_f32 v224, v224, v225
    v_add_f32 v228, v228, v229
    v_add_f32 v232, v232, v233
    v_add_f32 v236, v236, v237
    v_mov_b32 v225, v224
    v_mov_b32 v229, v228
    v_mov_b32 v233, v232
    v_mov_b32 v237, v236
    v_permlane16_swap_b32 v224, v225
    v_permlane16_swap_b32 v228, v229
    v_permlane16_swap_b32 v232, v233
    v_permlane16_swap_b32 v236, v237
    v_add_f32 v224, v224, v225
    v_add_f32 v228, v228, v229
    v_add_f32 v232, v232, v233
    v_add_f32 v236, v236, v237
    v_mov_b32 v226, v224
    v_mov_b32 v230, v228
    v_mov_b32 v234, v232
    v_mov_b32 v238, v236
    v_permlane32_swap_b32 v224, v226
    v_permlane32_swap_b32 v228, v230
    v_permlane32_swap_b32 v232, v234
    v_permlane32_swap_b32 v236, v238
    v_rcp_f32 v224, v224
    v_rcp_f32 v226, v226
    v_rcp_f32 v228, v228
    v_rcp_f32 v230, v230
    v_rcp_f32 v232, v232
    v_rcp_f32 v234, v234
    v_rcp_f32 v236, v236
    v_rcp_f32 v238, v238
    v_pk_mul_f32 v[160:161], v[160:161], v[224:225] op_sel:[0,0] op_sel_hi:[1,0]
    v_pk_mul_f32 v[162:163], v[162:163], v[224:225] op_sel:[0,0] op_sel_hi:[1,0]
    v_pk_mul_f32 v[164:165], v[164:165], v[224:225] op_sel:[0,0] op_sel_hi:[1,0]
    v_pk_mul_f32 v[166:167], v[166:167], v[224:225] op_sel:[0,0] op_sel_hi:[1,0]
    v_pk_mul_f32 v[168:169], v[168:169], v[226:227] op_sel:[0,0] op_sel_hi:[1,0]
    v_pk_mul_f32 v[170:171], v[170:171], v[226:227] op_sel:[0,0] op_sel_hi:[1,0]
    v_pk_mul_f32 v[172:173], v[172:173], v[226:227] op_sel:[0,0] op_sel_hi:[1,0]
    v_pk_mul_f32 v[174:175], v[174:175], v[226:227] op_sel:[0,0] op_sel_hi:[1,0]
    v_cvt_pk_bf16_f32 v32, v160, v161
    v_cvt_pk_bf16_f32 v33, v162, v163
    v_cvt_pk_bf16_f32 v34, v164, v165
    v_cvt_pk_bf16_f32 v35, v166, v167
    v_cvt_pk_bf16_f32 v64, v168, v169
    v_cvt_pk_bf16_f32 v65, v170, v171
    v_cvt_pk_bf16_f32 v66, v172, v173
    v_cvt_pk_bf16_f32 v67, v174, v175
    v_pk_mul_f32 v[176:177], v[176:177], v[228:229] op_sel:[0,0] op_sel_hi:[1,0]
    v_pk_mul_f32 v[178:179], v[178:179], v[228:229] op_sel:[0,0] op_sel_hi:[1,0]
    v_pk_mul_f32 v[180:181], v[180:181], v[228:229] op_sel:[0,0] op_sel_hi:[1,0]
    v_pk_mul_f32 v[182:183], v[182:183], v[228:229] op_sel:[0,0] op_sel_hi:[1,0]
    v_pk_mul_f32 v[184:185], v[184:185], v[230:231] op_sel:[0,0] op_sel_hi:[1,0]
    v_pk_mul_f32 v[186:187], v[186:187], v[230:231] op_sel:[0,0] op_sel_hi:[1,0]
    v_pk_mul_f32 v[188:189], v[188:189], v[230:231] op_sel:[0,0] op_sel_hi:[1,0]
    v_pk_mul_f32 v[190:191], v[190:191], v[230:231] op_sel:[0,0] op_sel_hi:[1,0]
    v_cvt_pk_bf16_f32 v36, v176, v177
    v_cvt_pk_bf16_f32 v37, v178, v179
    v_cvt_pk_bf16_f32 v38, v180, v181
    v_cvt_pk_bf16_f32 v39, v182, v183
    v_cvt_pk_bf16_f32 v68, v184, v185
    v_cvt_pk_bf16_f32 v69, v186, v187
    v_cvt_pk_bf16_f32 v70, v188, v189
    v_cvt_pk_bf16_f32 v71, v190, v191
    v_pk_mul_f32 v[192:193], v[192:193], v[232:233] op_sel:[0,0] op_sel_hi:[1,0]
    v_pk_mul_f32 v[194:195], v[194:195], v[232:233] op_sel:[0,0] op_sel_hi:[1,0]
    v_pk_mul_f32 v[196:197], v[196:197], v[232:233] op_sel:[0,0] op_sel_hi:[1,0]
    v_pk_mul_f32 v[198:199], v[198:199], v[232:233] op_sel:[0,0] op_sel_hi:[1,0]
    v_pk_mul_f32 v[200:201], v[200:201], v[234:235] op_sel:[0,0] op_sel_hi:[1,0]
    v_pk_mul_f32 v[202:203], v[202:203], v[234:235] op_sel:[0,0] op_sel_hi:[1,0]
    v_pk_mul_f32 v[204:205], v[204:205], v[234:235] op_sel:[0,0] op_sel_hi:[1,0]
    v_pk_mul_f32 v[206:207], v[206:207], v[234:235] op_sel:[0,0] op_sel_hi:[1,0]
    v_cvt_pk_bf16_f32 v40, v192, v193
    v_cvt_pk_bf16_f32 v41, v194, v195
    v_cvt_pk_bf16_f32 v42, v196, v197
    v_cvt_pk_bf16_f32 v43, v198, v199
    v_cvt_pk_bf16_f32 v72, v200, v201
    v_cvt_pk_bf16_f32 v73, v202, v203
    v_cvt_pk_bf16_f32 v74, v204, v205
    v_cvt_pk_bf16_f32 v75, v206, v207
    v_pk_mul_f32 v[208:209], v[208:209], v[236:237] op_sel:[0,0] op_sel_hi:[1,0]
    v_pk_mul_f32 v[210:211], v[210:211], v[236:237] op_sel:[0,0] op_sel_hi:[1,0]
    v_pk_mul_f32 v[212:213], v[212:213], v[236:237] op_sel:[0,0] op_sel_hi:[1,0]
    v_pk_mul_f32 v[214:215], v[214:215], v[236:237] op_sel:[0,0] op_sel_hi:[1,0]
    v_pk_mul_f32 v[216:217], v[216:217], v[238:239] op_sel:[0,0] op_sel_hi:[1,0]
    v_pk_mul_f32 v[218:219], v[218:219], v[238:239] op_sel:[0,0] op_sel_hi:[1,0]
    v_pk_mul_f32 v[220:221], v[220:221], v[238:239] op_sel:[0,0] op_sel_hi:[1,0]
    v_pk_mul_f32 v[222:223], v[222:223], v[238:239] op_sel:[0,0] op_sel_hi:[1,0]
    v_cvt_pk_bf16_f32 v44, v208, v209
    v_cvt_pk_bf16_f32 v45, v210, v211
    v_cvt_pk_bf16_f32 v46, v212, v213
    v_cvt_pk_bf16_f32 v47, v214, v215
    v_cvt_pk_bf16_f32 v76, v216, v217
    v_cvt_pk_bf16_f32 v77, v218, v219
    v_cvt_pk_bf16_f32 v78, v220, v221
    v_cvt_pk_bf16_f32 v79, v222, v223
    s_mov_b32 s92, s48
    s_and_b32 s93, s49, 0xffff
    s_mov_b32 s94, 4194304
    s_mov_b32 s95, 0x20000
    s_mov_b32 s96, s62
    s_and_b32 s97, s63, 0xffff
    s_mov_b32 s98, 4194304
    s_mov_b32 s99, 0x20000
    s_lshl_b32 s32, s100, 2
    s_add_u32 s32, s32, s18
    s_lshl_b32 s32, s32, 1
    s_add_u32 s32, s32, s3
    s_lshl_b32 s32, s32, 16
    s_lshl_b32 s33, s101, 1
    s_add_u32 s33, s33, 1
    s_sub_u32 s33, s33, s23
    s_lshl_b32 s33, s33, 7
    s_add_u32 s32, s32, s33
    s_add_u32 s33, s32, 32768
    s_lshl_b32 s37, s18, 12
    s_add_u32 s37, s37, 114688
    s_mov_b32 s38, s32
    v_pk_mul_f32 v[8:9], v[248:249], v[20:21] op_sel:[0,0] op_sel_hi:[1,0] neg_lo:[0,1] neg_hi:[0,1]
    v_pk_mul_f32 v[10:11], v[250:251], v[20:21] op_sel:[0,0] op_sel_hi:[1,0] neg_lo:[0,1] neg_hi:[0,1]
    v_pk_fma_f32 v[48:49], v[48:49], v[20:21], v[8:9] op_sel:[0,1,0] op_sel_hi:[1,1,1]
    v_pk_fma_f32 v[50:51], v[50:51], v[20:21], v[10:11] op_sel:[0,1,0] op_sel_hi:[1,1,1]
    v_cvt_pk_bf16_f32 v224, v48, v49
    v_cvt_pk_bf16_f32 v225, v50, v51
    v_pk_mul_f32 v[8:9], v[252:253], v[20:21] op_sel:[0,0] op_sel_hi:[1,0] neg_lo:[0,1] neg_hi:[0,1]
    v_pk_mul_f32 v[10:11], v[254:255], v[20:21] op_sel:[0,0] op_sel_hi:[1,0] neg_lo:[0,1] neg_hi:[0,1]
    v_pk_fma_f32 v[80:81], v[80:81], v[20:21], v[8:9] op_sel:[0,1,0] op_sel_hi:[1,1,1]
    v_pk_fma_f32 v[82:83], v[82:83], v[20:21], v[10:11] op_sel:[0,1,0] op_sel_hi:[1,1,1]
    v_cvt_pk_bf16_f32 v226, v80, v81
    v_cvt_pk_bf16_f32 v227, v82, v83
    v_pk_mul_f32 v[8:9], v[248:249], v[22:23] op_sel:[0,0] op_sel_hi:[1,0] neg_lo:[0,1] neg_hi:[0,1]
    v_pk_mul_f32 v[10:11], v[250:251], v[22:23] op_sel:[0,0] op_sel_hi:[1,0] neg_lo:[0,1] neg_hi:[0,1]
    v_pk_fma_f32 v[52:53], v[52:53], v[22:23], v[8:9] op_sel:[0,1,0] op_sel_hi:[1,1,1]
    v_pk_fma_f32 v[54:55], v[54:55], v[22:23], v[10:11] op_sel:[0,1,0] op_sel_hi:[1,1,1]
    v_cvt_pk_bf16_f32 v228, v52, v53
    v_cvt_pk_bf16_f32 v229, v54, v55
    v_pk_mul_f32 v[8:9], v[252:253], v[22:23] op_sel:[0,0] op_sel_hi:[1,0] neg_lo:[0,1] neg_hi:[0,1]
    v_pk_mul_f32 v[10:11], v[254:255], v[22:23] op_sel:[0,0] op_sel_hi:[1,0] neg_lo:[0,1] neg_hi:[0,1]
    v_pk_fma_f32 v[84:85], v[84:85], v[22:23], v[8:9] op_sel:[0,1,0] op_sel_hi:[1,1,1]
    v_pk_fma_f32 v[86:87], v[86:87], v[22:23], v[10:11] op_sel:[0,1,0] op_sel_hi:[1,1,1]
    v_cvt_pk_bf16_f32 v230, v84, v85
    v_cvt_pk_bf16_f32 v231, v86, v87
    v_pk_mul_f32 v[8:9], v[248:249], v[24:25] op_sel:[0,0] op_sel_hi:[1,0] neg_lo:[0,1] neg_hi:[0,1]
    v_pk_mul_f32 v[10:11], v[250:251], v[24:25] op_sel:[0,0] op_sel_hi:[1,0] neg_lo:[0,1] neg_hi:[0,1]
    v_pk_fma_f32 v[56:57], v[56:57], v[24:25], v[8:9] op_sel:[0,1,0] op_sel_hi:[1,1,1]
    v_pk_fma_f32 v[58:59], v[58:59], v[24:25], v[10:11] op_sel:[0,1,0] op_sel_hi:[1,1,1]
    v_cvt_pk_bf16_f32 v232, v56, v57
    v_cvt_pk_bf16_f32 v233, v58, v59
    v_pk_mul_f32 v[8:9], v[252:253], v[24:25] op_sel:[0,0] op_sel_hi:[1,0] neg_lo:[0,1] neg_hi:[0,1]
    v_pk_mul_f32 v[10:11], v[254:255], v[24:25] op_sel:[0,0] op_sel_hi:[1,0] neg_lo:[0,1] neg_hi:[0,1]
    v_pk_fma_f32 v[88:89], v[88:89], v[24:25], v[8:9] op_sel:[0,1,0] op_sel_hi:[1,1,1]
    v_pk_fma_f32 v[90:91], v[90:91], v[24:25], v[10:11] op_sel:[0,1,0] op_sel_hi:[1,1,1]
    v_cvt_pk_bf16_f32 v234, v88, v89
    v_cvt_pk_bf16_f32 v235, v90, v91
    v_pk_mul_f32 v[8:9], v[248:249], v[26:27] op_sel:[0,0] op_sel_hi:[1,0] neg_lo:[0,1] neg_hi:[0,1]
    v_pk_mul_f32 v[10:11], v[250:251], v[26:27] op_sel:[0,0] op_sel_hi:[1,0] neg_lo:[0,1] neg_hi:[0,1]
    v_pk_fma_f32 v[60:61], v[60:61], v[26:27], v[8:9] op_sel:[0,1,0] op_sel_hi:[1,1,1]
    v_pk_fma_f32 v[62:63], v[62:63], v[26:27], v[10:11] op_sel:[0,1,0] op_sel_hi:[1,1,1]
    v_cvt_pk_bf16_f32 v236, v60, v61
    v_cvt_pk_bf16_f32 v237, v62, v63
    v_pk_mul_f32 v[8:9], v[252:253], v[26:27] op_sel:[0,0] op_sel_hi:[1,0] neg_lo:[0,1] neg_hi:[0,1]
    v_pk_mul_f32 v[10:11], v[254:255], v[26:27] op_sel:[0,0] op_sel_hi:[1,0] neg_lo:[0,1] neg_hi:[0,1]
    v_pk_fma_f32 v[92:93], v[92:93], v[26:27], v[8:9] op_sel:[0,1,0] op_sel_hi:[1,1,1]
    v_pk_fma_f32 v[94:95], v[94:95], v[26:27], v[10:11] op_sel:[0,1,0] op_sel_hi:[1,1,1]
    v_cvt_pk_bf16_f32 v238, v92, v93
    v_cvt_pk_bf16_f32 v239, v94, v95
    v_mfma_f32_16x16x32_bf16 v[160:163], v[240:243], v[224:227], 0
    v_mfma_f32_16x16x32_bf16 v[164:167], v[244:247], v[224:227], 0
    v_mfma_f32_16x16x32_bf16 v[176:179], v[240:243], v[228:231], 0
    v_mfma_f32_16x16x32_bf16 v[180:183], v[244:247], v[228:231], 0
    v_mfma_f32_16x16x32_bf16 v[192:195], v[240:243], v[232:235], 0
    v_mfma_f32_16x16x32_bf16 v[196:199], v[244:247], v[232:235], 0
    v_mfma_f32_16x16x32_bf16 v[208:211], v[240:243], v[236:239], 0
    v_mfma_f32_16x16x32_bf16 v[212:215], v[244:247], v[236:239], 0
    s_nop 0
    v_max3_f32 v224, v160, v161, v162
    v_max3_f32 v225, -v160, -v161, -v162
    v_max3_f32 v228, v176, v177, v178
    v_max3_f32 v229, -v176, -v177, -v178
    v_max3_f32 v232, v192, v193, v194
    v_max3_f32 v233, -v192, -v193, -v194
    v_max3_f32 v236, v208, v209, v210
    v_max3_f32 v237, -v208, -v209, -v210
    v_max3_f32 v224, v224, v163, v164
    v_max3_f32 v225, v225, -v163, -v164
    v_max3_f32 v228, v228, v179, v180
    v_max3_f32 v229, v229, -v179, -v180
    v_max3_f32 v232, v232, v195, v196
    v_max3_f32 v233, v233, -v195, -v196
    v_max3_f32 v236, v236, v211, v212
    v_max3_f32 v237, v237, -v211, -v212
    v_max3_f32 v224, v224, v165, v166
    v_max3_f32 v225, v225, -v165, -v166
    v_max3_f32 v228, v228, v181, v182
    v_max3_f32 v229, v229, -v181, -v182
    v_max3_f32 v232, v232, v197, v198
    v_max3_f32 v233, v233, -v197, -v198
    v_max3_f32 v236, v236, v213, v214
    v_max3_f32 v237, v237, -v213, -v214
    v_max_f32 v224, v224, v167
    v_max_f32_e64 v225, v225, -v167
    v_max_f32 v228, v228, v183
    v_max_f32_e64 v229, v229, -v183
    v_max_f32 v232, v232, v199
    v_max_f32_e64 v233, v233, -v199
    v_max_f32 v236, v236, v215
    v_max_f32_e64 v237, v237, -v215
    v_permlane32_swap_b32 v224, v225
    v_permlane32_swap_b32 v228, v229
    v_permlane32_swap_b32 v232, v233
    v_permlane32_swap_b32 v236, v237
    v_max_f32 v224, v224, v225
    v_max_f32 v228, v228, v229
    v_max_f32 v232, v232, v233
    v_max_f32 v236, v236, v237
    v_mov_b32 v225, v224
    v_mov_b32 v229, v228
    v_mov_b32 v233, v232
    v_mov_b32 v237, v236
    v_permlane16_swap_b32 v224, v225
    v_permlane16_swap_b32 v228, v229
    v_permlane16_swap_b32 v232, v233
    v_permlane16_swap_b32 v236, v237
    v_max_f32 v224, v224, v225
    v_max_f32 v228, v228, v229
    v_max_f32 v232, v232, v233
    v_max_f32 v236, v236, v237
    v_mov_b32 v226, v224
    v_mov_b32 v230, v228
    v_mov_b32 v234, v232
    v_mov_b32 v238, v236
    v_permlane32_swap_b32 v224, v226
    v_permlane32_swap_b32 v228, v230
    v_permlane32_swap_b32 v232, v234
    v_permlane32_swap_b32 v236, v238
    v_mul_f32 v224, s43, v224
    v_mul_f32 v226, s43, v226
    v_mul_f32 v228, s43, v228
    v_mul_f32 v230, s43, v230
    v_mul_f32 v232, s43, v232
    v_mul_f32 v234, s43, v234
    v_mul_f32 v236, s43, v236
    v_mul_f32 v238, s43, v238
    v_pk_fma_f32 v[168:169], v[160:161], s[42:43], v[226:227] op_sel:[0,1,0] op_sel_hi:[1,1,0]
    v_pk_fma_f32 v[170:171], v[162:163], s[42:43], v[226:227] op_sel:[0,1,0] op_sel_hi:[1,1,0]
    v_pk_fma_f32 v[172:173], v[164:165], s[42:43], v[226:227] op_sel:[0,1,0] op_sel_hi:[1,1,0]
    v_pk_fma_f32 v[174:175], v[166:167], s[42:43], v[226:227] op_sel:[0,1,0] op_sel_hi:[1,1,0]
    v_pk_fma_f32 v[160:161], v[160:161], s[42:43], v[224:225] op_sel:[0,0,0] op_sel_hi:[1,0,0]
    v_pk_fma_f32 v[162:163], v[162:163], s[42:43], v[224:225] op_sel:[0,0,0] op_sel_hi:[1,0,0]
    v_pk_fma_f32 v[164:165], v[164:165], s[42:43], v[224:225] op_sel:[0,0,0] op_sel_hi:[1,0,0]
    v_pk_fma_f32 v[166:167], v[166:167], s[42:43], v[224:225] op_sel:[0,0,0] op_sel_hi:[1,0,0]
    v_pk_fma_f32 v[184:185], v[176:177], s[42:43], v[230:231] op_sel:[0,1,0] op_sel_hi:[1,1,0]
    v_pk_fma_f32 v[186:187], v[178:179], s[42:43], v[230:231] op_sel:[0,1,0] op_sel_hi:[1,1,0]
    v_pk_fma_f32 v[188:189], v[180:181], s[42:43], v[230:231] op_sel:[0,1,0] op_sel_hi:[1,1,0]
    v_pk_fma_f32 v[190:191], v[182:183], s[42:43], v[230:231] op_sel:[0,1,0] op_sel_hi:[1,1,0]
    v_pk_fma_f32 v[176:177], v[176:177], s[42:43], v[228:229] op_sel:[0,0,0] op_sel_hi:[1,0,0]
    v_pk_fma_f32 v[178:179], v[178:179], s[42:43], v[228:229] op_sel:[0,0,0] op_sel_hi:[1,0,0]
    v_pk_fma_f32 v[180:181], v[180:181], s[42:43], v[228:229] op_sel:[0,0,0] op_sel_hi:[1,0,0]
    v_pk_fma_f32 v[182:183], v[182:183], s[42:43], v[228:229] op_sel:[0,0,0] op_sel_hi:[1,0,0]
    v_pk_fma_f32 v[200:201], v[192:193], s[42:43], v[234:235] op_sel:[0,1,0] op_sel_hi:[1,1,0]
    v_pk_fma_f32 v[202:203], v[194:195], s[42:43], v[234:235] op_sel:[0,1,0] op_sel_hi:[1,1,0]
    v_pk_fma_f32 v[204:205], v[196:197], s[42:43], v[234:235] op_sel:[0,1,0] op_sel_hi:[1,1,0]
    v_pk_fma_f32 v[206:207], v[198:199], s[42:43], v[234:235] op_sel:[0,1,0] op_sel_hi:[1,1,0]
    v_pk_fma_f32 v[192:193], v[192:193], s[42:43], v[232:233] op_sel:[0,0,0] op_sel_hi:[1,0,0]
    v_pk_fma_f32 v[194:195], v[194:195], s[42:43], v[232:233] op_sel:[0,0,0] op_sel_hi:[1,0,0]
    v_pk_fma_f32 v[196:197], v[196:197], s[42:43], v[232:233] op_sel:[0,0,0] op_sel_hi:[1,0,0]
    v_pk_fma_f32 v[198:199], v[198:199], s[42:43], v[232:233] op_sel:[0,0,0] op_sel_hi:[1,0,0]
    v_pk_fma_f32 v[216:217], v[208:209], s[42:43], v[238:239] op_sel:[0,1,0] op_sel_hi:[1,1,0]
    v_pk_fma_f32 v[218:219], v[210:211], s[42:43], v[238:239] op_sel:[0,1,0] op_sel_hi:[1,1,0]
    v_pk_fma_f32 v[220:221], v[212:213], s[42:43], v[238:239] op_sel:[0,1,0] op_sel_hi:[1,1,0]
    v_pk_fma_f32 v[222:223], v[214:215], s[42:43], v[238:239] op_sel:[0,1,0] op_sel_hi:[1,1,0]
    v_pk_fma_f32 v[208:209], v[208:209], s[42:43], v[236:237] op_sel:[0,0,0] op_sel_hi:[1,0,0]
    v_pk_fma_f32 v[210:211], v[210:211], s[42:43], v[236:237] op_sel:[0,0,0] op_sel_hi:[1,0,0]
    v_pk_fma_f32 v[212:213], v[212:213], s[42:43], v[236:237] op_sel:[0,0,0] op_sel_hi:[1,0,0]
    v_pk_fma_f32 v[214:215], v[214:215], s[42:43], v[236:237] op_sel:[0,0,0] op_sel_hi:[1,0,0]
    v_exp_f32 v160, v160
    v_exp_f32 v161, v161
    v_exp_f32 v162, v162
    v_exp_f32 v163, v163
    v_exp_f32 v164, v164
    v_exp_f32 v165, v165
    s_add_u32 m0, m0, 8448
    s_add_u32 s35, s35, s31
    buffer_load_dwordx4 v4, s[8:11], s45 offen lds
    v_exp_f32 v166, v166
    v_exp_f32 v167, v167
    v_exp_f32 v168, v168
    v_exp_f32 v169, v169
    v_exp_f32 v170, v170
    v_exp_f32 v171, v171
    buffer_load_dwordx4 v5, s[8:11], s45 offen offset:1056 lds
    v_exp_f32 v172, v172
    v_exp_f32 v173, v173
    v_exp_f32 v174, v174
    v_exp_f32 v175, v175
    v_exp_f32 v176, v176
    v_exp_f32 v177, v177
    s_add_u32 m0, s39, 33792
    s_add_u32 s45, s35, s30
    buffer_load_dwordx4 v4, s[8:11], s35 offen lds
    v_exp_f32 v178, v178
    v_exp_f32 v179, v179
    v_exp_f32 v180, v180
    v_exp_f32 v181, v181
    v_exp_f32 v182, v182
    v_exp_f32 v183, v183
    buffer_load_dwordx4 v5, s[8:11], s35 offen offset:1056 lds
    v_exp_f32 v184, v184
    v_exp_f32 v185, v185
    v_exp_f32 v186, v186
    v_exp_f32 v187, v187
    v_exp_f32 v188, v188
    v_exp_f32 v189, v189
    s_add_u32 m0, m0, 8448
    s_add_u32 s35, s35, s31
    buffer_load_dwordx4 v4, s[8:11], s45 offen lds
    v_exp_f32 v190, v190
    v_exp_f32 v191, v191
    v_exp_f32 v192, v192
    v_exp_f32 v193, v193
    v_exp_f32 v194, v194
    buffer_load_dwordx4 v5, s[8:11], s45 offen offset:1056 lds
    v_exp_f32 v195, v195
    v_exp_f32 v196, v196
    v_exp_f32 v197, v197
    v_exp_f32 v198, v198
    v_exp_f32 v199, v199
    v_exp_f32 v200, v200
    s_add_u32 m0, s37, 0
    v_lshrrev_b32 v9, 3, v1
    v_and_b32 v8, 7, v1
    v_xor_b32 v8, v8, v9
    v_lshlrev_b32 v8, 4, v8
    v_lshl_add_u32 v8, v9, 11, v8
    buffer_load_dwordx4 v8, s[92:95], s38 offen lds
    s_add_u32 s38, s38, 16384
    v_exp_f32 v201, v201
    v_exp_f32 v202, v202
    v_exp_f32 v203, v203
    v_exp_f32 v204, v204
    v_exp_f32 v205, v205
    v_exp_f32 v206, v206
    s_add_u32 m0, s37, 1024
    s_nop 0
    buffer_load_dwordx4 v8, s[92:95], s38 offen lds
    s_add_u32 s38, s38, 16384
    v_exp_f32 v207, v207
    v_exp_f32 v208, v208
    v_exp_f32 v209, v209
    v_exp_f32 v210, v210
    v_exp_f32 v211, v211
    v_exp_f32 v212, v212
    s_add_u32 m0, s37, 2048
    s_nop 0
    buffer_load_dwordx4 v8, s[92:95], s38 offen lds
    s_add_u32 s38, s38, 16384
    v_exp_f32 v213, v213
    v_exp_f32 v214, v214
    v_exp_f32 v215, v215
    v_exp_f32 v216, v216
    v_exp_f32 v217, v217
    v_exp_f32 v218, v218
    s_add_u32 m0, s37, 3072
    s_nop 0
    buffer_load_dwordx4 v8, s[92:95], s38 offen lds
    s_add_u32 s38, s38, 16384
    v_exp_f32 v219, v219
    v_exp_f32 v220, v220
    v_exp_f32 v221, v221
    v_exp_f32 v222, v222
    v_exp_f32 v223, v223
    s_cmp_lg_u32 s18, 0
    s_cbranch_scc1 P1_kvnl
    v_mov_b32 v0, s46
    global_load_dword v30, v0, s[16:17] sc1
P1_kvnl:
    v_pk_add_f32 v[224:225], v[160:161], v[162:163] op_sel:[0,0] op_sel_hi:[1,1]
    v_pk_add_f32 v[226:227], v[168:169], v[170:171] op_sel:[0,0] op_sel_hi:[1,1]
    v_pk_add_f32 v[228:229], v[176:177], v[178:179] op_sel:[0,0] op_sel_hi:[1,1]
    v_pk_add_f32 v[230:231], v[184:185], v[186:187] op_sel:[0,0] op_sel_hi:[1,1]
    v_pk_add_f32 v[232:233], v[192:193], v[194:195] op_sel:[0,0] op_sel_hi:[1,1]
    v_pk_add_f32 v[234:235], v[200:201], v[202:203] op_sel:[0,0] op_sel_hi:[1,1]
    v_pk_add_f32 v[236:237], v[208:209], v[210:211] op_sel:[0,0] op_sel_hi:[1,1]
    v_pk_add_f32 v[238:239], v[216:217], v[218:219] op_sel:[0,0] op_sel_hi:[1,1]
    v_pk_add_f32 v[224:225], v[224:225], v[164:165] op_sel:[0,0] op_sel_hi:[1,1]
    v_pk_add_f32 v[226:227], v[226:227], v[172:173] op_sel:[0,0] op_sel_hi:[1,1]
    v_pk_add_f32 v[228:229], v[228:229], v[180:181] op_sel:[0,0] op_sel_hi:[1,1]
    v_pk_add_f32 v[230:231], v[230:231], v[188:189] op_sel:[0,0] op_sel_hi:[1,1]
    v_pk_add_f32 v[232:233], v[232:233], v[196:197] op_sel:[0,0] op_sel_hi:[1,1]
    v_pk_add_f32 v[234:235], v[234:235], v[204:205] op_sel:[0,0] op_sel_hi:[1,1]
    v_pk_add_f32 v[236:237], v[236:237], v[212:213] op_sel:[0,0] op_sel_hi:[1,1]
    v_pk_add_f32 v[238:239], v[238:239], v[220:221] op_sel:[0,0] op_sel_hi:[1,1]
    v_pk_add_f32 v[224:225], v[224:225], v[166:167] op_sel:[0,0] op_sel_hi:[1,1]
    v_pk_add_f32 v[226:227], v[226:227], v[174:175] op_sel:[0,0] op_sel_hi:[1,1]
    v_pk_add_f32 v[228:229], v[228:229], v[182:183] op_sel:[0,0] op_sel_hi:[1,1]
    v_pk_add_f32 v[230:231], v[230:231], v[190:191] op_sel:[0,0] op_sel_hi:[1,1]
    v_pk_add_f32 v[232:233], v[232:233], v[198:199] op_sel:[0,0] op_sel_hi:[1,1]
    v_pk_add_f32 v[234:235], v[234:235], v[206:207] op_sel:[0,0] op_sel_hi:[1,1]
    v_pk_add_f32 v[236:237], v[236:237], v[214:215] op_sel:[0,0] op_sel_hi:[1,1]
    v_pk_add_f32 v[238:239], v[238:239], v[222:223] op_sel:[0,0] op_sel_hi:[1,1]
    v_add_f32 v224, v224, v225
    v_add_f32 v228, v228, v229
    v_add_f32 v232, v232, v233
    v_add_f32 v236, v236, v237
    v_add_f32 v225, v226, v227
    v_add_f32 v229, v230, v231
    v_add_f32 v233, v234, v235
    v_add_f32 v237, v238, v239
    v_permlane32_swap_b32 v224, v225
    v_permlane32_swap_b32 v228, v229
    v_permlane32_swap_b32 v232, v233
    v_permlane32_swap_b32 v236, v237
    v_add_f32 v224, v224, v225
    v_add_f32 v228, v228, v229
    v_add_f32 v232, v232, v233
    v_add_f32 v236, v236, v237
    v_mov_b32 v225, v224
    v_mov_b32 v229, v228
    v_mov_b32 v233, v232
    v_mov_b32 v237, v236
    v_permlane16_swap_b32 v224, v225
    v_permlane16_swap_b32 v228, v229
    v_permlane16_swap_b32 v232, v233
    v_permlane16_swap_b32 v236, v237
    v_add_f32 v224, v224, v225
    v_add_f32 v228, v228, v229
    v_add_f32 v232, v232, v233
    v_add_f32 v236, v236, v237
    v_mov_b32 v226, v224
    v_mov_b32 v230, v228
    v_mov_b32 v234, v232
    v_mov_b32 v238, v236
    v_permlane32_swap_b32 v224, v226
    v_permlane32_swap_b32 v228, v230
    v_permlane32_swap_b32 v232, v234
    v_permlane32_swap_b32 v236, v238
    v_rcp_f32 v224, v224
    v_rcp_f32 v226, v226
    v_rcp_f32 v228, v228
    v_rcp_f32 v230, v230
    v_rcp_f32 v232, v232
    v_rcp_f32 v234, v234
    v_rcp_f32 v236, v236
    v_rcp_f32 v238, v238
    v_pk_mul_f32 v[160:161], v[160:161], v[224:225] op_sel:[0,0] op_sel_hi:[1,0]
    v_pk_mul_f32 v[162:163], v[162:163], v[224:225] op_sel:[0,0] op_sel_hi:[1,0]
    v_pk_mul_f32 v[164:165], v[164:165], v[224:225] op_sel:[0,0] op_sel_hi:[1,0]
    v_pk_mul_f32 v[166:167], v[166:167], v[224:225] op_sel:[0,0] op_sel_hi:[1,0]
    v_pk_mul_f32 v[168:169], v[168:169], v[226:227] op_sel:[0,0] op_sel_hi:[1,0]
    v_pk_mul_f32 v[170:171], v[170:171], v[226:227] op_sel:[0,0] op_sel_hi:[1,0]
    v_pk_mul_f32 v[172:173], v[172:173], v[226:227] op_sel:[0,0] op_sel_hi:[1,0]
    v_pk_mul_f32 v[174:175], v[174:175], v[226:227] op_sel:[0,0] op_sel_hi:[1,0]
    v_cvt_pk_bf16_f32 v48, v160, v161
    v_cvt_pk_bf16_f32 v49, v162, v163
    v_cvt_pk_bf16_f32 v50, v164, v165
    v_cvt_pk_bf16_f32 v51, v166, v167
    v_cvt_pk_bf16_f32 v80, v168, v169
    v_cvt_pk_bf16_f32 v81, v170, v171
    v_cvt_pk_bf16_f32 v82, v172, v173
    v_cvt_pk_bf16_f32 v83, v174, v175
    v_pk_mul_f32 v[176:177], v[176:177], v[228:229] op_sel:[0,0] op_sel_hi:[1,0]
    v_pk_mul_f32 v[178:179], v[178:179], v[228:229] op_sel:[0,0] op_sel_hi:[1,0]
    v_pk_mul_f32 v[180:181], v[180:181], v[228:229] op_sel:[0,0] op_sel_hi:[1,0]
    v_pk_mul_f32 v[182:183], v[182:183], v[228:229] op_sel:[0,0] op_sel_hi:[1,0]
    v_pk_mul_f32 v[184:185], v[184:185], v[230:231] op_sel:[0,0] op_sel_hi:[1,0]
    v_pk_mul_f32 v[186:187], v[186:187], v[230:231] op_sel:[0,0] op_sel_hi:[1,0]
    v_pk_mul_f32 v[188:189], v[188:189], v[230:231] op_sel:[0,0] op_sel_hi:[1,0]
    v_pk_mul_f32 v[190:191], v[190:191], v[230:231] op_sel:[0,0] op_sel_hi:[1,0]
    v_cvt_pk_bf16_f32 v52, v176, v177
    v_cvt_pk_bf16_f32 v53, v178, v179
    v_cvt_pk_bf16_f32 v54, v180, v181
    v_cvt_pk_bf16_f32 v55, v182, v183
    v_cvt_pk_bf16_f32 v84, v184, v185
    v_cvt_pk_bf16_f32 v85, v186, v187
    v_cvt_pk_bf16_f32 v86, v188, v189
    v_cvt_pk_bf16_f32 v87, v190, v191
    v_pk_mul_f32 v[192:193], v[192:193], v[232:233] op_sel:[0,0] op_sel_hi:[1,0]
    v_pk_mul_f32 v[194:195], v[194:195], v[232:233] op_sel:[0,0] op_sel_hi:[1,0]
    v_pk_mul_f32 v[196:197], v[196:197], v[232:233] op_sel:[0,0] op_sel_hi:[1,0]
    v_pk_mul_f32 v[198:199], v[198:199], v[232:233] op_sel:[0,0] op_sel_hi:[1,0]
    v_pk_mul_f32 v[200:201], v[200:201], v[234:235] op_sel:[0,0] op_sel_hi:[1,0]
    v_pk_mul_f32 v[202:203], v[202:203], v[234:235] op_sel:[0,0] op_sel_hi:[1,0]
    v_pk_mul_f32 v[204:205], v[204:205], v[234:235] op_sel:[0,0] op_sel_hi:[1,0]
    v_pk_mul_f32 v[206:207], v[206:207], v[234:235] op_sel:[0,0] op_sel_hi:[1,0]
    v_cvt_pk_bf16_f32 v56, v192, v193
    v_cvt_pk_bf16_f32 v57, v194, v195
    v_cvt_pk_bf16_f32 v58, v196, v197
    v_cvt_pk_bf16_f32 v59, v198, v199
    v_cvt_pk_bf16_f32 v88, v200, v201
    v_cvt_pk_bf16_f32 v89, v202, v203
    v_cvt_pk_bf16_f32 v90, v204, v205
    v_cvt_pk_bf16_f32 v91, v206, v207
    v_pk_mul_f32 v[208:209], v[208:209], v[236:237] op_sel:[0,0] op_sel_hi:[1,0]
    v_pk_mul_f32 v[210:211], v[210:211], v[236:237] op_sel:[0,0] op_sel_hi:[1,0]
    v_pk_mul_f32 v[212:213], v[212:213], v[236:237] op_sel:[0,0] op_sel_hi:[1,0]
    v_pk_mul_f32 v[214:215], v[214:215], v[236:237] op_sel:[0,0] op_sel_hi:[1,0]
    v_pk_mul_f32 v[216:217], v[216:217], v[238:239] op_sel:[0,0] op_sel_hi:[1,0]
    v_pk_mul_f32 v[218:219], v[218:219], v[238:239] op_sel:[0,0] op_sel_hi:[1,0]
    v_pk_mul_f32 v[220:221], v[220:221], v[238:239] op_sel:[0,0] op_sel_hi:[1,0]
    v_pk_mul_f32 v[222:223], v[222:223], v[238:239] op_sel:[0,0] op_sel_hi:[1,0]
    v_cvt_pk_bf16_f32 v60, v208, v209
    v_cvt_pk_bf16_f32 v61, v210, v211
    v_cvt_pk_bf16_f32 v62, v212, v213
    v_cvt_pk_bf16_f32 v63, v214, v215
    v_cvt_pk_bf16_f32 v92, v216, v217
    v_cvt_pk_bf16_f32 v93, v218, v219
    v_cvt_pk_bf16_f32 v94, v220, v221
    v_cvt_pk_bf16_f32 v95, v222, v223
    s_cmp_lg_u32 s18, 0
    s_cbranch_scc1 P1_kv_ok
    s_waitcnt vmcnt(0)
    v_readfirstlane_b32 s45, v30
    s_nop 1
    s_cmp_ge_u32 s45, 8
    s_cbranch_scc0 P1_kv_slow
P1_kv_ok:
    s_waitcnt vmcnt(0)
    s_barrier
    s_lshl_b32 s40, s22, 5
    s_add_u32 s40, s40, s18
    s_lshl_b32 s41, s40, 11
    s_add_u32 s41, s41, 25165824
    s_lshl_b32 s40, s40, 7
    s_add_u32 s40, s40, 28311552
    v_lshrrev_b32 v8, 3, v1
    v_and_b32 v9, 7, v1
    v_lshlrev_b32 v8, 9, v8
    v_lshl_add_u32 v8, v9, 4, v8
    buffer_load_dwordx4 v[224:227], v8, s[12:15], s40 offen sc1
    s_lshl_b32 s40, s20, 12
    s_add_u32 s40, s40, 140000
    s_lshl_b32 s44, s19, 10
    s_add_u32 s44, s40, s44
    v_add_u32 v30, s44, v6
    v_add_u32 v31, s40, v6
    s_lshl_b32 s40, s20, 7
    s_add_u32 s40, s40, 148192
    s_lshl_b32 s44, s19, 6
    s_add_u32 s44, s44, s40
    v_lshl_add_u32 v9, v9, 3, s44
    v_lshl_add_u32 v29, v29, 3, s40
    buffer_load_dwordx4 v[128:131], v6, s[12:15], s41 offen offset:0 sc1
    buffer_load_dwordx4 v[132:135], v6, s[12:15], s41 offen offset:1024 sc1
    s_add_u32 s41, s41, 8192
    buffer_load_dwordx4 v[136:139], v6, s[12:15], s41 offen offset:0 sc1
    buffer_load_dwordx4 v[140:143], v6, s[12:15], s41 offen offset:1024 sc1
    s_add_u32 s41, s41, 8192
    buffer_load_dwordx4 v[144:147], v6, s[12:15], s41 offen offset:0 sc1
    buffer_load_dwordx4 v[148:151], v6, s[12:15], s41 offen offset:1024 sc1
    s_add_u32 s41, s41, 8192
    buffer_load_dwordx4 v[152:155], v6, s[12:15], s41 offen offset:0 sc1
    buffer_load_dwordx4 v[156:159], v6, s[12:15], s41 offen offset:1024 sc1
    s_add_u32 s41, s41, 8192
    buffer_load_dwordx4 v[160:163], v6, s[12:15], s41 offen offset:0 sc1
    buffer_load_dwordx4 v[164:167], v6, s[12:15], s41 offen offset:1024 sc1
    s_add_u32 s41, s41, 8192
    buffer_load_dwordx4 v[168:171], v6, s[12:15], s41 offen offset:0 sc1
    buffer_load_dwordx4 v[172:175], v6, s[12:15], s41 offen offset:1024 sc1
    s_add_u32 s41, s41, 8192
    buffer_load_dwordx4 v[176:179], v6, s[12:15], s41 offen offset:0 sc1
    buffer_load_dwordx4 v[180:183], v6, s[12:15], s41 offen offset:1024 sc1
    s_add_u32 s41, s41, 8192
    buffer_load_dwordx4 v[184:187], v6, s[12:15], s41 offen offset:0 sc1
    buffer_load_dwordx4 v[188:191], v6, s[12:15], s41 offen offset:1024 sc1
    s_add_u32 s40, s25, 6144
    v_mov_b32 v11, s40
    global_load_dword v12, v11, s[16:17] sc1
    s_waitcnt vmcnt(17)
    v_add_f32_dpp v224, v224, v224 row_ror:8 row_mask:0xf bank_mask:0xf
    v_add_f32_dpp v225, v225, v225 row_ror:8 row_mask:0xf bank_mask:0xf
    v_add_f32_dpp v226, v226, v226 row_ror:8 row_mask:0xf bank_mask:0xf
    v_add_f32_dpp v227, v227, v227 row_ror:8 row_mask:0xf bank_mask:0xf
    v_mov_b32 v228, v224
    v_mov_b32 v229, v225
    v_mov_b32 v230, v226
    v_mov_b32 v231, v227
    v_permlane16_swap_b32 v224, v228
    v_permlane16_swap_b32 v225, v229
    v_permlane16_swap_b32 v226, v230
    v_permlane16_swap_b32 v227, v231
    v_add_f32 v224, v224, v228
    v_add_f32 v225, v225, v229
    v_add_f32 v226, v226, v230
    v_add_f32 v227, v227, v231
    v_mov_b32 v228, v224
    v_mov_b32 v229, v225
    v_mov_b32 v230, v226
    v_mov_b32 v231, v227
    v_permlane32_swap_b32 v224, v228
    v_permlane32_swap_b32 v225, v229
    v_permlane32_swap_b32 v226, v230
    v_permlane32_swap_b32 v227, v231
    v_add_f32 v224, v224, v228
    v_add_f32 v225, v225, v229
    v_add_f32 v226, v226, v230
    v_add_f32 v227, v227, v231
    v_cvt_pk_bf16_f32 v228, v224, v225
    v_cvt_pk_bf16_f32 v229, v226, v227
    ds_write_b64 v9, v[228:229]
    s_waitcnt vmcnt(15)
    v_lshlrev_b32 v96, 16, v128
    v_and_b32 v97, 0xffff0000, v128
    v_lshlrev_b32 v98, 16, v129
    v_and_b32 v99, 0xffff0000, v129
    v_lshlrev_b32 v100, 16, v130
    v_and_b32 v101, 0xffff0000, v130
    v_lshlrev_b32 v102, 16, v131
    v_and_b32 v103, 0xffff0000, v131
    v_lshlrev_b32 v104, 16, v132
    v_and_b32 v105, 0xffff0000, v132
    v_lshlrev_b32 v106, 16, v133
    v_and_b32 v107, 0xffff0000, v133
    v_lshlrev_b32 v108, 16, v134
    v_and_b32 v109, 0xffff0000, v134
    v_lshlrev_b32 v110, 16, v135
    v_and_b32 v111, 0xffff0000, v135
    s_waitcnt vmcnt(13)
    v_lshlrev_b32 v112, 16, v136
    v_and_b32 v113, 0xffff0000, v136
    v_lshlrev_b32 v114, 16, v137
    v_and_b32 v115, 0xffff0000, v137
    v_lshlrev_b32 v116, 16, v138
    v_and_b32 v117, 0xffff0000, v138
    v_lshlrev_b32 v118, 16, v139
    v_and_b32 v119, 0xffff0000, v139
    v_lshlrev_b32 v120, 16, v140
    v_and_b32 v121, 0xffff0000, v140
    v_lshlrev_b32 v122, 16, v141
    v_and_b32 v123, 0xffff0000, v141
    v_lshlrev_b32 v124, 16, v142
    v_and_b32 v125, 0xffff0000, v142
    v_lshlrev_b32 v126, 16, v143
    v_and_b32 v127, 0xffff0000, v143
    v_pk_add_f32 v[96:97], v[96:97], v[112:113] op_sel:[0,0] op_sel_hi:[1,1]
    v_pk_add_f32 v[98:99], v[98:99], v[114:115] op_sel:[0,0] op_sel_hi:[1,1]
    v_pk_add_f32 v[100:101], v[100:101], v[116:117] op_sel:[0,0] op_sel_hi:[1,1]
    v_pk_add_f32 v[102:103], v[102:103], v[118:119] op_sel:[0,0] op_sel_hi:[1,1]
    v_pk_add_f32 v[104:105], v[104:105], v[120:121] op_sel:[0,0] op_sel_hi:[1,1]
    v_pk_add_f32 v[106:107], v[106:107], v[122:123] op_sel:[0,0] op_sel_hi:[1,1]
    v_pk_add_f32 v[108:109], v[108:109], v[124:125] op_sel:[0,0] op_sel_hi:[1,1]
    v_pk_add_f32 v[110:111], v[110:111], v[126:127] op_sel:[0,0] op_sel_hi:[1,1]
    s_waitcnt vmcnt(11)
    v_lshlrev_b32 v112, 16, v144
    v_and_b32 v113, 0xffff0000, v144
    v_lshlrev_b32 v114, 16, v145
    v_and_b32 v115, 0xffff0000, v145
    v_lshlrev_b32 v116, 16, v146
    v_and_b32 v117, 0xffff0000, v146
    v_lshlrev_b32 v118, 16, v147
    v_and_b32 v119, 0xffff0000, v147
    v_lshlrev_b32 v120, 16, v148
    v_and_b32 v121, 0xffff0000, v148
    v_lshlrev_b32 v122, 16, v149
    v_and_b32 v123, 0xffff0000, v149
    v_lshlrev_b32 v124, 16, v150
    v_and_b32 v125, 0xffff0000, v150
    v_lshlrev_b32 v126, 16, v151
    v_and_b32 v127, 0xffff0000, v151
    v_pk_add_f32 v[96:97], v[96:97], v[112:113] op_sel:[0,0] op_sel_hi:[1,1]
    v_pk_add_f32 v[98:99], v[98:99], v[114:115] op_sel:[0,0] op_sel_hi:[1,1]
    v_pk_add_f32 v[100:101], v[100:101], v[116:117] op_sel:[0,0] op_sel_hi:[1,1]
    v_pk_add_f32 v[102:103], v[102:103], v[118:119] op_sel:[0,0] op_sel_hi:[1,1]
    v_pk_add_f32 v[104:105], v[104:105], v[120:121] op_sel:[0,0] op_sel_hi:[1,1]
    v_pk_add_f32 v[106:107], v[106:107], v[122:123] op_sel:[0,0] op_sel_hi:[1,1]
    v_pk_add_f32 v[108:109], v[108:109], v[124:125] op_sel:[0,0] op_sel_hi:[1,1]
    v_pk_add_f32 v[110:111], v[110:111], v[126:127] op_sel:[0,0] op_sel_hi:[1,1]
    s_waitcnt vmcnt(9)
    v_lshlrev_b32 v112, 16, v152
    v_and_b32 v113, 0xffff0000, v152
    v_lshlrev_b32 v114, 16, v153
    v_and_b32 v115, 0xffff0000, v153
    v_lshlrev_b32 v116, 16, v154
    v_and_b32 v117, 0xffff0000, v154
    v_lshlrev_b32 v118, 16, v155
    v_and_b32 v119, 0xffff0000, v155
    v_lshlrev_b32 v120, 16, v156
    v_and_b32 v121, 0xffff0000, v156
    v_lshlrev_b32 v122, 16, v157
    v_and_b32 v123, 0xffff0000, v157
    v_lshlrev_b32 v124, 16, v158
    v_and_b32 v125, 0xffff0000, v158
    v_lshlrev_b32 v126, 16, v159
    v_and_b32 v127, 0xffff0000, v159
    v_pk_add_f32 v[96:97], v[96:97], v[112:113] op_sel:[0,0] op_sel_hi:[1,1]
    v_pk_add_f32 v[98:99], v[98:99], v[114:115] op_sel:[0,0] op_sel_hi:[1,1]
    v_pk_add_f32 v[100:101], v[100:101], v[116:117] op_sel:[0,0] op_sel_hi:[1,1]
    v_pk_add_f32 v[102:103], v[102:103], v[118:119] op_sel:[0,0] op_sel_hi:[1,1]
    v_pk_add_f32 v[104:105], v[104:105], v[120:121] op_sel:[0,0] op_sel_hi:[1,1]
    v_pk_add_f32 v[106:107], v[106:107], v[122:123] op_sel:[0,0] op_sel_hi:[1,1]
    v_pk_add_f32 v[108:109], v[108:109], v[124:125] op_sel:[0,0] op_sel_hi:[1,1]
    v_pk_add_f32 v[110:111], v[110:111], v[126:127] op_sel:[0,0] op_sel_hi:[1,1]
    s_waitcnt vmcnt(7)
    v_lshlrev_b32 v112, 16, v160
    v_and_b32 v113, 0xffff0000, v160
    v_lshlrev_b32 v114, 16, v161
    v_and_b32 v115, 0xffff0000, v161
    v_lshlrev_b32 v116, 16, v162
    v_and_b32 v117, 0xffff0000, v162
    v_lshlrev_b32 v118, 16, v163
    v_and_b32 v119, 0xffff0000, v163
    v_lshlrev_b32 v120, 16, v164
    v_and_b32 v121, 0xffff0000, v164
    v_lshlrev_b32 v122, 16, v165
    v_and_b32 v123, 0xffff0000, v165
    v_lshlrev_b32 v124, 16, v166
    v_and_b32 v125, 0xffff0000, v166
    v_lshlrev_b32 v126, 16, v167
    v_and_b32 v127, 0xffff0000, v167
    v_pk_add_f32 v[96:97], v[96:97], v[112:113] op_sel:[0,0] op_sel_hi:[1,1]
    v_pk_add_f32 v[98:99], v[98:99], v[114:115] op_sel:[0,0] op_sel_hi:[1,1]
    v_pk_add_f32 v[100:101], v[100:101], v[116:117] op_sel:[0,0] op_sel_hi:[1,1]
    v_pk_add_f32 v[102:103], v[102:103], v[118:119] op_sel:[0,0] op_sel_hi:[1,1]
    v_pk_add_f32 v[104:105], v[104:105], v[120:121] op_sel:[0,0] op_sel_hi:[1,1]
    v_pk_add_f32 v[106:107], v[106:107], v[122:123] op_sel:[0,0] op_sel_hi:[1,1]
    v_pk_add_f32 v[108:109], v[108:109], v[124:125] op_sel:[0,0] op_sel_hi:[1,1]
    v_pk_add_f32 v[110:111], v[110:111], v[126:127] op_sel:[0,0] op_sel_hi:[1,1]
    s_waitcnt vmcnt(5)
    v_lshlrev_b32 v112, 16, v168
    v_and_b32 v113, 0xffff0000, v168
    v_lshlrev_b32 v114, 16, v169
    v_and_b32 v115, 0xffff0000, v169
    v_lshlrev_b32 v116, 16, v170
    v_and_b32 v117, 0xffff0000, v170
    v_lshlrev_b32 v118, 16, v171
    v_and_b32 v119, 0xffff0000, v171
    v_lshlrev_b32 v120, 16, v172
    v_and_b32 v121, 0xffff0000, v172
    v_lshlrev_b32 v122, 16, v173
    v_and_b32 v123, 0xffff0000, v173
    v_lshlrev_b32 v124, 16, v174
    v_and_b32 v125, 0xffff0000, v174
    v_lshlrev_b32 v126, 16, v175
    v_and_b32 v127, 0xffff0000, v175
    v_pk_add_f32 v[96:97], v[96:97], v[112:113] op_sel:[0,0] op_sel_hi:[1,1]
    v_pk_add_f32 v[98:99], v[98:99], v[114:115] op_sel:[0,0] op_sel_hi:[1,1]
    v_pk_add_f32 v[100:101], v[100:101], v[116:117] op_sel:[0,0] op_sel_hi:[1,1]
    v_pk_add_f32 v[102:103], v[102:103], v[118:119] op_sel:[0,0] op_sel_hi:[1,1]
    v_pk_add_f32 v[104:105], v[104:105], v[120:121] op_sel:[0,0] op_sel_hi:[1,1]
    v_pk_add_f32 v[106:107], v[106:107], v[122:123] op_sel:[0,0] op_sel_hi:[1,1]
    v_pk_add_f32 v[108:109], v[108:109], v[124:125] op_sel:[0,0] op_sel_hi:[1,1]
    v_pk_add_f32 v[110:111], v[110:111], v[126:127] op_sel:[0,0] op_sel_hi:[1,1]
    s_waitcnt vmcnt(3)
    v_lshlrev_b32 v112, 16, v176
    v_and_b32 v113, 0xffff0000, v176
    v_lshlrev_b32 v114, 16, v177
    v_and_b32 v115, 0xffff0000, v177
    v_lshlrev_b32 v116, 16, v178
    v_and_b32 v117, 0xffff0000, v178
    v_lshlrev_b32 v118, 16, v179
    v_and_b32 v119, 0xffff0000, v179
    v_lshlrev_b32 v120, 16, v180
    v_and_b32 v121, 0xffff0000, v180
    v_lshlrev_b32 v122, 16, v181
    v_and_b32 v123, 0xffff0000, v181
    v_lshlrev_b32 v124, 16, v182
    v_and_b32 v125, 0xffff0000, v182
    v_lshlrev_b32 v126, 16, v183
    v_and_b32 v127, 0xffff0000, v183
    v_pk_add_f32 v[96:97], v[96:97], v[112:113] op_sel:[0,0] op_sel_hi:[1,1]
    v_pk_add_f32 v[98:99], v[98:99], v[114:115] op_sel:[0,0] op_sel_hi:[1,1]
    v_pk_add_f32 v[100:101], v[100:101], v[116:117] op_sel:[0,0] op_sel_hi:[1,1]
    v_pk_add_f32 v[102:103], v[102:103], v[118:119] op_sel:[0,0] op_sel_hi:[1,1]
    v_pk_add_f32 v[104:105], v[104:105], v[120:121] op_sel:[0,0] op_sel_hi:[1,1]
    v_pk_add_f32 v[106:107], v[106:107], v[122:123] op_sel:[0,0] op_sel_hi:[1,1]
    v_pk_add_f32 v[108:109], v[108:109], v[124:125] op_sel:[0,0] op_sel_hi:[1,1]
    v_pk_add_f32 v[110:111], v[110:111], v[126:127] op_sel:[0,0] op_sel_hi:[1,1]
    s_waitcnt vmcnt(1)
    v_lshlrev_b32 v112, 16, v184
    v_and_b32 v113, 0xffff0000, v184
    v_lshlrev_b32 v114, 16, v185
    v_and_b32 v115, 0xffff0000, v185
    v_lshlrev_b32 v116, 16, v186
    v_and_b32 v117, 0xffff0000, v186
    v_lshlrev_b32 v118, 16, v187
    v_and_b32 v119, 0xffff0000, v187
    v_lshlrev_b32 v120, 16, v188
    v_and_b32 v121, 0xffff0000, v188
    v_lshlrev_b32 v122, 16, v189
    v_and_b32 v123, 0xffff0000, v189
    v_lshlrev_b32 v124, 16, v190
    v_and_b32 v125, 0xffff0000, v190
    v_lshlrev_b32 v126, 16, v191
    v_and_b32 v127, 0xffff0000, v191
    v_pk_add_f32 v[96:97], v[96:97], v[112:113] op_sel:[0,0] op_sel_hi:[1,1]
    v_pk_add_f32 v[98:99], v[98:99], v[114:115] op_sel:[0,0] op_sel_hi:[1,1]
    v_pk_add_f32 v[100:101], v[100:101], v[116:117] op_sel:[0,0] op_sel_hi:[1,1]
    v_pk_add_f32 v[102:103], v[102:103], v[118:119] op_sel:[0,0] op_sel_hi:[1,1]
    v_pk_add_f32 v[104:105], v[104:105], v[120:121] op_sel:[0,0] op_sel_hi:[1,1]
    v_pk_add_f32 v[106:107], v[106:107], v[122:123] op_sel:[0,0] op_sel_hi:[1,1]
    v_pk_add_f32 v[108:109], v[108:109], v[124:125] op_sel:[0,0] op_sel_hi:[1,1]
    v_pk_add_f32 v[110:111], v[110:111], v[126:127] op_sel:[0,0] op_sel_hi:[1,1]
    v_cvt_pk_bf16_f32 v232, v96, v97
    v_cvt_pk_bf16_f32 v233, v98, v99
    v_cvt_pk_bf16_f32 v234, v100, v101
    v_cvt_pk_bf16_f32 v235, v102, v103
    ds_write_b128 v30, v[232:235] offset:0
    v_cvt_pk_bf16_f32 v236, v104, v105
    v_cvt_pk_bf16_f32 v237, v106, v107
    v_cvt_pk_bf16_f32 v238, v108, v109
    v_cvt_pk_bf16_f32 v239, v110, v111
    ds_write_b128 v30, v[236:239] offset:2048
    s_waitcnt lgkmcnt(0)
    s_barrier
    ds_read_b128 v[224:227], v31 offset:0
    ds_read_b128 v[228:231], v31 offset:1024
    ds_read_b128 v[232:235], v31 offset:2048
    ds_read_b128 v[236:239], v31 offset:3072
    ds_read_b64 v[240:241], v29 offset:0
    ds_read_b64 v[242:243], v29 offset:32
    ds_read_b64 v[244:245], v29 offset:64
    ds_read_b64 v[246:247], v29 offset:96
    s_mul_i32 s26, s3, 294912
    s_add_u32 s36, s36, s26
    s_lshl_b32 s43, s26, 1
    s_sub_u32 s43, 294912, s43
    s_waitcnt vmcnt(0)
    v_readfirstlane_b32 s28, v12
    s_nop 1
    s_cmp_ge_u32 s28, 16
    s_cbranch_scc0 P1_late
    s_add_u32 s42, s36, s43
    buffer_load_dwordx4 a[224:227], v2, s[4:7], s36 offen offset:0 sc1
    buffer_load_dwordx4 a[228:231], v3, s[4:7], s36 offen offset:0 sc1
    buffer_load_dwordx4 a[232:235], v2, s[4:7], s42 offen offset:0 sc1
    buffer_load_dwordx4 a[236:239], v3, s[4:7], s42 offen offset:0 sc1
    buffer_load_dwordx4 a[240:243], v2, s[4:7], s36 offen offset:1024 sc1
    buffer_load_dwordx4 a[244:247], v3, s[4:7], s36 offen offset:1024 sc1
    buffer_load_dwordx4 a[248:251], v2, s[4:7], s42 offen offset:1024 sc1
    buffer_load_dwordx4 a[252:255], v3, s[4:7], s42 offen offset:1024 sc1
    s_add_u32 s36, s36, 2048
    s_add_u32 s42, s36, s43
    buffer_load_dwordx4 a[128:131], v2, s[4:7], s36 offen offset:0 sc1
    buffer_load_dwordx4 a[132:135], v3, s[4:7], s36 offen offset:0 sc1
    buffer_load_dwordx4 a[136:139], v2, s[4:7], s42 offen offset:0 sc1
    buffer_load_dwordx4 a[140:143], v3, s[4:7], s42 offen offset:0 sc1
    buffer_load_dwordx4 a[144:147], v2, s[4:7], s36 offen offset:1024 sc1
    buffer_load_dwordx4 a[148:151], v3, s[4:7], s36 offen offset:1024 sc1
    buffer_load_dwordx4 a[152:155], v2, s[4:7], s42 offen offset:1024 sc1
    buffer_load_dwordx4 a[156:159], v3, s[4:7], s42 offen offset:1024 sc1
    s_add_u32 s36, s36, 2048
P1_late:
    s_lshl_b32 s40, s21, 4
    s_lshl_b32 s41, s19, 3
    s_add_u32 s40, s40, s41
    s_mul_i32 s40, s40, 144
    s_lshl_b32 s41, s22, 1
    s_add_u32 s40, s40, s41
    s_add_u32 s40, s40, s20
    s_add_u32 s40, s40, 112
    s_lshl_b32 s40, s40, 10
    s_add_u32 s40, s40, 4194304
    s_mov_b32 s41, 897988541
    s_waitcnt lgkmcnt(0)
    v_mfma_f32_16x16x32_bf16 v[96:99], v[224:227], v[32:35], 0
    ds_read_b64_tr_b16 a[64:65], v7 offset:50688
    v_mfma_f32_16x16x32_bf16 v[100:103], v[232:235], v[32:35], 0
    ds_read_b64_tr_b16 a[66:67], v7 offset:51200
    v_mfma_f32_16x16x32_bf16 v[104:107], v[240:243], v[32:35], 0
    ds_read_b64_tr_b16 a[68:69], v7 offset:50720
    v_mfma_f32_16x16x32_bf16 v[108:111], v[224:227], v[36:39], 0
    ds_read_b64_tr_b16 a[70:71], v7 offset:51232
    v_mfma_f32_16x16x32_bf16 v[112:115], v[232:235], v[36:39], 0
    v_mfma_f32_16x16x32_bf16 v[116:119], v[240:243], v[36:39], 0
    ds_read_b64_tr_b16 a[72:73], v7 offset:50752
    v_mfma_f32_16x16x32_bf16 v[120:123], v[224:227], v[40:43], 0
    ds_read_b64_tr_b16 a[74:75], v7 offset:51264
    v_mfma_f32_16x16x32_bf16 v[124:127], v[232:235], v[40:43], 0
    ds_read_b64_tr_b16 a[76:77], v7 offset:50784
    v_mfma_f32_16x16x32_bf16 v[128:131], v[240:243], v[40:43], 0
    ds_read_b64_tr_b16 a[78:79], v7 offset:51296
    v_mfma_f32_16x16x32_bf16 v[132:135], v[224:227], v[44:47], 0
    v_mfma_f32_16x16x32_bf16 v[136:139], v[232:235], v[44:47], 0
    ds_read_b64_tr_b16 a[80:81], v7 offset:50816
    v_mfma_f32_16x16x32_bf16 v[140:143], v[240:243], v[44:47], 0
    ds_read_b64_tr_b16 a[82:83], v7 offset:51328
    v_mfma_f32_16x16x32_bf16 v[144:147], v[224:227], v[48:51], 0
    ds_read_b64_tr_b16 a[84:85], v7 offset:50848
    v_mfma_f32_16x16x32_bf16 v[148:151], v[232:235], v[48:51], 0
    ds_read_b64_tr_b16 a[86:87], v7 offset:51360
    v_mfma_f32_16x16x32_bf16 v[152:155], v[240:243], v[48:51], 0
    v_mfma_f32_16x16x32_bf16 v[156:159], v[224:227], v[52:55], 0
    ds_read_b64_tr_b16 a[88:89], v7 offset:50880
    v_mfma_f32_16x16x32_bf16 v[160:163], v[232:235], v[52:55], 0
    ds_read_b64_tr_b16 a[90:91], v7 offset:51392
    v_mfma_f32_16x16x32_bf16 v[164:167], v[240:243], v[52:55], 0
    ds_read_b64_tr_b16 a[92:93], v7 offset:50912
    v_mfma_f32_16x16x32_bf16 v[168:171], v[224:227], v[56:59], 0
    ds_read_b64_tr_b16 a[94:95], v7 offset:51424
    v_mfma_f32_16x16x32_bf16 v[172:175], v[232:235], v[56:59], 0
    v_mfma_f32_16x16x32_bf16 v[176:179], v[240:243], v[56:59], 0
    ds_read_b64_tr_b16 a[96:97], v7 offset:59136
    v_mfma_f32_16x16x32_bf16 v[180:183], v[224:227], v[60:63], 0
    ds_read_b64_tr_b16 a[98:99], v7 offset:59648
    v_mfma_f32_16x16x32_bf16 v[184:187], v[232:235], v[60:63], 0
    ds_read_b64_tr_b16 a[100:101], v7 offset:59168
    v_mfma_f32_16x16x32_bf16 v[188:191], v[240:243], v[60:63], 0
    ds_read_b64_tr_b16 a[102:103], v7 offset:59680
    v_mfma_f32_16x16x32_bf16 v[96:99], v[228:231], v[64:67], v[96:99]
    v_mfma_f32_16x16x32_bf16 v[100:103], v[236:239], v[64:67], v[100:103]
    ds_read_b64_tr_b16 a[104:105], v7 offset:59200
    v_mfma_f32_16x16x32_bf16 v[104:107], v[244:247], v[64:67], v[104:107]
    ds_read_b64_tr_b16 a[106:107], v7 offset:59712
    v_mfma_f32_16x16x32_bf16 v[108:111], v[228:231], v[68:71], v[108:111]
    ds_read_b64_tr_b16 a[108:109], v7 offset:59232
    v_mfma_f32_16x16x32_bf16 v[112:115], v[236:239], v[68:71], v[112:115]
    ds_read_b64_tr_b16 a[110:111], v7 offset:59744
    v_mfma_f32_16x16x32_bf16 v[116:119], v[244:247], v[68:71], v[116:119]
    v_mfma_f32_16x16x32_bf16 v[120:123], v[228:231], v[72:75], v[120:123]
    ds_read_b64_tr_b16 a[112:113], v7 offset:59264
    v_mfma_f32_16x16x32_bf16 v[124:127], v[236:239], v[72:75], v[124:127]
    ds_read_b64_tr_b16 a[114:115], v7 offset:59776
    v_mfma_f32_16x16x32_bf16 v[128:131], v[244:247], v[72:75], v[128:131]
    ds_read_b64_tr_b16 a[116:117], v7 offset:59296
    v_mfma_f32_16x16x32_bf16 v[132:135], v[228:231], v[76:79], v[132:135]
    ds_read_b64_tr_b16 a[118:119], v7 offset:59808
    v_mfma_f32_16x16x32_bf16 v[136:139], v[236:239], v[76:79], v[136:139]
    v_mfma_f32_16x16x32_bf16 v[140:143], v[244:247], v[76:79], v[140:143]
    ds_read_b64_tr_b16 a[120:121], v7 offset:59328
    v_mfma_f32_16x16x32_bf16 v[144:147], v[228:231], v[80:83], v[144:147]
    ds_read_b64_tr_b16 a[122:123], v7 offset:59840
    v_mfma_f32_16x16x32_bf16 v[148:151], v[236:239], v[80:83], v[148:151]
    ds_read_b64_tr_b16 a[124:125], v7 offset:59360
    v_mfma_f32_16x16x32_bf16 v[152:155], v[244:247], v[80:83], v[152:155]
    ds_read_b64_tr_b16 a[126:127], v7 offset:59872
    v_mfma_f32_16x16x32_bf16 v[156:159], v[228:231], v[84:87], v[156:159]
    v_mfma_f32_16x16x32_bf16 v[160:163], v[236:239], v[84:87], v[160:163]
    v_mfma_f32_16x16x32_bf16 v[164:167], v[244:247], v[84:87], v[164:167]
    v_mfma_f32_16x16x32_bf16 v[168:171], v[228:231], v[88:91], v[168:171]
    v_mfma_f32_16x16x32_bf16 v[172:175], v[236:239], v[88:91], v[172:175]
    v_mfma_f32_16x16x32_bf16 v[176:179], v[244:247], v[88:91], v[176:179]
    v_mfma_f32_16x16x32_bf16 v[180:183], v[228:231], v[92:95], v[180:183]
    v_mfma_f32_16x16x32_bf16 v[184:187], v[236:239], v[92:95], v[184:187]
    v_mfma_f32_16x16x32_bf16 v[188:191], v[244:247], v[92:95], v[188:191]
    v_add_f32 v104, s41, v104
    v_add_f32 v116, s41, v116
    v_add_f32 v128, s41, v128
    v_add_f32 v140, s41, v140
    v_add_f32 v152, s41, v152
    v_add_f32 v164, s41, v164
    v_add_f32 v176, s41, v176
    s_nop 0
    v_add_f32 v188, s41, v188
    v_rcp_f32 v104, v104
    v_rcp_f32 v116, v116
    v_rcp_f32 v128, v128
    v_rcp_f32 v140, v140
    v_rcp_f32 v152, v152
    v_rcp_f32 v164, v164
    v_rcp_f32 v176, v176
    v_rcp_f32 v188, v188
    v_pk_mul_f32 v[96:97], v[96:97], v[104:105] op_sel:[0,0] op_sel_hi:[1,0]
    v_pk_mul_f32 v[98:99], v[98:99], v[104:105] op_sel:[0,0] op_sel_hi:[1,0]
    v_pk_mul_f32 v[100:101], v[100:101], v[104:105] op_sel:[0,0] op_sel_hi:[1,0]
    v_pk_mul_f32 v[102:103], v[102:103], v[104:105] op_sel:[0,0] op_sel_hi:[1,0]
    v_cvt_pk_bf16_f32 v32, v96, v97
    v_cvt_pk_bf16_f32 v33, v98, v99
    v_cvt_pk_bf16_f32 v34, v100, v101
    v_cvt_pk_bf16_f32 v35, v102, v103
    buffer_store_dwordx4 v[32:35], v6, s[12:15], s40 offen sc1
    s_add_u32 s40, s40, 147456
    v_pk_mul_f32 v[108:109], v[108:109], v[116:117] op_sel:[0,0] op_sel_hi:[1,0]
    v_pk_mul_f32 v[110:111], v[110:111], v[116:117] op_sel:[0,0] op_sel_hi:[1,0]
    v_pk_mul_f32 v[112:113], v[112:113], v[116:117] op_sel:[0,0] op_sel_hi:[1,0]
    v_pk_mul_f32 v[114:115], v[114:115], v[116:117] op_sel:[0,0] op_sel_hi:[1,0]
    v_cvt_pk_bf16_f32 v36, v108, v109
    v_cvt_pk_bf16_f32 v37, v110, v111
    v_cvt_pk_bf16_f32 v38, v112, v113
    v_cvt_pk_bf16_f32 v39, v114, v115
    buffer_store_dwordx4 v[36:39], v6, s[12:15], s40 offen sc1
    s_add_u32 s40, s40, 147456
    v_pk_mul_f32 v[120:121], v[120:121], v[128:129] op_sel:[0,0] op_sel_hi:[1,0]
    v_pk_mul_f32 v[122:123], v[122:123], v[128:129] op_sel:[0,0] op_sel_hi:[1,0]
    v_pk_mul_f32 v[124:125], v[124:125], v[128:129] op_sel:[0,0] op_sel_hi:[1,0]
    v_pk_mul_f32 v[126:127], v[126:127], v[128:129] op_sel:[0,0] op_sel_hi:[1,0]
    v_cvt_pk_bf16_f32 v40, v120, v121
    v_cvt_pk_bf16_f32 v41, v122, v123
    v_cvt_pk_bf16_f32 v42, v124, v125
    v_cvt_pk_bf16_f32 v43, v126, v127
    buffer_store_dwordx4 v[40:43], v6, s[12:15], s40 offen sc1
    s_add_u32 s40, s40, 147456
    v_pk_mul_f32 v[132:133], v[132:133], v[140:141] op_sel:[0,0] op_sel_hi:[1,0]
    v_pk_mul_f32 v[134:135], v[134:135], v[140:141] op_sel:[0,0] op_sel_hi:[1,0]
    v_pk_mul_f32 v[136:137], v[136:137], v[140:141] op_sel:[0,0] op_sel_hi:[1,0]
    v_pk_mul_f32 v[138:139], v[138:139], v[140:141] op_sel:[0,0] op_sel_hi:[1,0]
    v_cvt_pk_bf16_f32 v44, v132, v133
    v_cvt_pk_bf16_f32 v45, v134, v135
    v_cvt_pk_bf16_f32 v46, v136, v137
    v_cvt_pk_bf16_f32 v47, v138, v139
    buffer_store_dwordx4 v[44:47], v6, s[12:15], s40 offen sc1
    s_add_u32 s40, s40, 147456
    v_pk_mul_f32 v[144:145], v[144:145], v[152:153] op_sel:[0,0] op_sel_hi:[1,0]
    v_pk_mul_f32 v[146:147], v[146:147], v[152:153] op_sel:[0,0] op_sel_hi:[1,0]
    v_pk_mul_f32 v[148:149], v[148:149], v[152:153] op_sel:[0,0] op_sel_hi:[1,0]
    v_pk_mul_f32 v[150:151], v[150:151], v[152:153] op_sel:[0,0] op_sel_hi:[1,0]
    v_cvt_pk_bf16_f32 v48, v144, v145
    v_cvt_pk_bf16_f32 v49, v146, v147
    v_cvt_pk_bf16_f32 v50, v148, v149
    v_cvt_pk_bf16_f32 v51, v150, v151
    buffer_store_dwordx4 v[48:51], v6, s[12:15], s40 offen sc1
    s_add_u32 s40, s40, 147456
    v_pk_mul_f32 v[156:157], v[156:157], v[164:165] op_sel:[0,0] op_sel_hi:[1,0]
    v_pk_mul_f32 v[158:159], v[158:159], v[164:165] op_sel:[0,0] op_sel_hi:[1,0]
    v_pk_mul_f32 v[160:161], v[160:161], v[164:165] op_sel:[0,0] op_sel_hi:[1,0]
    v_pk_mul_f32 v[162:163], v[162:163], v[164:165] op_sel:[0,0] op_sel_hi:[1,0]
    v_cvt_pk_bf16_f32 v52, v156, v157
    v_cvt_pk_bf16_f32 v53, v158, v159
    v_cvt_pk_bf16_f32 v54, v160, v161
    v_cvt_pk_bf16_f32 v55, v162, v163
    buffer_store_dwordx4 v[52:55], v6, s[12:15], s40 offen sc1
    s_add_u32 s40, s40, 147456
    v_pk_mul_f32 v[168:169], v[168:169], v[176:177] op_sel:[0,0] op_sel_hi:[1,0]
    v_pk_mul_f32 v[170:171], v[170:171], v[176:177] op_sel:[0,0] op_sel_hi:[1,0]
    v_pk_mul_f32 v[172:173], v[172:173], v[176:177] op_sel:[0,0] op_sel_hi:[1,0]
    v_pk_mul_f32 v[174:175], v[174:175], v[176:177] op_sel:[0,0] op_sel_hi:[1,0]
    v_cvt_pk_bf16_f32 v56, v168, v169
    v_cvt_pk_bf16_f32 v57, v170, v171
    v_cvt_pk_bf16_f32 v58, v172, v173
    v_cvt_pk_bf16_f32 v59, v174, v175
    buffer_store_dwordx4 v[56:59], v6, s[12:15], s40 offen sc1
    s_add_u32 s40, s40, 147456
    v_pk_mul_f32 v[180:181], v[180:181], v[188:189] op_sel:[0,0] op_sel_hi:[1,0]
    v_pk_mul_f32 v[182:183], v[182:183], v[188:189] op_sel:[0,0] op_sel_hi:[1,0]
    v_pk_mul_f32 v[184:185], v[184:185], v[188:189] op_sel:[0,0] op_sel_hi:[1,0]
    v_pk_mul_f32 v[186:187], v[186:187], v[188:189] op_sel:[0,0] op_sel_hi:[1,0]
    v_cvt_pk_bf16_f32 v60, v180, v181
    v_cvt_pk_bf16_f32 v61, v182, v183
    v_cvt_pk_bf16_f32 v62, v184, v185
    v_cvt_pk_bf16_f32 v63, v186, v187
    buffer_store_dwordx4 v[60:63], v6, s[12:15], s40 offen sc1
    v_mov_b64 v[96:97], 0
    v_mov_b64 v[98:99], 0
    v_mov_b64 v[100:101], 0
    v_mov_b64 v[102:103], 0
    v_mov_b64 v[104:105], 0
    v_mov_b64 v[106:107], 0
    v_mov_b64 v[108:109], 0
    v_mov_b64 v[110:111], 0
    v_mov_b64 v[112:113], 0
    v_mov_b64 v[114:115], 0
    v_mov_b64 v[116:117], 0
    v_mov_b64 v[118:119], 0
    v_mov_b64 v[120:121], 0
    v_mov_b64 v[122:123], 0
    v_mov_b64 v[124:125], 0
    v_mov_b64 v[126:127], 0
    v_mov_b64 v[128:129], 0
    v_mov_b64 v[130:131], 0
    v_mov_b64 v[132:133], 0
    v_mov_b64 v[134:135], 0
    v_mov_b64 v[136:137], 0
    v_mov_b64 v[138:139], 0
    v_mov_b64 v[140:141], 0
    v_mov_b64 v[142:143], 0
    v_mov_b64 v[144:145], 0
    v_mov_b64 v[146:147], 0
    v_mov_b64 v[148:149], 0
    v_mov_b64 v[150:151], 0
    v_mov_b64 v[152:153], 0
    v_mov_b64 v[154:155], 0
    v_mov_b64 v[156:157], 0
    v_mov_b64 v[158:159], 0
    v_mov_b64 v[160:161], 0
    v_mov_b64 v[162:163], 0
    v_mov_b64 v[164:165], 0
    v_mov_b64 v[166:167], 0
    v_mov_b64 v[168:169], 0
    v_mov_b64 v[170:171], 0
    v_mov_b64 v[172:173], 0
    v_mov_b64 v[174:175], 0
    v_mov_b64 v[176:177], 0
    v_mov_b64 v[178:179], 0
    v_mov_b64 v[180:181], 0
    v_mov_b64 v[182:183], 0
    v_mov_b64 v[184:185], 0
    v_mov_b64 v[186:187], 0
    v_mov_b64 v[188:189], 0
    v_mov_b64 v[190:191], 0
    v_mov_b64 v[192:193], 0
    v_mov_b64 v[194:195], 0
    v_mov_b64 v[196:197], 0
    v_mov_b64 v[198:199], 0
    v_mov_b64 v[200:201], 0
    v_mov_b64 v[202:203], 0
    v_mov_b64 v[204:205], 0
    v_mov_b64 v[206:207], 0
    v_mov_b64 v[208:209], 0
    v_mov_b64 v[210:211], 0
    v_mov_b64 v[212:213], 0
    v_mov_b64 v[214:215], 0
    v_mov_b64 v[216:217], 0
    v_mov_b64 v[218:219], 0
    v_mov_b64 v[220:221], 0
    v_mov_b64 v[222:223], 0
    v_mov_b64 v[224:225], 0
    v_mov_b64 v[226:227], 0
    v_mov_b64 v[228:229], 0
    v_mov_b64 v[230:231], 0
    v_mov_b64 v[232:233], 0
    v_mov_b64 v[234:235], 0
    v_mov_b64 v[236:237], 0
    v_mov_b64 v[238:239], 0
    v_mov_b64 v[240:241], 0
    v_mov_b64 v[242:243], 0
    v_mov_b64 v[244:245], 0
    v_mov_b64 v[246:247], 0
    v_mov_b64 v[248:249], 0
    v_mov_b64 v[250:251], 0
    v_mov_b64 v[252:253], 0
    v_mov_b64 v[254:255], 0
    v_and_b32 v9, 15, v1
    v_lshrrev_b32 v10, 5, v1
    v_and_b32 v0, 7, v1
    v_xor_b32 v0, v0, v10
    v_lshlrev_b32 v0, 4, v0
    v_lshl_add_u32 v0, v9, 7, v0
    v_bfe_u32 v8, v1, 4, 1
    v_lshl_add_u32 v0, v8, 3, v0
    v_add_u32 v0, s37, v0
    v_lshlrev_b32 v9, 11, v9
    v_lshl_add_u32 v9, v8, 5, v9
    v_lshl_add_u32 v8, v10, 4, v9
    v_lshrrev_b32 v18, 3, v1
    v_lshlrev_b32 v18, 14, v18
    v_and_b32 v19, 7, v1
    v_lshl_add_u32 v18, v19, 4, v18
    s_lshl_b32 s40, s18, 12
    s_and_b32 s44, s32, 0x7ff
    s_add_u32 s40, s40, s44
    v_add_u32 v18, s40, v18
    v_lshlrev_b32 v20, 7, v10
    v_sub_u32 v20, v7, v20
    v_add_u32 v27, 1966080, v18
    v_add_u32 v28, 992, v27
    v_add_u32 v18, 524288, v18
    v_add_u32 v19, 992, v18
    v_add_u32 v29, 67584, v20
    v_add_u32 v30, 126720, v20
    s_add_u32 s46, s39, 67584
    s_mov_b32 s92, s54
    s_and_b32 s93, s55, 0xffff
    s_mov_b32 s94, 1966080
    s_mov_b32 s95, 0x20000
    s_lshl_b32 s40, s100, 3
    s_add_u32 s40, s40, s101
    s_add_u32 s41, s40, 48
    s_lshl_b32 s41, s41, 8
    s_lshl_b32 s40, s40, 2
    s_lshl_b32 s44, s23, 1
    s_add_u32 s40, s40, s44
    s_add_u32 s40, s40, s3
    s_lshl_b32 s45, s18, 12
    s_add_u32 s45, s45, 29360128
    s_mul_i32 s38, s40, 49152
    s_add_u32 s38, s38, s45
    s_xor_b32 s44, s40, 1
    s_mul_i32 s44, s44, 49152
    s_add_u32 s44, s44, s45
    s_add_u32 s44, s44, 0
    v_add_u32 v21, s44, v6
    s_xor_b32 s44, s40, 2
    s_mul_i32 s44, s44, 49152
    s_add_u32 s44, s44, s45
    s_add_u32 s44, s44, 16384
    v_add_u32 v22, s44, v6
    s_xor_b32 s44, s40, 3
    s_mul_i32 s44, s44, 49152
    s_add_u32 s44, s44, s45
    s_add_u32 s44, s44, 32768
    v_add_u32 v23, s44, v6
    s_cmp_ge_u32 s28, 16
    s_cbranch_scc1 P1_early
    v_readfirstlane_b32 s45, v12
    s_nop 1
    s_cmp_ge_u32 s45, 16
    s_cbranch_scc0 P1_q2_slow
P1_q2_ok:
    s_add_u32 s42, s36, s43
    buffer_load_dwordx4 a[224:227], v2, s[4:7], s36 offen offset:0 sc1
    buffer_load_dwordx4 a[228:231], v3, s[4:7], s36 offen offset:0 sc1
    buffer_load_dwordx4 a[232:235], v2, s[4:7], s42 offen offset:0 sc1
    buffer_load_dwordx4 a[236:239], v3, s[4:7], s42 offen offset:0 sc1
    buffer_load_dwordx4 a[240:243], v2, s[4:7], s36 offen offset:1024 sc1
    buffer_load_dwordx4 a[244:247], v3, s[4:7], s36 offen offset:1024 sc1
    buffer_load_dwordx4 a[248:251], v2, s[4:7], s42 offen offset:1024 sc1
    buffer_load_dwordx4 a[252:255], v3, s[4:7], s42 offen offset:1024 sc1
    s_add_u32 s36, s36, 2048
    s_add_u32 s42, s36, s43
    buffer_load_dwordx4 a[128:131], v2, s[4:7], s36 offen offset:0 sc1
    buffer_load_dwordx4 a[132:135], v3, s[4:7], s36 offen offset:0 sc1
    buffer_load_dwordx4 a[136:139], v2, s[4:7], s42 offen offset:0 sc1
    buffer_load_dwordx4 a[140:143], v3, s[4:7], s42 offen offset:0 sc1
    buffer_load_dwordx4 a[144:147], v2, s[4:7], s36 offen offset:1024 sc1
    buffer_load_dwordx4 a[148:151], v3, s[4:7], s36 offen offset:1024 sc1
    buffer_load_dwordx4 a[152:155], v2, s[4:7], s42 offen offset:1024 sc1
    buffer_load_dwordx4 a[156:159], v3, s[4:7], s42 offen offset:1024 sc1
    s_add_u32 s36, s36, 2048
    s_waitcnt vmcnt(0)
P1_early:
    s_add_u32 s40, s25, 8192
    v_mov_b32 v12, s40
    ds_read_b64 v[80:81], v0 offset:0
    ds_read_b64 v[88:89], v0 offset:2048
    v_xor_b32 v0, 32, v0
    ds_read_b64 v[82:83], v0 offset:0
    ds_read_b64 v[90:91], v0 offset:2048
    v_xor_b32 v0, 96, v0
    ds_read_b64 v[84:85], v0 offset:0
    ds_read_b64 v[92:93], v0 offset:2048
    v_xor_b32 v0, 32, v0
    ds_read_b64 v[86:87], v0 offset:0
    ds_read_b64 v[94:95], v0 offset:2048
    s_mov_b32 s28, 2048
    s_mov_b32 s34, 2048
    s_mov_b32 s19, s43
    s_mov_b32 s20, s43
    s_waitcnt vmcnt(16)
    s_branch P2_Y3
.p2align 6
P2_Y0:
    s_waitcnt vmcnt(15) lgkmcnt(0)
    s_barrier
    v_mfma_f32_16x16x32_bf16 v[128:131], a[0:3], a[128:131], v[128:131]
    s_bitcmp1_b32 s47, s29
    s_cbranch_scc1 P2_Yhook0
P2_Yb0:
    v_mfma_f32_16x16x32_bf16 v[144:147], a[4:7], a[128:131], v[144:147]
    global_load_dword v13, v12, s[16:17] sc1
    v_mfma_f32_16x16x32_bf16 v[160:163], a[8:11], a[128:131], v[160:163]
    s_add_u32 s42, s36, s43
    v_mfma_f32_16x16x32_bf16 v[176:179], a[12:15], a[128:131], v[176:179]
    ds_read_b64_tr_b16 a[64:65], v7 offset:16896
    v_mfma_f32_16x16x32_bf16 v[192:195], a[16:19], a[128:131], v[192:195]
    ds_read_b64_tr_b16 a[66:67], v7 offset:17408
    v_mfma_f32_16x16x32_bf16 v[208:211], a[20:23], a[128:131], v[208:211]
    s_add_u32 m0, s39, 0
    v_mfma_f32_16x16x32_bf16 v[224:227], a[24:27], a[128:131], v[224:227]
    s_add_u32 s45, s35, s30
    v_mfma_f32_16x16x32_bf16 v[240:243], a[28:31], a[128:131], v[240:243]
    buffer_load_dwordx4 v4, s[8:11], s35 offen lds
    v_mfma_f32_16x16x32_bf16 v[244:247], a[28:31], a[132:135], v[244:247]
    ds_read_b64_tr_b16 a[68:69], v7 offset:16928
    v_mfma_f32_16x16x32_bf16 v[228:231], a[24:27], a[132:135], v[228:231]
    ds_read_b64_tr_b16 a[70:71], v7 offset:17440
    v_mfma_f32_16x16x32_bf16 v[212:215], a[20:23], a[132:135], v[212:215]
    buffer_load_dwordx4 a[192:195], v2, s[4:7], s36 offen offset:0 sc1
    v_mfma_f32_16x16x32_bf16 v[196:199], a[16:19], a[132:135], v[196:199]
    ds_read_b64_tr_b16 a[72:73], v7 offset:16960
    v_mfma_f32_16x16x32_bf16 v[180:183], a[12:15], a[132:135], v[180:183]
    ds_read_b64_tr_b16 a[74:75], v7 offset:17472
    v_mfma_f32_16x16x32_bf16 v[164:167], a[8:11], a[132:135], v[164:167]
    ds_read_b64_tr_b16 a[76:77], v7 offset:16992
    v_mfma_f32_16x16x32_bf16 v[148:151], a[4:7], a[132:135], v[148:151]
    buffer_load_dwordx4 a[196:199], v3, s[4:7], s36 offen offset:0 sc1
    v_mfma_f32_16x16x32_bf16 v[132:135], a[0:3], a[132:135], v[132:135]
    ds_read_b64_tr_b16 a[78:79], v7 offset:17504
    v_mfma_f32_16x16x32_bf16 v[136:139], a[0:3], a[136:139], v[136:139]
    ds_read_b64_tr_b16 a[80:81], v7 offset:17024
    v_mfma_f32_16x16x32_bf16 v[152:155], a[4:7], a[136:139], v[152:155]
    ds_read_b64_tr_b16 a[82:83], v7 offset:17536
    v_mfma_f32_16x16x32_bf16 v[168:171], a[8:11], a[136:139], v[168:171]
    buffer_load_dwordx4 v5, s[8:11], s35 offen offset:1056 lds
    v_mfma_f32_16x16x32_bf16 v[184:187], a[12:15], a[136:139], v[184:187]
    ds_read_b64_tr_b16 a[84:85], v7 offset:17056
    v_mfma_f32_16x16x32_bf16 v[200:203], a[16:19], a[136:139], v[200:203]
    v_mfma_f32_16x16x32_bf16 v[216:219], a[20:23], a[136:139], v[216:219]
    ds_read_b64_tr_b16 a[86:87], v7 offset:17568
    v_mfma_f32_16x16x32_bf16 v[232:235], a[24:27], a[136:139], v[232:235]
    buffer_load_dwordx4 a[200:203], v2, s[4:7], s42 offen offset:0 sc1
    v_mfma_f32_16x16x32_bf16 v[248:251], a[28:31], a[136:139], v[248:251]
    ds_read_b64_tr_b16 a[88:89], v7 offset:17088
    v_mfma_f32_16x16x32_bf16 v[252:255], a[28:31], a[140:143], v[252:255]
    ds_read_b64_tr_b16 a[90:91], v7 offset:17600
    v_mfma_f32_16x16x32_bf16 v[236:239], a[24:27], a[140:143], v[236:239]
    ds_read_b64_tr_b16 a[92:93], v7 offset:17120
    v_mfma_f32_16x16x32_bf16 v[220:223], a[20:23], a[140:143], v[220:223]
    buffer_load_dwordx4 a[204:207], v3, s[4:7], s42 offen offset:0 sc1
    v_mfma_f32_16x16x32_bf16 v[204:207], a[16:19], a[140:143], v[204:207]
    ds_read_b64_tr_b16 a[94:95], v7 offset:17632
    v_mfma_f32_16x16x32_bf16 v[188:191], a[12:15], a[140:143], v[188:191]
    ds_read_b64_tr_b16 a[96:97], v7 offset:25344
    v_mfma_f32_16x16x32_bf16 v[172:175], a[8:11], a[140:143], v[172:175]
    ds_read_b64_tr_b16 a[98:99], v7 offset:25856
    v_mfma_f32_16x16x32_bf16 v[156:159], a[4:7], a[140:143], v[156:159]
    s_add_u32 m0, m0, 8448
    v_mfma_f32_16x16x32_bf16 v[140:143], a[0:3], a[140:143], v[140:143]
    s_add_u32 s35, s35, s31
    v_mfma_f32_16x16x32_bf16 v[128:131], a[32:35], a[144:147], v[128:131]
    buffer_load_dwordx4 v4, s[8:11], s45 offen lds
    v_mfma_f32_16x16x32_bf16 v[144:147], a[36:39], a[144:147], v[144:147]
    ds_read_b64_tr_b16 a[100:101], v7 offset:25376
    v_mfma_f32_16x16x32_bf16 v[160:163], a[40:43], a[144:147], v[160:163]
    ds_read_b64_tr_b16 a[102:103], v7 offset:25888
    v_mfma_f32_16x16x32_bf16 v[176:179], a[44:47], a[144:147], v[176:179]
    buffer_load_dwordx4 a[208:211], v2, s[4:7], s36 offen offset:1024 sc1
    v_mfma_f32_16x16x32_bf16 v[192:195], a[48:51], a[144:147], v[192:195]
    ds_read_b64_tr_b16 a[104:105], v7 offset:25408
    v_mfma_f32_16x16x32_bf16 v[208:211], a[52:55], a[144:147], v[208:211]
    ds_read_b64_tr_b16 a[106:107], v7 offset:25920
    v_mfma_f32_16x16x32_bf16 v[224:227], a[56:59], a[144:147], v[224:227]
    ds_read_b64_tr_b16 a[108:109], v7 offset:25440
    v_mfma_f32_16x16x32_bf16 v[240:243], a[60:63], a[144:147], v[240:243]
    buffer_load_dwordx4 a[212:215], v3, s[4:7], s36 offen offset:1024 sc1
    v_mfma_f32_16x16x32_bf16 v[244:247], a[60:63], a[148:151], v[244:247]
    ds_read_b64_tr_b16 a[110:111], v7 offset:25952
    v_mfma_f32_16x16x32_bf16 v[228:231], a[56:59], a[148:151], v[228:231]
    v_mfma_f32_16x16x32_bf16 v[212:215], a[52:55], a[148:151], v[212:215]
    ds_read_b64_tr_b16 a[112:113], v7 offset:25472
    v_mfma_f32_16x16x32_bf16 v[196:199], a[48:51], a[148:151], v[196:199]
    ds_read_b64_tr_b16 a[114:115], v7 offset:25984
    v_mfma_f32_16x16x32_bf16 v[180:183], a[44:47], a[148:151], v[180:183]
    buffer_load_dwordx4 v5, s[8:11], s45 offen offset:1056 lds
    v_mfma_f32_16x16x32_bf16 v[164:167], a[40:43], a[148:151], v[164:167]
    ds_read_b64_tr_b16 a[116:117], v7 offset:25504
    v_mfma_f32_16x16x32_bf16 v[148:151], a[36:39], a[148:151], v[148:151]
    ds_read_b64_tr_b16 a[118:119], v7 offset:26016
    v_mfma_f32_16x16x32_bf16 v[132:135], a[32:35], a[148:151], v[132:135]
    buffer_load_dwordx4 a[216:219], v2, s[4:7], s42 offen offset:1024 sc1
    v_mfma_f32_16x16x32_bf16 v[136:139], a[32:35], a[152:155], v[136:139]
    ds_read_b64_tr_b16 a[120:121], v7 offset:25536
    v_mfma_f32_16x16x32_bf16 v[152:155], a[36:39], a[152:155], v[152:155]
    ds_read_b64_tr_b16 a[122:123], v7 offset:26048
    v_mfma_f32_16x16x32_bf16 v[168:171], a[40:43], a[152:155], v[168:171]
    ds_read_b64_tr_b16 a[124:125], v7 offset:25568
    v_mfma_f32_16x16x32_bf16 v[184:187], a[44:47], a[152:155], v[184:187]
    buffer_load_dwordx4 a[220:223], v3, s[4:7], s42 offen offset:1024 sc1
    v_mfma_f32_16x16x32_bf16 v[200:203], a[48:51], a[152:155], v[200:203]
    ds_read_b64_tr_b16 a[126:127], v7 offset:26080
    v_mfma_f32_16x16x32_bf16 v[216:219], a[52:55], a[152:155], v[216:219]
    s_mov_b32 m0, s46
    v_mfma_f32_16x16x32_bf16 v[232:235], a[56:59], a[152:155], v[232:235]
    buffer_load_dwordx4 v18, s[92:95], 0 offen lds
    v_mfma_f32_16x16x32_bf16 v[248:251], a[60:63], a[152:155], v[248:251]
    s_add_u32 s46, s46, 8448
    v_add_u32 v18, 131072, v18
    v_mfma_f32_16x16x32_bf16 v[252:255], a[60:63], a[156:159], v[252:255]
    s_add_u32 s36, s36, s28
    s_mov_b32 s28, s34
    v_mfma_f32_16x16x32_bf16 v[236:239], a[56:59], a[156:159], v[236:239]
    s_mov_b32 s34, 2048
    s_mov_b32 s43, s19
    v_mfma_f32_16x16x32_bf16 v[220:223], a[52:55], a[156:159], v[220:223]
    s_mov_b32 s19, s20
    v_mfma_f32_16x16x32_bf16 v[204:207], a[48:51], a[156:159], v[204:207]
    buffer_load_dwordx4 v19, s[92:95], 0 offen offset:1056 lds
    v_mfma_f32_16x16x32_bf16 v[188:191], a[44:47], a[156:159], v[188:191]
    v_add_u32 v19, 131072, v19
    v_mfma_f32_16x16x32_bf16 v[172:175], a[40:43], a[156:159], v[172:175]
    s_sub_u32 s29, s29, 1
    v_mfma_f32_16x16x32_bf16 v[156:159], a[36:39], a[156:159], v[156:159]
    v_mfma_f32_16x16x32_bf16 v[140:143], a[32:35], a[156:159], v[140:143]
P2_Y1:
    s_waitcnt vmcnt(15) lgkmcnt(0)
    s_barrier
    v_mfma_f32_16x16x32_bf16 v[128:131], a[64:67], a[160:163], v[128:131]
    s_bitcmp1_b32 s47, s29
    s_cbranch_scc1 P2_Yhook1
P2_Yb1:
    v_mfma_f32_16x16x32_bf16 v[144:147], a[68:71], a[160:163], v[144:147]
    global_load_dword v13, v12, s[16:17] sc1
    v_mfma_f32_16x16x32_bf16 v[160:163], a[72:75], a[160:163], v[160:163]
    s_add_u32 s42, s36, s43
    v_mfma_f32_16x16x32_bf16 v[176:179], a[76:79], a[160:163], v[176:179]
    ds_read_b64_tr_b16 a[0:1], v7 offset:33792
    v_mfma_f32_16x16x32_bf16 v[192:195], a[80:83], a[160:163], v[192:195]
    ds_read_b64_tr_b16 a[2:3], v7 offset:34304
    v_mfma_f32_16x16x32_bf16 v[208:211], a[84:87], a[160:163], v[208:211]
    s_add_u32 m0, s39, 16896
    v_mfma_f32_16x16x32_bf16 v[224:227], a[88:91], a[160:163], v[224:227]
    s_add_u32 s45, s35, s30
    v_mfma_f32_16x16x32_bf16 v[240:243], a[92:95], a[160:163], v[240:243]
    buffer_load_dwordx4 v4, s[8:11], s35 offen lds
    v_mfma_f32_16x16x32_bf16 v[244:247], a[92:95], a[164:167], v[244:247]
    ds_read_b64_tr_b16 a[4:5], v7 offset:33824
    v_mfma_f32_16x16x32_bf16 v[228:231], a[88:91], a[164:167], v[228:231]
    ds_read_b64_tr_b16 a[6:7], v7 offset:34336
    v_mfma_f32_16x16x32_bf16 v[212:215], a[84:87], a[164:167], v[212:215]
    buffer_load_dwordx4 a[224:227], v2, s[4:7], s36 offen offset:0 sc1
    v_mfma_f32_16x16x32_bf16 v[196:199], a[80:83], a[164:167], v[196:199]
    ds_read_b64_tr_b16 a[8:9], v7 offset:33856
    v_mfma_f32_16x16x32_bf16 v[180:183], a[76:79], a[164:167], v[180:183]
    ds_read_b64_tr_b16 a[10:11], v7 offset:34368
    v_mfma_f32_16x16x32_bf16 v[164:167], a[72:75], a[164:167], v[164:167]
    ds_read_b64_tr_b16 a[12:13], v7 offset:33888
    v_mfma_f32_16x16x32_bf16 v[148:151], a[68:71], a[164:167], v[148:151]
    buffer_load_dwordx4 a[228:231], v3, s[4:7], s36 offen offset:0 sc1
    v_mfma_f32_16x16x32_bf16 v[132:135], a[64:67], a[164:167], v[132:135]
    ds_read_b64_tr_b16 a[14:15], v7 offset:34400
    v_mfma_f32_16x16x32_bf16 v[136:139], a[64:67], a[168:171], v[136:139]
    ds_read_b64_tr_b16 a[16:17], v7 offset:33920
    v_mfma_f32_16x16x32_bf16 v[152:155], a[68:71], a[168:171], v[152:155]
    ds_read_b64_tr_b16 a[18:19], v7 offset:34432
    v_mfma_f32_16x16x32_bf16 v[168:171], a[72:75], a[168:171], v[168:171]
    buffer_load_dwordx4 v5, s[8:11], s35 offen offset:1056 lds
    v_mfma_f32_16x16x32_bf16 v[184:187], a[76:79], a[168:171], v[184:187]
    ds_read_b64_tr_b16 a[20:21], v7 offset:33952
    v_mfma_f32_16x16x32_bf16 v[200:203], a[80:83], a[168:171], v[200:203]
    v_mfma_f32_16x16x32_bf16 v[216:219], a[84:87], a[168:171], v[216:219]
    ds_read_b64_tr_b16 a[22:23], v7 offset:34464
    v_mfma_f32_16x16x32_bf16 v[232:235], a[88:91], a[168:171], v[232:235]
    buffer_load_dwordx4 a[232:235], v2, s[4:7], s42 offen offset:0 sc1
    v_mfma_f32_16x16x32_bf16 v[248:251], a[92:95], a[168:171], v[248:251]
    ds_read_b64_tr_b16 a[24:25], v7 offset:33984
    v_mfma_f32_16x16x32_bf16 v[252:255], a[92:95], a[172:175], v[252:255]
    ds_read_b64_tr_b16 a[26:27], v7 offset:34496
    v_mfma_f32_16x16x32_bf16 v[236:239], a[88:91], a[172:175], v[236:239]
    ds_read_b64_tr_b16 a[28:29], v7 offset:34016
    v_mfma_f32_16x16x32_bf16 v[220:223], a[84:87], a[172:175], v[220:223]
    buffer_load_dwordx4 a[236:239], v3, s[4:7], s42 offen offset:0 sc1
    v_mfma_f32_16x16x32_bf16 v[204:207], a[80:83], a[172:175], v[204:207]
    ds_read_b64_tr_b16 a[30:31], v7 offset:34528
    v_mfma_f32_16x16x32_bf16 v[188:191], a[76:79], a[172:175], v[188:191]
    ds_read_b64_tr_b16 a[32:33], v7 offset:42240
    v_mfma_f32_16x16x32_bf16 v[172:175], a[72:75], a[172:175], v[172:175]
    ds_read_b64_tr_b16 a[34:35], v7 offset:42752
    v_mfma_f32_16x16x32_bf16 v[156:159], a[68:71], a[172:175], v[156:159]
    s_add_u32 m0, m0, 8448
    v_mfma_f32_16x16x32_bf16 v[140:143], a[64:67], a[172:175], v[140:143]
    s_add_u32 s35, s35, s31
    v_mfma_f32_16x16x32_bf16 v[128:131], a[96:99], a[176:179], v[128:131]
    buffer_load_dwordx4 v4, s[8:11], s45 offen lds
    v_mfma_f32_16x16x32_bf16 v[144:147], a[100:103], a[176:179], v[144:147]
    ds_read_b64_tr_b16 a[36:37], v7 offset:42272
    v_mfma_f32_16x16x32_bf16 v[160:163], a[104:107], a[176:179], v[160:163]
    ds_read_b64_tr_b16 a[38:39], v7 offset:42784
    v_mfma_f32_16x16x32_bf16 v[176:179], a[108:111], a[176:179], v[176:179]
    buffer_load_dwordx4 a[240:243], v2, s[4:7], s36 offen offset:1024 sc1
    v_mfma_f32_16x16x32_bf16 v[192:195], a[112:115], a[176:179], v[192:195]
    ds_read_b64_tr_b16 a[40:41], v7 offset:42304
    v_mfma_f32_16x16x32_bf16 v[208:211], a[116:119], a[176:179], v[208:211]
    ds_read_b64_tr_b16 a[42:43], v7 offset:42816
    v_mfma_f32_16x16x32_bf16 v[224:227], a[120:123], a[176:179], v[224:227]
    ds_read_b64_tr_b16 a[44:45], v7 offset:42336
    v_mfma_f32_16x16x32_bf16 v[240:243], a[124:127], a[176:179], v[240:243]
    buffer_load_dwordx4 a[244:247], v3, s[4:7], s36 offen offset:1024 sc1
    v_mfma_f32_16x16x32_bf16 v[244:247], a[124:127], a[180:183], v[244:247]
    ds_read_b64_tr_b16 a[46:47], v7 offset:42848
    v_mfma_f32_16x16x32_bf16 v[228:231], a[120:123], a[180:183], v[228:231]
    v_mfma_f32_16x16x32_bf16 v[212:215], a[116:119], a[180:183], v[212:215]
    ds_read_b64_tr_b16 a[48:49], v7 offset:42368
    v_mfma_f32_16x16x32_bf16 v[196:199], a[112:115], a[180:183], v[196:199]
    ds_read_b64_tr_b16 a[50:51], v7 offset:42880
    v_mfma_f32_16x16x32_bf16 v[180:183], a[108:111], a[180:183], v[180:183]
    buffer_load_dwordx4 v5, s[8:11], s45 offen offset:1056 lds
    v_mfma_f32_16x16x32_bf16 v[164:167], a[104:107], a[180:183], v[164:167]
    ds_read_b64_tr_b16 a[52:53], v7 offset:42400
    v_mfma_f32_16x16x32_bf16 v[148:151], a[100:103], a[180:183], v[148:151]
    ds_read_b64_tr_b16 a[54:55], v7 offset:42912
    v_mfma_f32_16x16x32_bf16 v[132:135], a[96:99], a[180:183], v[132:135]
    buffer_load_dwordx4 a[248:251], v2, s[4:7], s42 offen offset:1024 sc1
    v_mfma_f32_16x16x32_bf16 v[136:139], a[96:99], a[184:187], v[136:139]
    ds_read_b64_tr_b16 a[56:57], v7 offset:42432
    v_mfma_f32_16x16x32_bf16 v[152:155], a[100:103], a[184:187], v[152:155]
    ds_read_b64_tr_b16 a[58:59], v7 offset:42944
    v_mfma_f32_16x16x32_bf16 v[168:171], a[104:107], a[184:187], v[168:171]
    ds_read_b64_tr_b16 a[60:61], v7 offset:42464
    v_mfma_f32_16x16x32_bf16 v[184:187], a[108:111], a[184:187], v[184:187]
    buffer_load_dwordx4 a[252:255], v3, s[4:7], s42 offen offset:1024 sc1
    v_mfma_f32_16x16x32_bf16 v[200:203], a[112:115], a[184:187], v[200:203]
    ds_read_b64_tr_b16 a[62:63], v7 offset:42976
    v_mfma_f32_16x16x32_bf16 v[216:219], a[116:119], a[184:187], v[216:219]
    s_mov_b32 m0, s46
    v_mfma_f32_16x16x32_bf16 v[232:235], a[120:123], a[184:187], v[232:235]
    buffer_load_dwordx4 v18, s[92:95], 0 offen lds
    v_mfma_f32_16x16x32_bf16 v[248:251], a[124:127], a[184:187], v[248:251]
    s_add_u32 s46, s46, 8448
    v_add_u32 v18, 131072, v18
    v_mfma_f32_16x16x32_bf16 v[252:255], a[124:127], a[188:191], v[252:255]
    s_add_u32 s36, s36, s28
    s_mov_b32 s28, s34
    v_mfma_f32_16x16x32_bf16 v[236:239], a[120:123], a[188:191], v[236:239]
    s_mov_b32 s34, 2048
    s_mov_b32 s43, s19
    v_mfma_f32_16x16x32_bf16 v[220:223], a[116:119], a[188:191], v[220:223]
    s_mov_b32 s19, s20
    v_mfma_f32_16x16x32_bf16 v[204:207], a[112:115], a[188:191], v[204:207]
    buffer_load_dwordx4 v19, s[92:95], 0 offen offset:1056 lds
    v_mfma_f32_16x16x32_bf16 v[188:191], a[108:111], a[188:191], v[188:191]
    v_add_u32 v19, 131072, v19
    v_mfma_f32_16x16x32_bf16 v[172:175], a[104:107], a[188:191], v[172:175]
    s_sub_u32 s29, s29, 1
    v_mfma_f32_16x16x32_bf16 v[156:159], a[100:103], a[188:191], v[156:159]
    v_mfma_f32_16x16x32_bf16 v[140:143], a[96:99], a[188:191], v[140:143]
P2_Y2:
    s_waitcnt vmcnt(15) lgkmcnt(0)
    s_barrier
    v_mfma_f32_16x16x32_bf16 v[128:131], a[0:3], a[192:195], v[128:131]
    s_bitcmp1_b32 s47, s29
    s_cbranch_scc1 P2_Yhook2
P2_Yb2:
    v_mfma_f32_16x16x32_bf16 v[144:147], a[4:7], a[192:195], v[144:147]
    global_load_dword v13, v12, s[16:17] sc1
    v_mfma_f32_16x16x32_bf16 v[160:163], a[8:11], a[192:195], v[160:163]
    s_add_u32 s42, s36, s43
    v_mfma_f32_16x16x32_bf16 v[176:179], a[12:15], a[192:195], v[176:179]
    ds_read_b64_tr_b16 a[64:65], v7 offset:50688
    v_mfma_f32_16x16x32_bf16 v[192:195], a[16:19], a[192:195], v[192:195]
    ds_read_b64_tr_b16 a[66:67], v7 offset:51200
    v_mfma_f32_16x16x32_bf16 v[208:211], a[20:23], a[192:195], v[208:211]
    s_add_u32 m0, s39, 33792
    v_mfma_f32_16x16x32_bf16 v[224:227], a[24:27], a[192:195], v[224:227]
    s_add_u32 s45, s35, s30
    v_mfma_f32_16x16x32_bf16 v[240:243], a[28:31], a[192:195], v[240:243]
    buffer_load_dwordx4 v4, s[8:11], s35 offen lds
    v_mfma_f32_16x16x32_bf16 v[244:247], a[28:31], a[196:199], v[244:247]
    ds_read_b64_tr_b16 a[68:69], v7 offset:50720
    v_mfma_f32_16x16x32_bf16 v[228:231], a[24:27], a[196:199], v[228:231]
    ds_read_b64_tr_b16 a[70:71], v7 offset:51232
    v_mfma_f32_16x16x32_bf16 v[212:215], a[20:23], a[196:199], v[212:215]
    buffer_load_dwordx4 a[128:131], v2, s[4:7], s36 offen offset:0 sc1
    v_mfma_f32_16x16x32_bf16 v[196:199], a[16:19], a[196:199], v[196:199]
    ds_read_b64_tr_b16 a[72:73], v7 offset:50752
    v_mfma_f32_16x16x32_bf16 v[180:183], a[12:15], a[196:199], v[180:183]
    ds_read_b64_tr_b16 a[74:75], v7 offset:51264
    v_mfma_f32_16x16x32_bf16 v[164:167], a[8:11], a[196:199], v[164:167]
    ds_read_b64_tr_b16 a[76:77], v7 offset:50784
    v_mfma_f32_16x16x32_bf16 v[148:151], a[4:7], a[196:199], v[148:151]
    buffer_load_dwordx4 a[132:135], v3, s[4:7], s36 offen offset:0 sc1
    v_mfma_f32_16x16x32_bf16 v[132:135], a[0:3], a[196:199], v[132:135]
    ds_read_b64_tr_b16 a[78:79], v7 offset:51296
    v_mfma_f32_16x16x32_bf16 v[136:139], a[0:3], a[200:203], v[136:139]
    ds_read_b64_tr_b16 a[80:81], v7 offset:50816
    v_mfma_f32_16x16x32_bf16 v[152:155], a[4:7], a[200:203], v[152:155]
    ds_read_b64_tr_b16 a[82:83], v7 offset:51328
    v_mfma_f32_16x16x32_bf16 v[168:171], a[8:11], a[200:203], v[168:171]
    buffer_load_dwordx4 v5, s[8:11], s35 offen offset:1056 lds
    v_mfma_f32_16x16x32_bf16 v[184:187], a[12:15], a[200:203], v[184:187]
    ds_read_b64_tr_b16 a[84:85], v7 offset:50848
    v_mfma_f32_16x16x32_bf16 v[200:203], a[16:19], a[200:203], v[200:203]
    v_mfma_f32_16x16x32_bf16 v[216:219], a[20:23], a[200:203], v[216:219]
    ds_read_b64_tr_b16 a[86:87], v7 offset:51360
    v_mfma_f32_16x16x32_bf16 v[232:235], a[24:27], a[200:203], v[232:235]
    buffer_load_dwordx4 a[136:139], v2, s[4:7], s42 offen offset:0 sc1
    v_mfma_f32_16x16x32_bf16 v[248:251], a[28:31], a[200:203], v[248:251]
    ds_read_b64_tr_b16 a[88:89], v7 offset:50880
    v_mfma_f32_16x16x32_bf16 v[252:255], a[28:31], a[204:207], v[252:255]
    ds_read_b64_tr_b16 a[90:91], v7 offset:51392
    v_mfma_f32_16x16x32_bf16 v[236:239], a[24:27], a[204:207], v[236:239]
    ds_read_b64_tr_b16 a[92:93], v7 offset:50912
    v_mfma_f32_16x16x32_bf16 v[220:223], a[20:23], a[204:207], v[220:223]
    buffer_load_dwordx4 a[140:143], v3, s[4:7], s42 offen offset:0 sc1
    v_mfma_f32_16x16x32_bf16 v[204:207], a[16:19], a[204:207], v[204:207]
    ds_read_b64_tr_b16 a[94:95], v7 offset:51424
    v_mfma_f32_16x16x32_bf16 v[188:191], a[12:15], a[204:207], v[188:191]
    ds_read_b64_tr_b16 a[96:97], v7 offset:59136
    v_mfma_f32_16x16x32_bf16 v[172:175], a[8:11], a[204:207], v[172:175]
    ds_read_b64_tr_b16 a[98:99], v7 offset:59648
    v_mfma_f32_16x16x32_bf16 v[156:159], a[4:7], a[204:207], v[156:159]
    s_add_u32 m0, m0, 8448
    v_mfma_f32_16x16x32_bf16 v[140:143], a[0:3], a[204:207], v[140:143]
    s_add_u32 s35, s35, s31
    v_mfma_f32_16x16x32_bf16 v[128:131], a[32:35], a[208:211], v[128:131]
    buffer_load_dwordx4 v4, s[8:11], s45 offen lds
    v_mfma_f32_16x16x32_bf16 v[144:147], a[36:39], a[208:211], v[144:147]
    ds_read_b64_tr_b16 a[100:101], v7 offset:59168
    v_mfma_f32_16x16x32_bf16 v[160:163], a[40:43], a[208:211], v[160:163]
    ds_read_b64_tr_b16 a[102:103], v7 offset:59680
    v_mfma_f32_16x16x32_bf16 v[176:179], a[44:47], a[208:211], v[176:179]
    buffer_load_dwordx4 a[144:147], v2, s[4:7], s36 offen offset:1024 sc1
    v_mfma_f32_16x16x32_bf16 v[192:195], a[48:51], a[208:211], v[192:195]
    ds_read_b64_tr_b16 a[104:105], v7 offset:59200
    v_mfma_f32_16x16x32_bf16 v[208:211], a[52:55], a[208:211], v[208:211]
    ds_read_b64_tr_b16 a[106:107], v7 offset:59712
    v_mfma_f32_16x16x32_bf16 v[224:227], a[56:59], a[208:211], v[224:227]
    ds_read_b64_tr_b16 a[108:109], v7 offset:59232
    v_mfma_f32_16x16x32_bf16 v[240:243], a[60:63], a[208:211], v[240:243]
    buffer_load_dwordx4 a[148:151], v3, s[4:7], s36 offen offset:1024 sc1
    v_mfma_f32_16x16x32_bf16 v[244:247], a[60:63], a[212:215], v[244:247]
    ds_read_b64_tr_b16 a[110:111], v7 offset:59744
    v_mfma_f32_16x16x32_bf16 v[228:231], a[56:59], a[212:215], v[228:231]
    v_mfma_f32_16x16x32_bf16 v[212:215], a[52:55], a[212:215], v[212:215]
    ds_read_b64_tr_b16 a[112:113], v7 offset:59264
    v_mfma_f32_16x16x32_bf16 v[196:199], a[48:51], a[212:215], v[196:199]
    ds_read_b64_tr_b16 a[114:115], v7 offset:59776
    v_mfma_f32_16x16x32_bf16 v[180:183], a[44:47], a[212:215], v[180:183]
    buffer_load_dwordx4 v5, s[8:11], s45 offen offset:1056 lds
    v_mfma_f32_16x16x32_bf16 v[164:167], a[40:43], a[212:215], v[164:167]
    ds_read_b64_tr_b16 a[116:117], v7 offset:59296
    v_mfma_f32_16x16x32_bf16 v[148:151], a[36:39], a[212:215], v[148:151]
    ds_read_b64_tr_b16 a[118:119], v7 offset:59808
    v_mfma_f32_16x16x32_bf16 v[132:135], a[32:35], a[212:215], v[132:135]
    buffer_load_dwordx4 a[152:155], v2, s[4:7], s42 offen offset:1024 sc1
    v_mfma_f32_16x16x32_bf16 v[136:139], a[32:35], a[216:219], v[136:139]
    ds_read_b64_tr_b16 a[120:121], v7 offset:59328
    v_mfma_f32_16x16x32_bf16 v[152:155], a[36:39], a[216:219], v[152:155]
    ds_read_b64_tr_b16 a[122:123], v7 offset:59840
    v_mfma_f32_16x16x32_bf16 v[168:171], a[40:43], a[216:219], v[168:171]
    ds_read_b64_tr_b16 a[124:125], v7 offset:59360
    v_mfma_f32_16x16x32_bf16 v[184:187], a[44:47], a[216:219], v[184:187]
    buffer_load_dwordx4 a[156:159], v3, s[4:7], s42 offen offset:1024 sc1
    v_mfma_f32_16x16x32_bf16 v[200:203], a[48:51], a[216:219], v[200:203]
    ds_read_b64_tr_b16 a[126:127], v7 offset:59872
    v_mfma_f32_16x16x32_bf16 v[216:219], a[52:55], a[216:219], v[216:219]
    s_mov_b32 m0, s46
    v_mfma_f32_16x16x32_bf16 v[232:235], a[56:59], a[216:219], v[232:235]
    buffer_load_dwordx4 v18, s[92:95], 0 offen lds
    v_mfma_f32_16x16x32_bf16 v[248:251], a[60:63], a[216:219], v[248:251]
    s_add_u32 s46, s46, 8448
    v_add_u32 v18, 131072, v18
    v_mfma_f32_16x16x32_bf16 v[252:255], a[60:63], a[220:223], v[252:255]
    s_add_u32 s36, s36, s28
    s_mov_b32 s28, s34
    v_mfma_f32_16x16x32_bf16 v[236:239], a[56:59], a[220:223], v[236:239]
    s_mov_b32 s34, 2048
    s_mov_b32 s43, s19
    v_mfma_f32_16x16x32_bf16 v[220:223], a[52:55], a[220:223], v[220:223]
    s_mov_b32 s19, s20
    v_mfma_f32_16x16x32_bf16 v[204:207], a[48:51], a[220:223], v[204:207]
    buffer_load_dwordx4 v19, s[92:95], 0 offen offset:1056 lds
    v_mfma_f32_16x16x32_bf16 v[188:191], a[44:47], a[220:223], v[188:191]
    v_add_u32 v19, 131072, v19
    v_mfma_f32_16x16x32_bf16 v[172:175], a[40:43], a[220:223], v[172:175]
    s_sub_u32 s29, s29, 1
    v_mfma_f32_16x16x32_bf16 v[156:159], a[36:39], a[220:223], v[156:159]
    v_mfma_f32_16x16x32_bf16 v[140:143], a[32:35], a[220:223], v[140:143]
    s_cmp_eq_u32 s29, 1
    s_cbranch_scc1 P2_tail
P2_Y3:
    s_waitcnt vmcnt(15) lgkmcnt(0)
    s_barrier
    v_mfma_f32_16x16x32_bf16 v[128:131], a[64:67], a[224:227], v[128:131]
    s_bitcmp1_b32 s47, s29
    s_cbranch_scc1 P2_Yhook3
P2_Yb3:
    v_mfma_f32_16x16x32_bf16 v[144:147], a[68:71], a[224:227], v[144:147]
    global_load_dword v13, v12, s[16:17] sc1
    v_mfma_f32_16x16x32_bf16 v[160:163], a[72:75], a[224:227], v[160:163]
    s_add_u32 s42, s36, s43
    v_mfma_f32_16x16x32_bf16 v[176:179], a[76:79], a[224:227], v[176:179]
    ds_read_b64_tr_b16 a[0:1], v7 offset:0
    v_mfma_f32_16x16x32_bf16 v[192:195], a[80:83], a[224:227], v[192:195]
    ds_read_b64_tr_b16 a[2:3], v7 offset:512
    v_mfma_f32_16x16x32_bf16 v[208:211], a[84:87], a[224:227], v[208:211]
    s_add_u32 m0, s39, 50688
    v_mfma_f32_16x16x32_bf16 v[224:227], a[88:91], a[224:227], v[224:227]
    s_add_u32 s45, s35, s30
    v_mfma_f32_16x16x32_bf16 v[240:243], a[92:95], a[224:227], v[240:243]
    buffer_load_dwordx4 v4, s[8:11], s35 offen lds
    v_mfma_f32_16x16x32_bf16 v[244:247], a[92:95], a[228:231], v[244:247]
    ds_read_b64_tr_b16 a[4:5], v7 offset:32
    v_mfma_f32_16x16x32_bf16 v[228:231], a[88:91], a[228:231], v[228:231]
    ds_read_b64_tr_b16 a[6:7], v7 offset:544
    v_mfma_f32_16x16x32_bf16 v[212:215], a[84:87], a[228:231], v[212:215]
    buffer_load_dwordx4 a[160:163], v2, s[4:7], s36 offen offset:0 sc1
    v_mfma_f32_16x16x32_bf16 v[196:199], a[80:83], a[228:231], v[196:199]
    ds_read_b64_tr_b16 a[8:9], v7 offset:64
    v_mfma_f32_16x16x32_bf16 v[180:183], a[76:79], a[228:231], v[180:183]
    ds_read_b64_tr_b16 a[10:11], v7 offset:576
    v_mfma_f32_16x16x32_bf16 v[164:167], a[72:75], a[228:231], v[164:167]
    ds_read_b64_tr_b16 a[12:13], v7 offset:96
    v_mfma_f32_16x16x32_bf16 v[148:151], a[68:71], a[228:231], v[148:151]
    buffer_load_dwordx4 a[164:167], v3, s[4:7], s36 offen offset:0 sc1
    v_mfma_f32_16x16x32_bf16 v[132:135], a[64:67], a[228:231], v[132:135]
    ds_read_b64_tr_b16 a[14:15], v7 offset:608
    v_mfma_f32_16x16x32_bf16 v[136:139], a[64:67], a[232:235], v[136:139]
    ds_read_b64_tr_b16 a[16:17], v7 offset:128
    v_mfma_f32_16x16x32_bf16 v[152:155], a[68:71], a[232:235], v[152:155]
    ds_read_b64_tr_b16 a[18:19], v7 offset:640
    v_mfma_f32_16x16x32_bf16 v[168:171], a[72:75], a[232:235], v[168:171]
    buffer_load_dwordx4 v5, s[8:11], s35 offen offset:1056 lds
    v_mfma_f32_16x16x32_bf16 v[184:187], a[76:79], a[232:235], v[184:187]
    ds_read_b64_tr_b16 a[20:21], v7 offset:160
    v_mfma_f32_16x16x32_bf16 v[200:203], a[80:83], a[232:235], v[200:203]
    v_mfma_f32_16x16x32_bf16 v[216:219], a[84:87], a[232:235], v[216:219]
    ds_read_b64_tr_b16 a[22:23], v7 offset:672
    v_mfma_f32_16x16x32_bf16 v[232:235], a[88:91], a[232:235], v[232:235]
    buffer_load_dwordx4 a[168:171], v2, s[4:7], s42 offen offset:0 sc1
    v_mfma_f32_16x16x32_bf16 v[248:251], a[92:95], a[232:235], v[248:251]
    ds_read_b64_tr_b16 a[24:25], v7 offset:192
    v_mfma_f32_16x16x32_bf16 v[252:255], a[92:95], a[236:239], v[252:255]
    ds_read_b64_tr_b16 a[26:27], v7 offset:704
    v_mfma_f32_16x16x32_bf16 v[236:239], a[88:91], a[236:239], v[236:239]
    ds_read_b64_tr_b16 a[28:29], v7 offset:224
    v_mfma_f32_16x16x32_bf16 v[220:223], a[84:87], a[236:239], v[220:223]
    buffer_load_dwordx4 a[172:175], v3, s[4:7], s42 offen offset:0 sc1
    v_mfma_f32_16x16x32_bf16 v[204:207], a[80:83], a[236:239], v[204:207]
    ds_read_b64_tr_b16 a[30:31], v7 offset:736
    v_mfma_f32_16x16x32_bf16 v[188:191], a[76:79], a[236:239], v[188:191]
    ds_read_b64_tr_b16 a[32:33], v7 offset:8448
    v_mfma_f32_16x16x32_bf16 v[172:175], a[72:75], a[236:239], v[172:175]
    ds_read_b64_tr_b16 a[34:35], v7 offset:8960
    v_mfma_f32_16x16x32_bf16 v[156:159], a[68:71], a[236:239], v[156:159]
    s_add_u32 m0, m0, 8448
    v_mfma_f32_16x16x32_bf16 v[140:143], a[64:67], a[236:239], v[140:143]
    s_add_u32 s35, s35, s31
    v_mfma_f32_16x16x32_bf16 v[128:131], a[96:99], a[240:243], v[128:131]
    buffer_load_dwordx4 v4, s[8:11], s45 offen lds
    v_mfma_f32_16x16x32_bf16 v[144:147], a[100:103], a[240:243], v[144:147]
    ds_read_b64_tr_b16 a[36:37], v7 offset:8480
    v_mfma_f32_16x16x32_bf16 v[160:163], a[104:107], a[240:243], v[160:163]
    ds_read_b64_tr_b16 a[38:39], v7 offset:8992
    v_mfma_f32_16x16x32_bf16 v[176:179], a[108:111], a[240:243], v[176:179]
    buffer_load_dwordx4 a[176:179], v2, s[4:7], s36 offen offset:1024 sc1
    v_mfma_f32_16x16x32_bf16 v[192:195], a[112:115], a[240:243], v[192:195]
    ds_read_b64_tr_b16 a[40:41], v7 offset:8512
    v_mfma_f32_16x16x32_bf16 v[208:211], a[116:119], a[240:243], v[208:211]
    ds_read_b64_tr_b16 a[42:43], v7 offset:9024
    v_mfma_f32_16x16x32_bf16 v[224:227], a[120:123], a[240:243], v[224:227]
    ds_read_b64_tr_b16 a[44:45], v7 offset:8544
    v_mfma_f32_16x16x32_bf16 v[240:243], a[124:127], a[240:243], v[240:243]
    buffer_load_dwordx4 a[180:183], v3, s[4:7], s36 offen offset:1024 sc1
    v_mfma_f32_16x16x32_bf16 v[244:247], a[124:127], a[244:247], v[244:247]
    ds_read_b64_tr_b16 a[46:47], v7 offset:9056
    v_mfma_f32_16x16x32_bf16 v[228:231], a[120:123], a[244:247], v[228:231]
    v_mfma_f32_16x16x32_bf16 v[212:215], a[116:119], a[244:247], v[212:215]
    ds_read_b64_tr_b16 a[48:49], v7 offset:8576
    v_mfma_f32_16x16x32_bf16 v[196:199], a[112:115], a[244:247], v[196:199]
    ds_read_b64_tr_b16 a[50:51], v7 offset:9088
    v_mfma_f32_16x16x32_bf16 v[180:183], a[108:111], a[244:247], v[180:183]
    buffer_load_dwordx4 v5, s[8:11], s45 offen offset:1056 lds
    v_mfma_f32_16x16x32_bf16 v[164:167], a[104:107], a[244:247], v[164:167]
    ds_read_b64_tr_b16 a[52:53], v7 offset:8608
    v_mfma_f32_16x16x32_bf16 v[148:151], a[100:103], a[244:247], v[148:151]
    ds_read_b64_tr_b16 a[54:55], v7 offset:9120
    v_mfma_f32_16x16x32_bf16 v[132:135], a[96:99], a[244:247], v[132:135]
    buffer_load_dwordx4 a[184:187], v2, s[4:7], s42 offen offset:1024 sc1
    v_mfma_f32_16x16x32_bf16 v[136:139], a[96:99], a[248:251], v[136:139]
    ds_read_b64_tr_b16 a[56:57], v7 offset:8640
    v_mfma_f32_16x16x32_bf16 v[152:155], a[100:103], a[248:251], v[152:155]
    ds_read_b64_tr_b16 a[58:59], v7 offset:9152
    v_mfma_f32_16x16x32_bf16 v[168:171], a[104:107], a[248:251], v[168:171]
    ds_read_b64_tr_b16 a[60:61], v7 offset:8672
    v_mfma_f32_16x16x32_bf16 v[184:187], a[108:111], a[248:251], v[184:187]
    buffer_load_dwordx4 a[188:191], v3, s[4:7], s42 offen offset:1024 sc1
    v_mfma_f32_16x16x32_bf16 v[200:203], a[112:115], a[248:251], v[200:203]
    ds_read_b64_tr_b16 a[62:63], v7 offset:9184
    v_mfma_f32_16x16x32_bf16 v[216:219], a[116:119], a[248:251], v[216:219]
    s_mov_b32 m0, s46
    v_mfma_f32_16x16x32_bf16 v[232:235], a[120:123], a[248:251], v[232:235]
    buffer_load_dwordx4 v18, s[92:95], 0 offen lds
    v_mfma_f32_16x16x32_bf16 v[248:251], a[124:127], a[248:251], v[248:251]
    s_add_u32 s46, s46, 8448
    v_add_u32 v18, 131072, v18
    v_mfma_f32_16x16x32_bf16 v[252:255], a[124:127], a[252:255], v[252:255]
    s_add_u32 s36, s36, s28
    s_mov_b32 s28, s34
    v_mfma_f32_16x16x32_bf16 v[236:239], a[120:123], a[252:255], v[236:239]
    s_mov_b32 s34, 2048
    s_mov_b32 s43, s19
    v_mfma_f32_16x16x32_bf16 v[220:223], a[116:119], a[252:255], v[220:223]
    s_mov_b32 s19, s20
    v_mfma_f32_16x16x32_bf16 v[204:207], a[112:115], a[252:255], v[204:207]
    buffer_load_dwordx4 v19, s[92:95], 0 offen offset:1056 lds
    v_mfma_f32_16x16x32_bf16 v[188:191], a[108:111], a[252:255], v[188:191]
    v_add_u32 v19, 131072, v19
    v_mfma_f32_16x16x32_bf16 v[172:175], a[104:107], a[252:255], v[172:175]
    s_sub_u32 s29, s29, 1
    v_mfma_f32_16x16x32_bf16 v[156:159], a[100:103], a[252:255], v[156:159]
    v_mfma_f32_16x16x32_bf16 v[140:143], a[96:99], a[252:255], v[140:143]
    s_branch P2_Y0
P2_tail:
    s_waitcnt vmcnt(15) lgkmcnt(0)
    s_barrier
    v_mfma_f32_16x16x32_bf16 v[200:203], a[80:83], a[232:235], v[200:203]
    v_mfma_f32_16x16x32_bf16 v[200:203], a[112:115], a[248:251], v[200:203]
    s_add_u32 s42, s36, s43
    v_mfma_f32_16x16x32_bf16 v[216:219], a[84:87], a[232:235], v[216:219]
    v_mfma_f32_16x16x32_bf16 v[216:219], a[116:119], a[248:251], v[216:219]
    ds_read_b64_tr_b16 a[0:1], v7 offset:0
    v_mfma_f32_16x16x32_bf16 v[232:235], a[88:91], a[232:235], v[232:235]
    ds_read_b64_tr_b16 a[2:3], v7 offset:512
    v_mfma_f32_16x16x32_bf16 v[232:235], a[120:123], a[248:251], v[232:235]
    v_mfma_f32_16x16x32_bf16 v[248:251], a[92:95], a[232:235], v[248:251]
    s_add_u32 m0, s39, 50688
    v_mfma_f32_16x16x32_bf16 v[248:251], a[124:127], a[248:251], v[248:251]
    v_mfma_f32_16x16x32_bf16 v[204:207], a[80:83], a[236:239], v[204:207]
    s_add_u32 s45, s35, s30
    v_mfma_f32_16x16x32_bf16 v[204:207], a[112:115], a[252:255], v[204:207]
    v_cvt_pk_bf16_f32 v200, v200, v201
    v_cvt_pk_bf16_f32 v201, v202, v203
    v_mfma_f32_16x16x32_bf16 v[220:223], a[84:87], a[236:239], v[220:223]
    v_cvt_pk_bf16_f32 v202, v216, v217
    v_cvt_pk_bf16_f32 v203, v218, v219
    v_mfma_f32_16x16x32_bf16 v[220:223], a[116:119], a[252:255], v[220:223]
    buffer_store_dwordx4 v[200:203], v23, s[12:15], 0 offen offset:0 sc1
    buffer_load_dwordx4 v4, s[8:11], s35 offen lds
    ds_read_b64_tr_b16 a[4:5], v7 offset:32
    v_mfma_f32_16x16x32_bf16 v[236:239], a[88:91], a[236:239], v[236:239]
    v_mfma_f32_16x16x32_bf16 v[236:239], a[120:123], a[252:255], v[236:239]
    v_cvt_pk_bf16_f32 v232, v232, v233
    v_cvt_pk_bf16_f32 v233, v234, v235
    v_mfma_f32_16x16x32_bf16 v[252:255], a[92:95], a[236:239], v[252:255]
    v_cvt_pk_bf16_f32 v234, v248, v249
    v_cvt_pk_bf16_f32 v235, v250, v251
    v_mfma_f32_16x16x32_bf16 v[252:255], a[124:127], a[252:255], v[252:255]
    buffer_store_dwordx4 v[232:235], v23, s[12:15], 0 offen offset:1024 sc1
    buffer_load_dwordx4 a[160:163], v2, s[4:7], s36 offen offset:0 sc1
    ds_read_b64_tr_b16 a[6:7], v7 offset:544
    v_mfma_f32_16x16x32_bf16 v[192:195], a[80:83], a[224:227], v[192:195]
    buffer_load_dwordx4 a[164:167], v3, s[4:7], s36 offen offset:0 sc1
    v_mfma_f32_16x16x32_bf16 v[192:195], a[112:115], a[240:243], v[192:195]
    v_cvt_pk_bf16_f32 v204, v204, v205
    v_cvt_pk_bf16_f32 v205, v206, v207
    v_mfma_f32_16x16x32_bf16 v[208:211], a[84:87], a[224:227], v[208:211]
    v_cvt_pk_bf16_f32 v206, v220, v221
    v_cvt_pk_bf16_f32 v207, v222, v223
    v_mfma_f32_16x16x32_bf16 v[208:211], a[116:119], a[240:243], v[208:211]
    buffer_store_dwordx4 v[204:207], v23, s[12:15], 0 offen offset:2048 sc1
    ds_read_b64_tr_b16 a[8:9], v7 offset:64
    ds_read_b64_tr_b16 a[10:11], v7 offset:576
    v_mfma_f32_16x16x32_bf16 v[224:227], a[88:91], a[224:227], v[224:227]
    v_mfma_f32_16x16x32_bf16 v[224:227], a[120:123], a[240:243], v[224:227]
    v_cvt_pk_bf16_f32 v236, v236, v237
    v_cvt_pk_bf16_f32 v237, v238, v239
    v_mfma_f32_16x16x32_bf16 v[240:243], a[92:95], a[224:227], v[240:243]
    v_cvt_pk_bf16_f32 v238, v252, v253
    v_cvt_pk_bf16_f32 v239, v254, v255
    v_mfma_f32_16x16x32_bf16 v[240:243], a[124:127], a[240:243], v[240:243]
    buffer_store_dwordx4 v[236:239], v23, s[12:15], 0 offen offset:3072 sc1
    buffer_load_dwordx4 v5, s[8:11], s35 offen offset:1056 lds
    ds_read_b64_tr_b16 a[12:13], v7 offset:96
    v_mfma_f32_16x16x32_bf16 v[196:199], a[80:83], a[228:231], v[196:199]
    buffer_load_dwordx4 a[168:171], v2, s[4:7], s42 offen offset:0 sc1
    v_mfma_f32_16x16x32_bf16 v[196:199], a[112:115], a[244:247], v[196:199]
    v_cvt_pk_bf16_f32 v192, v192, v193
    v_cvt_pk_bf16_f32 v193, v194, v195
    v_mfma_f32_16x16x32_bf16 v[212:215], a[84:87], a[228:231], v[212:215]
    v_cvt_pk_bf16_f32 v194, v208, v209
    v_cvt_pk_bf16_f32 v195, v210, v211
    v_mfma_f32_16x16x32_bf16 v[212:215], a[116:119], a[244:247], v[212:215]
    buffer_store_dwordx4 v[192:195], v22, s[12:15], 0 offen offset:0 sc1
    ds_read_b64_tr_b16 a[14:15], v7 offset:608
    buffer_load_dwordx4 a[172:175], v3, s[4:7], s42 offen offset:0 sc1
    v_mfma_f32_16x16x32_bf16 v[228:231], a[88:91], a[228:231], v[228:231]
    v_mfma_f32_16x16x32_bf16 v[228:231], a[120:123], a[244:247], v[228:231]
    v_cvt_pk_bf16_f32 v224, v224, v225
    v_cvt_pk_bf16_f32 v225, v226, v227
    v_mfma_f32_16x16x32_bf16 v[244:247], a[92:95], a[228:231], v[244:247]
    v_cvt_pk_bf16_f32 v226, v240, v241
    v_cvt_pk_bf16_f32 v227, v242, v243
    v_mfma_f32_16x16x32_bf16 v[244:247], a[124:127], a[244:247], v[244:247]
    buffer_store_dwordx4 v[224:227], v22, s[12:15], 0 offen offset:1024 sc1
    ds_read_b64_tr_b16 a[32:33], v7 offset:8448
    ds_read_b64_tr_b16 a[34:35], v7 offset:8960
    v_mfma_f32_16x16x32_bf16 v[136:139], a[64:67], a[232:235], v[136:139]
    s_add_u32 m0, m0, 8448
    v_mfma_f32_16x16x32_bf16 v[136:139], a[96:99], a[248:251], v[136:139]
    v_cvt_pk_bf16_f32 v196, v196, v197
    v_cvt_pk_bf16_f32 v197, v198, v199
    v_mfma_f32_16x16x32_bf16 v[152:155], a[68:71], a[232:235], v[152:155]
    v_cvt_pk_bf16_f32 v198, v212, v213
    v_cvt_pk_bf16_f32 v199, v214, v215
    v_mfma_f32_16x16x32_bf16 v[152:155], a[100:103], a[248:251], v[152:155]
    buffer_store_dwordx4 v[196:199], v22, s[12:15], 0 offen offset:2048 sc1
    s_add_u32 s35, s35, s31
    v_mfma_f32_16x16x32_bf16 v[168:171], a[72:75], a[232:235], v[168:171]
    buffer_load_dwordx4 v4, s[8:11], s45 offen lds
    v_mfma_f32_16x16x32_bf16 v[168:171], a[104:107], a[248:251], v[168:171]
    v_cvt_pk_bf16_f32 v228, v228, v229
    v_cvt_pk_bf16_f32 v229, v230, v231
    v_mfma_f32_16x16x32_bf16 v[184:187], a[76:79], a[232:235], v[184:187]
    v_cvt_pk_bf16_f32 v230, v244, v245
    v_cvt_pk_bf16_f32 v231, v246, v247
    v_mfma_f32_16x16x32_bf16 v[184:187], a[108:111], a[248:251], v[184:187]
    buffer_store_dwordx4 v[228:231], v22, s[12:15], 0 offen offset:3072 sc1
    ds_read_b64_tr_b16 a[36:37], v7 offset:8480
    buffer_load_dwordx4 a[176:179], v2, s[4:7], s36 offen offset:1024 sc1
    v_mfma_f32_16x16x32_bf16 v[140:143], a[64:67], a[236:239], v[140:143]
    v_mfma_f32_16x16x32_bf16 v[140:143], a[96:99], a[252:255], v[140:143]
    v_cvt_pk_bf16_f32 v136, v136, v137
    v_cvt_pk_bf16_f32 v137, v138, v139
    v_mfma_f32_16x16x32_bf16 v[156:159], a[68:71], a[236:239], v[156:159]
    v_cvt_pk_bf16_f32 v138, v152, v153
    v_cvt_pk_bf16_f32 v139, v154, v155
    v_mfma_f32_16x16x32_bf16 v[156:159], a[100:103], a[252:255], v[156:159]
    buffer_store_dwordx4 v[136:139], v21, s[12:15], 0 offen offset:0 sc1
    ds_read_b64_tr_b16 a[38:39], v7 offset:8992
    buffer_load_dwordx4 a[180:183], v3, s[4:7], s36 offen offset:1024 sc1
    v_mfma_f32_16x16x32_bf16 v[172:175], a[72:75], a[236:239], v[172:175]
    ds_read_b64_tr_b16 a[40:41], v7 offset:8512
    v_mfma_f32_16x16x32_bf16 v[172:175], a[104:107], a[252:255], v[172:175]
    v_cvt_pk_bf16_f32 v168, v168, v169
    v_cvt_pk_bf16_f32 v169, v170, v171
    v_mfma_f32_16x16x32_bf16 v[188:191], a[76:79], a[236:239], v[188:191]
    v_cvt_pk_bf16_f32 v170, v184, v185
    v_cvt_pk_bf16_f32 v171, v186, v187
    v_mfma_f32_16x16x32_bf16 v[188:191], a[108:111], a[252:255], v[188:191]
    buffer_store_dwordx4 v[168:171], v21, s[12:15], 0 offen offset:1024 sc1
    ds_read_b64_tr_b16 a[42:43], v7 offset:9024
    buffer_load_dwordx4 v5, s[8:11], s45 offen offset:1056 lds
    v_mfma_f32_16x16x32_bf16 v[128:131], a[64:67], a[224:227], v[128:131]
    v_mfma_f32_16x16x32_bf16 v[128:131], a[96:99], a[240:243], v[128:131]
    v_cvt_pk_bf16_f32 v140, v140, v141
    v_cvt_pk_bf16_f32 v141, v142, v143
    v_mfma_f32_16x16x32_bf16 v[144:147], a[68:71], a[224:227], v[144:147]
    v_cvt_pk_bf16_f32 v142, v156, v157
    v_cvt_pk_bf16_f32 v143, v158, v159
    v_mfma_f32_16x16x32_bf16 v[144:147], a[100:103], a[240:243], v[144:147]
    buffer_store_dwordx4 v[140:143], v21, s[12:15], 0 offen offset:2048 sc1
    ds_read_b64_tr_b16 a[44:45], v7 offset:8544
    buffer_load_dwordx4 a[184:187], v2, s[4:7], s42 offen offset:1024 sc1
    v_mfma_f32_16x16x32_bf16 v[160:163], a[72:75], a[224:227], v[160:163]
    ds_read_b64_tr_b16 a[46:47], v7 offset:9056
    v_mfma_f32_16x16x32_bf16 v[160:163], a[104:107], a[240:243], v[160:163]
    v_cvt_pk_bf16_f32 v172, v172, v173
    v_cvt_pk_bf16_f32 v173, v174, v175
    v_mfma_f32_16x16x32_bf16 v[176:179], a[76:79], a[224:227], v[176:179]
    v_cvt_pk_bf16_f32 v174, v188, v189
    v_cvt_pk_bf16_f32 v175, v190, v191
    v_mfma_f32_16x16x32_bf16 v[176:179], a[108:111], a[240:243], v[176:179]
    buffer_store_dwordx4 v[172:175], v21, s[12:15], 0 offen offset:3072 sc1
    buffer_load_dwordx4 a[188:191], v3, s[4:7], s42 offen offset:1024 sc1
    s_add_u32 s36, s36, 2048
    v_mfma_f32_16x16x32_bf16 v[132:135], a[64:67], a[228:231], v[132:135]
    v_mfma_f32_16x16x32_bf16 v[132:135], a[96:99], a[244:247], v[132:135]
    v_mfma_f32_16x16x32_bf16 v[148:151], a[68:71], a[228:231], v[148:151]
    v_mfma_f32_16x16x32_bf16 v[148:151], a[100:103], a[244:247], v[148:151]
    v_mfma_f32_16x16x32_bf16 v[164:167], a[72:75], a[228:231], v[164:167]
    v_mfma_f32_16x16x32_bf16 v[164:167], a[104:107], a[244:247], v[164:167]
    v_mfma_f32_16x16x32_bf16 v[180:183], a[76:79], a[228:231], v[180:183]
    v_mfma_f32_16x16x32_bf16 v[180:183], a[108:111], a[244:247], v[180:183]
    s_waitcnt vmcnt(24) lgkmcnt(0)
    s_barrier
    v_mfma_f32_16x16x32_bf16 v[96:99], a[0:3], a[128:131], v[96:99]
    buffer_load_dwordx4 a[192:195], v2, s[4:7], s36 offen offset:0 sc1
    ds_read_b64_tr_b16 a[64:65], v7 offset:16896
    v_mfma_f32_16x16x32_bf16 v[100:103], a[0:3], a[132:135], v[100:103]
    buffer_load_dwordx4 a[196:199], v3, s[4:7], s36 offen offset:0 sc1
    ds_read_b64_tr_b16 a[66:67], v7 offset:17408
    v_mfma_f32_16x16x32_bf16 v[104:107], a[4:7], a[128:131], v[104:107]
    ds_read_b64_tr_b16 a[68:69], v7 offset:16928
    buffer_load_dwordx4 a[208:211], v2, s[4:7], s36 offen offset:1024 sc1
    v_mfma_f32_16x16x32_bf16 v[108:111], a[4:7], a[132:135], v[108:111]
    ds_read_b64_tr_b16 a[70:71], v7 offset:17440
    v_mfma_f32_16x16x32_bf16 v[112:115], a[8:11], a[128:131], v[112:115]
    ds_read_b64_tr_b16 a[72:73], v7 offset:16960
    buffer_load_dwordx4 a[212:215], v3, s[4:7], s36 offen offset:1024 sc1
    v_mfma_f32_16x16x32_bf16 v[116:119], a[8:11], a[132:135], v[116:119]
    s_add_u32 s36, s36, 2048
    ds_read_b64_tr_b16 a[74:75], v7 offset:17472
    v_mfma_f32_16x16x32_bf16 v[120:123], a[12:15], a[128:131], v[120:123]
    ds_read_b64_tr_b16 a[76:77], v7 offset:16992
    buffer_load_dwordx4 a[224:227], v2, s[4:7], s36 offen offset:0 sc1
    v_mfma_f32_16x16x32_bf16 v[124:127], a[12:15], a[132:135], v[124:127]
    ds_read_b64_tr_b16 a[78:79], v7 offset:17504
    v_mfma_f32_16x16x32_bf16 v[96:99], a[32:35], a[144:147], v[96:99]
    buffer_load_dwordx4 a[228:231], v3, s[4:7], s36 offen offset:0 sc1
    ds_read_b64_tr_b16 a[96:97], v7 offset:25344
    v_mfma_f32_16x16x32_bf16 v[100:103], a[32:35], a[148:151], v[100:103]
    ds_read_b64_tr_b16 a[98:99], v7 offset:25856
    buffer_load_dwordx4 a[240:243], v2, s[4:7], s36 offen offset:1024 sc1
    v_mfma_f32_16x16x32_bf16 v[104:107], a[36:39], a[144:147], v[104:107]
    ds_read_b64_tr_b16 a[100:101], v7 offset:25376
    ds_read_b64_tr_b16 a[102:103], v7 offset:25888
    v_mfma_f32_16x16x32_bf16 v[108:111], a[36:39], a[148:151], v[108:111]
    buffer_load_dwordx4 a[244:247], v3, s[4:7], s36 offen offset:1024 sc1
    v_mfma_f32_16x16x32_bf16 v[112:115], a[40:43], a[144:147], v[112:115]
    s_add_u32 s36, s36, 6144
    ds_read_b64_tr_b16 a[104:105], v7 offset:25408
    v_mfma_f32_16x16x32_bf16 v[116:119], a[40:43], a[148:151], v[116:119]
    ds_read_b64_tr_b16 a[106:107], v7 offset:25920
    ds_read_b64_tr_b16 a[108:109], v7 offset:25440
    v_mfma_f32_16x16x32_bf16 v[120:123], a[44:47], a[144:147], v[120:123]
    ds_read_b64_tr_b16 a[110:111], v7 offset:25952
    v_mfma_f32_16x16x32_bf16 v[124:127], a[44:47], a[148:151], v[124:127]
    s_waitcnt vmcnt(8) lgkmcnt(0)
    s_barrier
    v_mfma_f32_16x16x32_bf16 v[96:99], a[64:67], a[160:163], v[96:99]
    buffer_load_dwordx4 a[200:203], v2, s[4:7], s36 offen offset:0 sc1
    ds_read_b64_tr_b16 a[0:1], v7 offset:33792
    v_mfma_f32_16x16x32_bf16 v[100:103], a[64:67], a[164:167], v[100:103]
    ds_read_b64_tr_b16 a[2:3], v7 offset:34304
    v_mfma_f32_16x16x32_bf16 v[104:107], a[68:71], a[160:163], v[104:107]
    ds_read_b64_tr_b16 a[4:5], v7 offset:33824
    buffer_load_dwordx4 a[204:207], v3, s[4:7], s36 offen offset:0 sc1
    v_mfma_f32_16x16x32_bf16 v[108:111], a[68:71], a[164:167], v[108:111]
    ds_read_b64_tr_b16 a[6:7], v7 offset:34336
    v_mfma_f32_16x16x32_bf16 v[112:115], a[72:75], a[160:163], v[112:115]
    ds_read_b64_tr_b16 a[8:9], v7 offset:33856
    v_mfma_f32_16x16x32_bf16 v[116:119], a[72:75], a[164:167], v[116:119]
    ds_read_b64_tr_b16 a[10:11], v7 offset:34368
    ds_read_b64_tr_b16 a[12:13], v7 offset:33888
    v_mfma_f32_16x16x32_bf16 v[120:123], a[76:79], a[160:163], v[120:123]
    buffer_load_dwordx4 a[216:219], v2, s[4:7], s36 offen offset:1024 sc1
    v_mfma_f32_16x16x32_bf16 v[124:127], a[76:79], a[164:167], v[124:127]
    ds_read_b64_tr_b16 a[14:15], v7 offset:34400
    ds_read_b64_tr_b16 a[32:33], v7 offset:42240
    v_mfma_f32_16x16x32_bf16 v[96:99], a[96:99], a[176:179], v[96:99]
    ds_read_b64_tr_b16 a[34:35], v7 offset:42752
    v_mfma_f32_16x16x32_bf16 v[100:103], a[96:99], a[180:183], v[100:103]
    buffer_load_dwordx4 a[220:223], v3, s[4:7], s36 offen offset:1024 sc1
    v_mfma_f32_16x16x32_bf16 v[104:107], a[100:103], a[176:179], v[104:107]
    s_add_u32 s36, s36, 2048
    ds_read_b64_tr_b16 a[36:37], v7 offset:42272
    v_mfma_f32_16x16x32_bf16 v[108:111], a[100:103], a[180:183], v[108:111]
    ds_read_b64_tr_b16 a[38:39], v7 offset:42784
    v_mfma_f32_16x16x32_bf16 v[112:115], a[104:107], a[176:179], v[112:115]
    ds_read_b64_tr_b16 a[40:41], v7 offset:42304
    ds_read_b64_tr_b16 a[42:43], v7 offset:42816
    v_mfma_f32_16x16x32_bf16 v[116:119], a[104:107], a[180:183], v[116:119]
    ds_read_b64_tr_b16 a[44:45], v7 offset:42336
    v_mfma_f32_16x16x32_bf16 v[120:123], a[108:111], a[176:179], v[120:123]
    ds_read_b64_tr_b16 a[46:47], v7 offset:42848
    v_mfma_f32_16x16x32_bf16 v[124:127], a[108:111], a[180:183], v[124:127]
    s_waitcnt vmcnt(8) lgkmcnt(0)
    s_barrier
    v_mfma_f32_16x16x32_bf16 v[96:99], a[0:3], a[192:195], v[96:99]
    buffer_load_dwordx4 a[232:235], v2, s[4:7], s36 offen offset:0 sc1
    ds_read_b64_tr_b16 a[64:65], v7 offset:50688
    v_mfma_f32_16x16x32_bf16 v[100:103], a[0:3], a[196:199], v[100:103]
    ds_read_b64_tr_b16 a[66:67], v7 offset:51200
    v_mfma_f32_16x16x32_bf16 v[104:107], a[4:7], a[192:195], v[104:107]
    ds_read_b64_tr_b16 a[68:69], v7 offset:50720
    buffer_load_dwordx4 a[236:239], v3, s[4:7], s36 offen offset:0 sc1
    v_mfma_f32_16x16x32_bf16 v[108:111], a[4:7], a[196:199], v[108:111]
    ds_read_b64_tr_b16 a[70:71], v7 offset:51232
    v_mfma_f32_16x16x32_bf16 v[112:115], a[8:11], a[192:195], v[112:115]
    ds_read_b64_tr_b16 a[72:73], v7 offset:50752
    v_mfma_f32_16x16x32_bf16 v[116:119], a[8:11], a[196:199], v[116:119]
    ds_read_b64_tr_b16 a[74:75], v7 offset:51264
    ds_read_b64_tr_b16 a[76:77], v7 offset:50784
    v_mfma_f32_16x16x32_bf16 v[120:123], a[12:15], a[192:195], v[120:123]
    buffer_load_dwordx4 a[248:251], v2, s[4:7], s36 offen offset:1024 sc1
    v_mfma_f32_16x16x32_bf16 v[124:127], a[12:15], a[196:199], v[124:127]
    ds_read_b64_tr_b16 a[78:79], v7 offset:51296
    ds_read_b64_tr_b16 a[96:97], v7 offset:59136
    v_mfma_f32_16x16x32_bf16 v[96:99], a[32:35], a[208:211], v[96:99]
    ds_read_b64_tr_b16 a[98:99], v7 offset:59648
    v_mfma_f32_16x16x32_bf16 v[100:103], a[32:35], a[212:215], v[100:103]
    buffer_load_dwordx4 a[252:255], v3, s[4:7], s36 offen offset:1024 sc1
    v_mfma_f32_16x16x32_bf16 v[104:107], a[36:39], a[208:211], v[104:107]
    s_add_u32 s36, s36, 2048
    ds_read_b64_tr_b16 a[100:101], v7 offset:59168
    v_mfma_f32_16x16x32_bf16 v[108:111], a[36:39], a[212:215], v[108:111]
    ds_read_b64_tr_b16 a[102:103], v7 offset:59680
    v_mfma_f32_16x16x32_bf16 v[112:115], a[40:43], a[208:211], v[112:115]
    ds_read_b64_tr_b16 a[104:105], v7 offset:59200
    ds_read_b64_tr_b16 a[106:107], v7 offset:59712
    v_mfma_f32_16x16x32_bf16 v[116:119], a[40:43], a[212:215], v[116:119]
    ds_read_b64_tr_b16 a[108:109], v7 offset:59232
    v_mfma_f32_16x16x32_bf16 v[120:123], a[44:47], a[208:211], v[120:123]
    ds_read_b64_tr_b16 a[110:111], v7 offset:59744
    v_mfma_f32_16x16x32_bf16 v[124:127], a[44:47], a[212:215], v[124:127]
    s_waitcnt vmcnt(8) lgkmcnt(0)
    s_barrier
    v_mfma_f32_16x16x32_bf16 v[96:99], a[64:67], a[224:227], v[96:99]
    s_cmp_lg_u32 s18, 0
    s_cbranch_scc1 P2_ysig
    v_mov_b32 v16, s41
    v_mov_b32 v17, 1
    s_mov_b64 exec, 1
    global_atomic_add v16, v17, s[16:17] sc1
    s_mov_b64 exec, -1
P2_ysig:
    buffer_load_dwordx4 a[128:131], v2, s[4:7], s36 offen offset:0 sc1
    v_mfma_f32_16x16x32_bf16 v[100:103], a[64:67], a[228:231], v[100:103]
    ds_read_b64_tr_b16 a[0:1], v29 offset:0
    v_mfma_f32_16x16x32_bf16 v[104:107], a[68:71], a[224:227], v[104:107]
    ds_read_b64_tr_b16 a[2:3], v29 offset:256
    ds_read_b64_tr_b16 a[4:5], v29 offset:32
    v_mfma_f32_16x16x32_bf16 v[108:111], a[68:71], a[228:231], v[108:111]
    buffer_load_dwordx4 a[132:135], v3, s[4:7], s36 offen offset:0 sc1
    v_mfma_f32_16x16x32_bf16 v[112:115], a[72:75], a[224:227], v[112:115]
    ds_read_b64_tr_b16 a[6:7], v29 offset:288
    ds_read_b64_tr_b16 a[8:9], v29 offset:64
    v_mfma_f32_16x16x32_bf16 v[116:119], a[72:75], a[228:231], v[116:119]
    ds_read_b64_tr_b16 a[10:11], v29 offset:320
    v_mfma_f32_16x16x32_bf16 v[120:123], a[76:79], a[224:227], v[120:123]
    ds_read_b64_tr_b16 a[12:13], v29 offset:96
    buffer_load_dwordx4 a[144:147], v2, s[4:7], s36 offen offset:1024 sc1
    v_mfma_f32_16x16x32_bf16 v[124:127], a[76:79], a[228:231], v[124:127]
    ds_read_b64_tr_b16 a[14:15], v29 offset:352
    v_mfma_f32_16x16x32_bf16 v[96:99], a[96:99], a[240:243], v[96:99]
    ds_read_b64_tr_b16 a[32:33], v29 offset:512
    ds_read_b64_tr_b16 a[34:35], v29 offset:768
    v_mfma_f32_16x16x32_bf16 v[100:103], a[96:99], a[244:247], v[100:103]
    buffer_load_dwordx4 a[148:151], v3, s[4:7], s36 offen offset:1024 sc1
    v_mfma_f32_16x16x32_bf16 v[104:107], a[100:103], a[240:243], v[104:107]
    s_add_u32 s36, s36, 2048
    ds_read_b64_tr_b16 a[36:37], v29 offset:544
    v_mfma_f32_16x16x32_bf16 v[108:111], a[100:103], a[244:247], v[108:111]
    ds_read_b64_tr_b16 a[38:39], v29 offset:800
    v_mfma_f32_16x16x32_bf16 v[112:115], a[104:107], a[240:243], v[112:115]
    ds_read_b64_tr_b16 a[40:41], v29 offset:576
    ds_read_b64_tr_b16 a[42:43], v29 offset:832
    v_mfma_f32_16x16x32_bf16 v[116:119], a[104:107], a[244:247], v[116:119]
    ds_read_b64_tr_b16 a[44:45], v29 offset:608
    v_mfma_f32_16x16x32_bf16 v[120:123], a[108:111], a[240:243], v[120:123]
    ds_read_b64_tr_b16 a[46:47], v29 offset:864
    v_mfma_f32_16x16x32_bf16 v[124:127], a[108:111], a[244:247], v[124:127]
    s_waitcnt vmcnt(12) lgkmcnt(0)
    v_mfma_f32_16x16x32_bf16 v[96:99], a[0:3], a[136:139], v[96:99]
    buffer_load_dwordx4 a[160:163], v2, s[4:7], s36 offen offset:0 sc1
    ds_read_b64_tr_b16 a[64:65], v29 offset:8448
    v_mfma_f32_16x16x32_bf16 v[100:103], a[0:3], a[140:143], v[100:103]
    ds_read_b64_tr_b16 a[66:67], v29 offset:8704
    buffer_load_dwordx4 a[164:167], v3, s[4:7], s36 offen offset:0 sc1
    v_mfma_f32_16x16x32_bf16 v[104:107], a[4:7], a[136:139], v[104:107]
    ds_read_b64_tr_b16 a[68:69], v29 offset:8480
    v_mfma_f32_16x16x32_bf16 v[108:111], a[4:7], a[140:143], v[108:111]
    ds_read_b64_tr_b16 a[70:71], v29 offset:8736
    buffer_load_dwordx4 a[176:179], v2, s[4:7], s36 offen offset:1024 sc1
    v_mfma_f32_16x16x32_bf16 v[112:115], a[8:11], a[136:139], v[112:115]
    ds_read_b64_tr_b16 a[72:73], v29 offset:8512
    v_mfma_f32_16x16x32_bf16 v[116:119], a[8:11], a[140:143], v[116:119]
    ds_read_b64_tr_b16 a[74:75], v29 offset:8768
    ds_read_b64_tr_b16 a[76:77], v29 offset:8544
    v_mfma_f32_16x16x32_bf16 v[120:123], a[12:15], a[136:139], v[120:123]
    buffer_load_dwordx4 a[180:183], v3, s[4:7], s36 offen offset:1024 sc1
    s_add_u32 s36, s36, 2048
    v_mfma_f32_16x16x32_bf16 v[124:127], a[12:15], a[140:143], v[124:127]
    ds_read_b64_tr_b16 a[78:79], v29 offset:8800
    v_mfma_f32_16x16x32_bf16 v[96:99], a[32:35], a[152:155], v[96:99]
    ds_read_b64_tr_b16 a[96:97], v29 offset:8960
    s_mov_b32 m0, s39
    v_mfma_f32_16x16x32_bf16 v[100:103], a[32:35], a[156:159], v[100:103]
    buffer_load_dwordx4 v27, s[8:11], 0 offen lds
    v_mfma_f32_16x16x32_bf16 v[104:107], a[36:39], a[152:155], v[104:107]
    ds_read_b64_tr_b16 a[98:99], v29 offset:9216
    ds_read_b64_tr_b16 a[100:101], v29 offset:8992
    v_mfma_f32_16x16x32_bf16 v[108:111], a[36:39], a[156:159], v[108:111]
    buffer_load_dwordx4 v28, s[8:11], 0 offen offset:1056 lds
    ds_read_b64_tr_b16 a[102:103], v29 offset:9248
    v_mfma_f32_16x16x32_bf16 v[112:115], a[40:43], a[152:155], v[112:115]
    ds_read_b64_tr_b16 a[104:105], v29 offset:9024
    v_mfma_f32_16x16x32_bf16 v[116:119], a[40:43], a[156:159], v[116:119]
    ds_read_b64_tr_b16 a[106:107], v29 offset:9280
    ds_read_b64_tr_b16 a[108:109], v29 offset:9056
    v_mfma_f32_16x16x32_bf16 v[120:123], a[44:47], a[152:155], v[120:123]
    ds_read_b64_tr_b16 a[110:111], v29 offset:9312
    v_mfma_f32_16x16x32_bf16 v[124:127], a[44:47], a[156:159], v[124:127]
    s_waitcnt vmcnt(18) lgkmcnt(0)
    v_mfma_f32_16x16x32_bf16 v[96:99], a[64:67], a[168:171], v[96:99]
    v_and_b32 v230, 15, v1
    v_lshrrev_b32 v231, 4, v1
    v_lshlrev_b32 v231, 2, v231
    v_sub_u32 v230, v230, v231
    v_mfma_f32_16x16x32_bf16 v[100:103], a[64:67], a[172:175], v[100:103]
    v_lshlrev_b32 v231, 4, v230
    v_mov_b32 v232, 0x3f80
    v_lshlrev_b32 v231, v231, v232
    v_lshrrev_b32 v230, 1, v230
    v_mfma_f32_16x16x32_bf16 v[104:107], a[68:71], a[168:171], v[104:107]
    v_cmp_eq_u32 vcc, 0, v230
    v_mov_b64 v[224:225], 0
    s_nop 0
    v_cndmask_b32 v226, 0, v231, vcc
    v_cmp_eq_u32 vcc, 1, v230
    v_mfma_f32_16x16x32_bf16 v[108:111], a[68:71], a[172:175], v[108:111]
    v_mov_b64 v[228:229], 0
    v_cndmask_b32 v227, 0, v231, vcc
    buffer_load_dwordx4 a[192:195], v2, s[4:7], s36 offen offset:0 sc1
    v_mfma_f32_16x16x32_bf16 v[112:115], a[72:75], a[168:171], v[112:115]
    ds_read_b64_tr_b16 a[0:1], v29 offset:16896
    ds_read_b64_tr_b16 a[2:3], v29 offset:17152
    v_mfma_f32_16x16x32_bf16 v[116:119], a[72:75], a[172:175], v[116:119]
    ds_read_b64_tr_b16 a[4:5], v29 offset:16928
    buffer_load_dwordx4 a[196:199], v3, s[4:7], s36 offen offset:0 sc1
    v_mfma_f32_16x16x32_bf16 v[120:123], a[76:79], a[168:171], v[120:123]
    ds_read_b64_tr_b16 a[6:7], v29 offset:17184
    ds_read_b64_tr_b16 a[8:9], v29 offset:16960
    v_mfma_f32_16x16x32_bf16 v[124:127], a[76:79], a[172:175], v[124:127]
    ds_read_b64_tr_b16 a[10:11], v29 offset:17216
    v_mfma_f32_16x16x32_bf16 v[96:99], a[96:99], a[184:187], v[96:99]
    ds_read_b64_tr_b16 a[12:13], v29 offset:16992
    buffer_load_dwordx4 a[208:211], v2, s[4:7], s36 offen offset:1024 sc1
    v_mfma_f32_16x16x32_bf16 v[100:103], a[96:99], a[188:191], v[100:103]
    ds_read_b64_tr_b16 a[14:15], v29 offset:17248
    ds_read_b64_tr_b16 a[32:33], v29 offset:17408
    v_mfma_f32_16x16x32_bf16 v[104:107], a[100:103], a[184:187], v[104:107]
    ds_read_b64_tr_b16 a[34:35], v29 offset:17664
    buffer_load_dwordx4 a[212:215], v3, s[4:7], s36 offen offset:1024 sc1
    v_mfma_f32_16x16x32_bf16 v[108:111], a[100:103], a[188:191], v[108:111]
    s_add_u32 s36, s36, 2048
    ds_read_b64_tr_b16 a[36:37], v29 offset:17440
    v_mfma_f32_16x16x32_bf16 v[112:115], a[104:107], a[184:187], v[112:115]
    ds_read_b64_tr_b16 a[38:39], v29 offset:17696
    ds_read_b64_tr_b16 a[40:41], v29 offset:17472
    v_mfma_f32_16x16x32_bf16 v[116:119], a[104:107], a[188:191], v[116:119]
    ds_read_b64_tr_b16 a[42:43], v29 offset:17728
    ds_read_b64_tr_b16 a[44:45], v29 offset:17504
    v_mfma_f32_16x16x32_bf16 v[120:123], a[108:111], a[184:187], v[120:123]
    ds_read_b64_tr_b16 a[46:47], v29 offset:17760
    v_mfma_f32_16x16x32_bf16 v[124:127], a[108:111], a[188:191], v[124:127]
    s_waitcnt vmcnt(18) lgkmcnt(0)
    v_mfma_f32_16x16x32_bf16 v[96:99], a[0:3], a[200:203], v[96:99]
    buffer_load_dwordx4 a[224:227], v2, s[4:7], s36 offen offset:0 sc1
    ds_read_b64_tr_b16 a[64:65], v29 offset:25344
    v_mfma_f32_16x16x32_bf16 v[100:103], a[0:3], a[204:207], v[100:103]
    ds_read_b64_tr_b16 a[66:67], v29 offset:25600
    v_mfma_f32_16x16x32_bf16 v[104:107], a[4:7], a[200:203], v[104:107]
    ds_read_b64_tr_b16 a[68:69], v29 offset:25376
    buffer_load_dwordx4 a[228:231], v3, s[4:7], s36 offen offset:0 sc1
    v_mfma_f32_16x16x32_bf16 v[108:111], a[4:7], a[204:207], v[108:111]
    ds_read_b64_tr_b16 a[70:71], v29 offset:25632
    v_mfma_f32_16x16x32_bf16 v[112:115], a[8:11], a[200:203], v[112:115]
    ds_read_b64_tr_b16 a[72:73], v29 offset:25408
    v_mfma_f32_16x16x32_bf16 v[116:119], a[8:11], a[204:207], v[116:119]
    ds_read_b64_tr_b16 a[74:75], v29 offset:25664
    ds_read_b64_tr_b16 a[76:77], v29 offset:25440
    v_mfma_f32_16x16x32_bf16 v[120:123], a[12:15], a[200:203], v[120:123]
    buffer_load_dwordx4 a[240:243], v2, s[4:7], s36 offen offset:1024 sc1
    v_mfma_f32_16x16x32_bf16 v[124:127], a[12:15], a[204:207], v[124:127]
    ds_read_b64_tr_b16 a[78:79], v29 offset:25696
    ds_read_b64_tr_b16 a[96:97], v29 offset:25856
    v_mfma_f32_16x16x32_bf16 v[96:99], a[32:35], a[216:219], v[96:99]
    ds_read_b64_tr_b16 a[98:99], v29 offset:26112
    v_mfma_f32_16x16x32_bf16 v[100:103], a[32:35], a[220:223], v[100:103]
    buffer_load_dwordx4 a[244:247], v3, s[4:7], s36 offen offset:1024 sc1
    v_mfma_f32_16x16x32_bf16 v[104:107], a[36:39], a[216:219], v[104:107]
    s_add_u32 s36, s36, 2048
    ds_read_b64_tr_b16 a[100:101], v29 offset:25888
    v_mfma_f32_16x16x32_bf16 v[108:111], a[36:39], a[220:223], v[108:111]
    ds_read_b64_tr_b16 a[102:103], v29 offset:26144
    v_mfma_f32_16x16x32_bf16 v[112:115], a[40:43], a[216:219], v[112:115]
    ds_read_b64_tr_b16 a[104:105], v29 offset:25920
    ds_read_b64_tr_b16 a[106:107], v29 offset:26176
    v_mfma_f32_16x16x32_bf16 v[116:119], a[40:43], a[220:223], v[116:119]
    ds_read_b64_tr_b16 a[108:109], v29 offset:25952
    v_mfma_f32_16x16x32_bf16 v[120:123], a[44:47], a[216:219], v[120:123]
    ds_read_b64_tr_b16 a[110:111], v29 offset:26208
    v_mfma_f32_16x16x32_bf16 v[124:127], a[44:47], a[220:223], v[124:127]
    s_waitcnt vmcnt(18) lgkmcnt(0)
    v_mfma_f32_16x16x32_bf16 v[96:99], a[64:67], a[232:235], v[96:99]
    buffer_load_dwordx4 a[136:139], v2, s[4:7], s36 offen offset:0 sc1
    ds_read_b64_tr_b16 a[0:1], v29 offset:33792
    v_mfma_f32_16x16x32_bf16 v[100:103], a[64:67], a[236:239], v[100:103]
    ds_read_b64_tr_b16 a[2:3], v29 offset:34048
    v_mfma_f32_16x16x32_bf16 v[104:107], a[68:71], a[232:235], v[104:107]
    ds_read_b64_tr_b16 a[4:5], v29 offset:33824
    buffer_load_dwordx4 a[140:143], v3, s[4:7], s36 offen offset:0 sc1
    v_mfma_f32_16x16x32_bf16 v[108:111], a[68:71], a[236:239], v[108:111]
    ds_read_b64_tr_b16 a[6:7], v29 offset:34080
    v_mfma_f32_16x16x32_bf16 v[112:115], a[72:75], a[232:235], v[112:115]
    ds_read_b64_tr_b16 a[8:9], v29 offset:33856
    v_mfma_f32_16x16x32_bf16 v[116:119], a[72:75], a[236:239], v[116:119]
    ds_read_b64_tr_b16 a[10:11], v29 offset:34112
    ds_read_b64_tr_b16 a[12:13], v29 offset:33888
    v_mfma_f32_16x16x32_bf16 v[120:123], a[76:79], a[232:235], v[120:123]
    buffer_load_dwordx4 a[152:155], v2, s[4:7], s36 offen offset:1024 sc1
    v_mfma_f32_16x16x32_bf16 v[124:127], a[76:79], a[236:239], v[124:127]
    ds_read_b64_tr_b16 a[14:15], v29 offset:34144
    ds_read_b64_tr_b16 a[32:33], v29 offset:34304
    v_mfma_f32_16x16x32_bf16 v[96:99], a[96:99], a[248:251], v[96:99]
    ds_read_b64_tr_b16 a[34:35], v29 offset:34560
    v_mfma_f32_16x16x32_bf16 v[100:103], a[96:99], a[252:255], v[100:103]
    buffer_load_dwordx4 a[156:159], v3, s[4:7], s36 offen offset:1024 sc1
    v_mfma_f32_16x16x32_bf16 v[104:107], a[100:103], a[248:251], v[104:107]
    s_add_u32 s36, s36, 2048
    ds_read_b64_tr_b16 a[36:37], v29 offset:34336
    v_mfma_f32_16x16x32_bf16 v[108:111], a[100:103], a[252:255], v[108:111]
    ds_read_b64_tr_b16 a[38:39], v29 offset:34592
    v_mfma_f32_16x16x32_bf16 v[112:115], a[104:107], a[248:251], v[112:115]
    ds_read_b64_tr_b16 a[40:41], v29 offset:34368
    ds_read_b64_tr_b16 a[42:43], v29 offset:34624
    v_mfma_f32_16x16x32_bf16 v[116:119], a[104:107], a[252:255], v[116:119]
    ds_read_b64_tr_b16 a[44:45], v29 offset:34400
    v_mfma_f32_16x16x32_bf16 v[120:123], a[108:111], a[248:251], v[120:123]
    ds_read_b64_tr_b16 a[46:47], v29 offset:34656
    v_mfma_f32_16x16x32_bf16 v[124:127], a[108:111], a[252:255], v[124:127]
    s_waitcnt vmcnt(18) lgkmcnt(0)
    v_mfma_f32_16x16x32_bf16 v[96:99], a[0:3], a[128:131], v[96:99]
    buffer_load_dwordx4 a[168:171], v2, s[4:7], s36 offen offset:0 sc1
    ds_read_b64_tr_b16 a[64:65], v29 offset:42240
    v_mfma_f32_16x16x32_bf16 v[100:103], a[0:3], a[132:135], v[100:103]
    ds_read_b64_tr_b16 a[66:67], v29 offset:42496
    v_mfma_f32_16x16x32_bf16 v[104:107], a[4:7], a[128:131], v[104:107]
    ds_read_b64_tr_b16 a[68:69], v29 offset:42272
    buffer_load_dwordx4 a[172:175], v3, s[4:7], s36 offen offset:0 sc1
    v_mfma_f32_16x16x32_bf16 v[108:111], a[4:7], a[132:135], v[108:111]
    ds_read_b64_tr_b16 a[70:71], v29 offset:42528
    v_mfma_f32_16x16x32_bf16 v[112:115], a[8:11], a[128:131], v[112:115]
    ds_read_b64_tr_b16 a[72:73], v29 offset:42304
    v_mfma_f32_16x16x32_bf16 v[116:119], a[8:11], a[132:135], v[116:119]
    ds_read_b64_tr_b16 a[74:75], v29 offset:42560
    ds_read_b64_tr_b16 a[76:77], v29 offset:42336
    v_mfma_f32_16x16x32_bf16 v[120:123], a[12:15], a[128:131], v[120:123]
    buffer_load_dwordx4 a[184:187], v2, s[4:7], s36 offen offset:1024 sc1
    v_mfma_f32_16x16x32_bf16 v[124:127], a[12:15], a[132:135], v[124:127]
    ds_read_b64_tr_b16 a[78:79], v29 offset:42592
    ds_read_b64_tr_b16 a[96:97], v29 offset:42752
    v_mfma_f32_16x16x32_bf16 v[96:99], a[32:35], a[144:147], v[96:99]
    ds_read_b64_tr_b16 a[98:99], v29 offset:43008
    v_mfma_f32_16x16x32_bf16 v[100:103], a[32:35], a[148:151], v[100:103]
    buffer_load_dwordx4 a[188:191], v3, s[4:7], s36 offen offset:1024 sc1
    v_mfma_f32_16x16x32_bf16 v[104:107], a[36:39], a[144:147], v[104:107]
    s_add_u32 s36, s36, 2048
    ds_read_b64_tr_b16 a[100:101], v29 offset:42784
    v_mfma_f32_16x16x32_bf16 v[108:111], a[36:39], a[148:151], v[108:111]
    ds_read_b64_tr_b16 a[102:103], v29 offset:43040
    v_mfma_f32_16x16x32_bf16 v[112:115], a[40:43], a[144:147], v[112:115]
    ds_read_b64_tr_b16 a[104:105], v29 offset:42816
    ds_read_b64_tr_b16 a[106:107], v29 offset:43072
    v_mfma_f32_16x16x32_bf16 v[116:119], a[40:43], a[148:151], v[116:119]
    ds_read_b64_tr_b16 a[108:109], v29 offset:42848
    v_mfma_f32_16x16x32_bf16 v[120:123], a[44:47], a[144:147], v[120:123]
    ds_read_b64_tr_b16 a[110:111], v29 offset:43104
    v_mfma_f32_16x16x32_bf16 v[124:127], a[44:47], a[148:151], v[124:127]
    s_waitcnt vmcnt(18) lgkmcnt(0)
    v_mfma_f32_16x16x32_bf16 v[96:99], a[64:67], a[160:163], v[96:99]
    global_load_dword v13, v12, s[16:17] sc1
    buffer_load_dwordx4 a[200:203], v2, s[4:7], s36 offen offset:0 sc1
    v_mfma_f32_16x16x32_bf16 v[100:103], a[64:67], a[164:167], v[100:103]
    ds_read_b64_tr_b16 a[0:1], v29 offset:50688
    v_mfma_f32_16x16x32_bf16 v[104:107], a[68:71], a[160:163], v[104:107]
    ds_read_b64_tr_b16 a[2:3], v29 offset:50944
    ds_read_b64_tr_b16 a[4:5], v29 offset:50720
    v_mfma_f32_16x16x32_bf16 v[108:111], a[68:71], a[164:167], v[108:111]
    buffer_load_dwordx4 a[204:207], v3, s[4:7], s36 offen offset:0 sc1
    v_mfma_f32_16x16x32_bf16 v[112:115], a[72:75], a[160:163], v[112:115]
    ds_read_b64_tr_b16 a[6:7], v29 offset:50976
    ds_read_b64_tr_b16 a[8:9], v29 offset:50752
    v_mfma_f32_16x16x32_bf16 v[116:119], a[72:75], a[164:167], v[116:119]
    ds_read_b64_tr_b16 a[10:11], v29 offset:51008
    v_mfma_f32_16x16x32_bf16 v[120:123], a[76:79], a[160:163], v[120:123]
    ds_read_b64_tr_b16 a[12:13], v29 offset:50784
    buffer_load_dwordx4 a[216:219], v2, s[4:7], s36 offen offset:1024 sc1
    v_mfma_f32_16x16x32_bf16 v[124:127], a[76:79], a[164:167], v[124:127]
    ds_read_b64_tr_b16 a[14:15], v29 offset:51040
    v_mfma_f32_16x16x32_bf16 v[96:99], a[96:99], a[176:179], v[96:99]
    ds_read_b64_tr_b16 a[32:33], v29 offset:51200
    ds_read_b64_tr_b16 a[34:35], v29 offset:51456
    v_mfma_f32_16x16x32_bf16 v[100:103], a[96:99], a[180:183], v[100:103]
    buffer_load_dwordx4 a[220:223], v3, s[4:7], s36 offen offset:1024 sc1
    v_mfma_f32_16x16x32_bf16 v[104:107], a[100:103], a[176:179], v[104:107]
    s_add_u32 s36, s36, 2048
    ds_read_b64_tr_b16 a[36:37], v29 offset:51232
    v_mfma_f32_16x16x32_bf16 v[108:111], a[100:103], a[180:183], v[108:111]
    ds_read_b64_tr_b16 a[38:39], v29 offset:51488
    v_mfma_f32_16x16x32_bf16 v[112:115], a[104:107], a[176:179], v[112:115]
    ds_read_b64_tr_b16 a[40:41], v29 offset:51264
    ds_read_b64_tr_b16 a[42:43], v29 offset:51520
    v_mfma_f32_16x16x32_bf16 v[116:119], a[104:107], a[180:183], v[116:119]
    ds_read_b64_tr_b16 a[44:45], v29 offset:51296
    v_mfma_f32_16x16x32_bf16 v[120:123], a[108:111], a[176:179], v[120:123]
    ds_read_b64_tr_b16 a[46:47], v29 offset:51552
    v_mfma_f32_16x16x32_bf16 v[124:127], a[108:111], a[180:183], v[124:127]
    s_waitcnt vmcnt(17) lgkmcnt(0)
    v_mfma_f32_16x16x32_bf16 v[96:99], a[0:3], a[192:195], v[96:99]
    buffer_load_dwordx4 a[232:235], v2, s[4:7], s36 offen offset:0 sc1
    ds_read_b64_tr_b16 a[64:65], v30 offset:0
    v_mfma_f32_16x16x32_bf16 v[100:103], a[0:3], a[196:199], v[100:103]
    ds_read_b64_tr_b16 a[66:67], v30 offset:256
    v_mfma_f32_16x16x32_bf16 v[104:107], a[4:7], a[192:195], v[104:107]
    ds_read_b64_tr_b16 a[68:69], v30 offset:32
    buffer_load_dwordx4 a[236:239], v3, s[4:7], s36 offen offset:0 sc1
    v_mfma_f32_16x16x32_bf16 v[108:111], a[4:7], a[196:199], v[108:111]
    ds_read_b64_tr_b16 a[70:71], v30 offset:288
    v_mfma_f32_16x16x32_bf16 v[112:115], a[8:11], a[192:195], v[112:115]
    ds_read_b64_tr_b16 a[72:73], v30 offset:64
    v_mfma_f32_16x16x32_bf16 v[116:119], a[8:11], a[196:199], v[116:119]
    ds_read_b64_tr_b16 a[74:75], v30 offset:320
    ds_read_b64_tr_b16 a[76:77], v30 offset:96
    v_mfma_f32_16x16x32_bf16 v[120:123], a[12:15], a[192:195], v[120:123]
    buffer_load_dwordx4 a[248:251], v2, s[4:7], s36 offen offset:1024 sc1
    v_mfma_f32_16x16x32_bf16 v[124:127], a[12:15], a[196:199], v[124:127]
    ds_read_b64_tr_b16 a[78:79], v30 offset:352
    ds_read_b64_tr_b16 a[96:97], v30 offset:512
    v_mfma_f32_16x16x32_bf16 v[96:99], a[32:35], a[208:211], v[96:99]
    ds_read_b64_tr_b16 a[98:99], v30 offset:768
    v_mfma_f32_16x16x32_bf16 v[100:103], a[32:35], a[212:215], v[100:103]
    buffer_load_dwordx4 a[252:255], v3, s[4:7], s36 offen offset:1024 sc1
    v_mfma_f32_16x16x32_bf16 v[104:107], a[36:39], a[208:211], v[104:107]
    s_add_u32 s36, s36, 2048
    ds_read_b64_tr_b16 a[100:101], v30 offset:544
    v_mfma_f32_16x16x32_bf16 v[108:111], a[36:39], a[212:215], v[108:111]
    ds_read_b64_tr_b16 a[102:103], v30 offset:800
    v_mfma_f32_16x16x32_bf16 v[112:115], a[40:43], a[208:211], v[112:115]
    ds_read_b64_tr_b16 a[104:105], v30 offset:576
    ds_read_b64_tr_b16 a[106:107], v30 offset:832
    v_mfma_f32_16x16x32_bf16 v[116:119], a[40:43], a[212:215], v[116:119]
    ds_read_b64_tr_b16 a[108:109], v30 offset:608
    v_mfma_f32_16x16x32_bf16 v[120:123], a[44:47], a[208:211], v[120:123]
    ds_read_b64_tr_b16 a[110:111], v30 offset:864
    v_mfma_f32_16x16x32_bf16 v[124:127], a[44:47], a[212:215], v[124:127]
    s_waitcnt vmcnt(8) lgkmcnt(0)
    v_mfma_f32_16x16x32_bf16 v[96:99], a[64:67], a[224:227], v[96:99]
    v_readfirstlane_b32 s45, v13
    s_nop 1
    s_cmp_ge_u32 s45, 4
    s_cbranch_scc0 P2_y_slow
P2_y_ok:
    buffer_load_dwordx4 v[32:35], v6, s[12:15], s38 offen offset:0 sc1
    v_mfma_f32_16x16x32_bf16 v[100:103], a[64:67], a[228:231], v[100:103]
    ds_read_b64_tr_b16 a[0:1], v30 offset:8448
    buffer_load_dwordx4 v[36:39], v6, s[12:15], s38 offen offset:1024 sc1
    v_mfma_f32_16x16x32_bf16 v[104:107], a[68:71], a[224:227], v[104:107]
    ds_read_b64_tr_b16 a[2:3], v30 offset:8704
    buffer_load_dwordx4 v[40:43], v6, s[12:15], s38 offen offset:2048 sc1
    v_mfma_f32_16x16x32_bf16 v[108:111], a[68:71], a[228:231], v[108:111]
    ds_read_b64_tr_b16 a[4:5], v30 offset:8480
    buffer_load_dwordx4 v[44:47], v6, s[12:15], s38 offen offset:3072 sc1
    v_mfma_f32_16x16x32_bf16 v[112:115], a[72:75], a[224:227], v[112:115]
    ds_read_b64_tr_b16 a[6:7], v30 offset:8736
    s_add_u32 s38, s38, 16384
    buffer_load_dwordx4 v[48:51], v6, s[12:15], s38 offen offset:0 sc1
    v_mfma_f32_16x16x32_bf16 v[116:119], a[72:75], a[228:231], v[116:119]
    ds_read_b64_tr_b16 a[8:9], v30 offset:8512
    buffer_load_dwordx4 v[52:55], v6, s[12:15], s38 offen offset:1024 sc1
    v_mfma_f32_16x16x32_bf16 v[120:123], a[76:79], a[224:227], v[120:123]
    ds_read_b64_tr_b16 a[10:11], v30 offset:8768
    ds_read_b64_tr_b16 a[12:13], v30 offset:8544
    v_mfma_f32_16x16x32_bf16 v[124:127], a[76:79], a[228:231], v[124:127]
    buffer_load_dwordx4 v[56:59], v6, s[12:15], s38 offen offset:2048 sc1
    ds_read_b64_tr_b16 a[14:15], v30 offset:8800
    v_mfma_f32_16x16x32_bf16 v[96:99], a[96:99], a[240:243], v[96:99]
    buffer_load_dwordx4 v[60:63], v6, s[12:15], s38 offen offset:3072 sc1
    ds_read_b64_tr_b16 a[32:33], v30 offset:8960
    v_mfma_f32_16x16x32_bf16 v[100:103], a[96:99], a[244:247], v[100:103]
    s_add_u32 s38, s38, 16384
    buffer_load_dwordx4 v[64:67], v6, s[12:15], s38 offen offset:0 sc1
    ds_read_b64_tr_b16 a[34:35], v30 offset:9216
    v_mfma_f32_16x16x32_bf16 v[104:107], a[100:103], a[240:243], v[104:107]
    buffer_load_dwordx4 v[68:71], v6, s[12:15], s38 offen offset:1024 sc1
    ds_read_b64_tr_b16 a[36:37], v30 offset:8992
    v_mfma_f32_16x16x32_bf16 v[108:111], a[100:103], a[244:247], v[108:111]
    buffer_load_dwordx4 v[72:75], v6, s[12:15], s38 offen offset:2048 sc1
    ds_read_b64_tr_b16 a[38:39], v30 offset:9248
    v_mfma_f32_16x16x32_bf16 v[112:115], a[104:107], a[240:243], v[112:115]
    buffer_load_dwordx4 v[76:79], v6, s[12:15], s38 offen offset:3072 sc1
    ds_read_b64_tr_b16 a[40:41], v30 offset:9024
    v_mfma_f32_16x16x32_bf16 v[116:119], a[104:107], a[244:247], v[116:119]
    ds_read_b64_tr_b16 a[42:43], v30 offset:9280
    ds_read_b64_tr_b16 a[44:45], v30 offset:9056
    v_mfma_f32_16x16x32_bf16 v[120:123], a[108:111], a[240:243], v[120:123]
    ds_read_b64_tr_b16 a[46:47], v30 offset:9312
    v_mfma_f32_16x16x32_bf16 v[124:127], a[108:111], a[244:247], v[124:127]
    s_waitcnt vmcnt(25) lgkmcnt(0)
    v_mfma_f32_16x16x32_bf16 v[96:99], a[0:3], a[136:139], v[96:99]
    ds_read_b64_tr_b16 a[64:65], v30 offset:16896
    ds_read_b64_tr_b16 a[66:67], v30 offset:17152
    v_mfma_f32_16x16x32_bf16 v[100:103], a[0:3], a[140:143], v[100:103]
    ds_read_b64_tr_b16 a[68:69], v30 offset:16928
    v_mfma_f32_16x16x32_bf16 v[104:107], a[4:7], a[136:139], v[104:107]
    ds_read_b64_tr_b16 a[70:71], v30 offset:17184
    v_mfma_f32_16x16x32_bf16 v[108:111], a[4:7], a[140:143], v[108:111]
    ds_read_b64_tr_b16 a[72:73], v30 offset:16960
    v_mfma_f32_16x16x32_bf16 v[112:115], a[8:11], a[136:139], v[112:115]
    ds_read_b64_tr_b16 a[74:75], v30 offset:17216
    v_mfma_f32_16x16x32_bf16 v[116:119], a[8:11], a[140:143], v[116:119]
    ds_read_b64_tr_b16 a[76:77], v30 offset:16992
    v_mfma_f32_16x16x32_bf16 v[120:123], a[12:15], a[136:139], v[120:123]
    ds_read_b64_tr_b16 a[78:79], v30 offset:17248
    v_mfma_f32_16x16x32_bf16 v[124:127], a[12:15], a[140:143], v[124:127]
    ds_read_b64_tr_b16 a[96:97], v30 offset:17408
    v_mfma_f32_16x16x32_bf16 v[96:99], a[32:35], a[152:155], v[96:99]
    ds_read_b64_tr_b16 a[98:99], v30 offset:17664
    v_mfma_f32_16x16x32_bf16 v[100:103], a[32:35], a[156:159], v[100:103]
    ds_read_b64_tr_b16 a[100:101], v30 offset:17440
    v_mfma_f32_16x16x32_bf16 v[104:107], a[36:39], a[152:155], v[104:107]
    ds_read_b64_tr_b16 a[102:103], v30 offset:17696
    v_mfma_f32_16x16x32_bf16 v[108:111], a[36:39], a[156:159], v[108:111]
    ds_read_b64_tr_b16 a[104:105], v30 offset:17472
    v_mfma_f32_16x16x32_bf16 v[112:115], a[40:43], a[152:155], v[112:115]
    ds_read_b64_tr_b16 a[106:107], v30 offset:17728
    v_mfma_f32_16x16x32_bf16 v[116:119], a[40:43], a[156:159], v[116:119]
    ds_read_b64_tr_b16 a[108:109], v30 offset:17504
    v_mfma_f32_16x16x32_bf16 v[120:123], a[44:47], a[152:155], v[120:123]
    ds_read_b64_tr_b16 a[110:111], v30 offset:17760
    v_mfma_f32_16x16x32_bf16 v[124:127], a[44:47], a[156:159], v[124:127]
    s_waitcnt vmcnt(21) lgkmcnt(0)
    v_mfma_f32_16x16x32_bf16 v[96:99], a[64:67], a[168:171], v[96:99]
    ds_read_b64_tr_b16 a[0:1], v30 offset:25344
    ds_read_b64_tr_b16 a[2:3], v30 offset:25600
    v_mfma_f32_16x16x32_bf16 v[100:103], a[64:67], a[172:175], v[100:103]
    ds_read_b64_tr_b16 a[4:5], v30 offset:25376
    v_mfma_f32_16x16x32_bf16 v[104:107], a[68:71], a[168:171], v[104:107]
    ds_read_b64_tr_b16 a[6:7], v30 offset:25632
    v_mfma_f32_16x16x32_bf16 v[108:111], a[68:71], a[172:175], v[108:111]
    ds_read_b64_tr_b16 a[8:9], v30 offset:25408
    v_mfma_f32_16x16x32_bf16 v[112:115], a[72:75], a[168:171], v[112:115]
    ds_read_b64_tr_b16 a[10:11], v30 offset:25664
    v_mfma_f32_16x16x32_bf16 v[116:119], a[72:75], a[172:175], v[116:119]
    ds_read_b64_tr_b16 a[12:13], v30 offset:25440
    v_mfma_f32_16x16x32_bf16 v[120:123], a[76:79], a[168:171], v[120:123]
    ds_read_b64_tr_b16 a[14:15], v30 offset:25696
    v_mfma_f32_16x16x32_bf16 v[124:127], a[76:79], a[172:175], v[124:127]
    ds_read_b64_tr_b16 a[32:33], v30 offset:25856
    v_mfma_f32_16x16x32_bf16 v[96:99], a[96:99], a[184:187], v[96:99]
    ds_read_b64_tr_b16 a[34:35], v30 offset:26112
    v_mfma_f32_16x16x32_bf16 v[100:103], a[96:99], a[188:191], v[100:103]
    ds_read_b64_tr_b16 a[36:37], v30 offset:25888
    v_mfma_f32_16x16x32_bf16 v[104:107], a[100:103], a[184:187], v[104:107]
    ds_read_b64_tr_b16 a[38:39], v30 offset:26144
    v_mfma_f32_16x16x32_bf16 v[108:111], a[100:103], a[188:191], v[108:111]
    ds_read_b64_tr_b16 a[40:41], v30 offset:25920
    v_mfma_f32_16x16x32_bf16 v[112:115], a[104:107], a[184:187], v[112:115]
    ds_read_b64_tr_b16 a[42:43], v30 offset:26176
    v_mfma_f32_16x16x32_bf16 v[116:119], a[104:107], a[188:191], v[116:119]
    ds_read_b64_tr_b16 a[44:45], v30 offset:25952
    v_mfma_f32_16x16x32_bf16 v[120:123], a[108:111], a[184:187], v[120:123]
    ds_read_b64_tr_b16 a[46:47], v30 offset:26208
    v_mfma_f32_16x16x32_bf16 v[124:127], a[108:111], a[188:191], v[124:127]
    s_waitcnt vmcnt(16) lgkmcnt(0)
    s_barrier
    v_mfma_f32_16x16x32_bf16 v[96:99], a[0:3], a[200:203], v[96:99]
    ds_read_b64_tr_b16 a[64:65], v20 offset:0
    ds_read_b64_tr_b16 a[66:67], v20 offset:256
    v_mfma_f32_16x16x32_bf16 v[100:103], a[0:3], a[204:207], v[100:103]
    ds_read_b64_tr_b16 a[68:69], v20 offset:32
    v_mfma_f32_16x16x32_bf16 v[104:107], a[4:7], a[200:203], v[104:107]
    ds_read_b64_tr_b16 a[70:71], v20 offset:288
    v_mfma_f32_16x16x32_bf16 v[108:111], a[4:7], a[204:207], v[108:111]
    ds_read_b64_tr_b16 a[72:73], v20 offset:64
    v_mfma_f32_16x16x32_bf16 v[112:115], a[8:11], a[200:203], v[112:115]
    ds_read_b64_tr_b16 a[74:75], v20 offset:320
    v_mfma_f32_16x16x32_bf16 v[116:119], a[8:11], a[204:207], v[116:119]
    ds_read_b64_tr_b16 a[76:77], v20 offset:96
    v_mfma_f32_16x16x32_bf16 v[120:123], a[12:15], a[200:203], v[120:123]
    ds_read_b64_tr_b16 a[78:79], v20 offset:352
    v_mfma_f32_16x16x32_bf16 v[124:127], a[12:15], a[204:207], v[124:127]
    ds_read_b64_tr_b16 a[96:97], v20 offset:512
    v_mfma_f32_16x16x32_bf16 v[96:99], a[32:35], a[216:219], v[96:99]
    ds_read_b64_tr_b16 a[98:99], v20 offset:768
    v_mfma_f32_16x16x32_bf16 v[100:103], a[32:35], a[220:223], v[100:103]
    ds_read_b64_tr_b16 a[100:101], v20 offset:544
    v_mfma_f32_16x16x32_bf16 v[104:107], a[36:39], a[216:219], v[104:107]
    ds_read_b64_tr_b16 a[102:103], v20 offset:800
    v_mfma_f32_16x16x32_bf16 v[108:111], a[36:39], a[220:223], v[108:111]
    ds_read_b64_tr_b16 a[104:105], v20 offset:576
    v_mfma_f32_16x16x32_bf16 v[112:115], a[40:43], a[216:219], v[112:115]
    ds_read_b64_tr_b16 a[106:107], v20 offset:832
    v_mfma_f32_16x16x32_bf16 v[116:119], a[40:43], a[220:223], v[116:119]
    ds_read_b64_tr_b16 a[108:109], v20 offset:608
    v_mfma_f32_16x16x32_bf16 v[120:123], a[44:47], a[216:219], v[120:123]
    ds_read_b64_tr_b16 a[110:111], v20 offset:864
    v_mfma_f32_16x16x32_bf16 v[124:127], a[44:47], a[220:223], v[124:127]
    s_waitcnt vmcnt(12) lgkmcnt(0)
    v_mfma_f32_16x16x32_bf16 v[96:99], a[64:67], a[232:235], v[96:99]
    v_mfma_f32_16x16x32_bf16 v[100:103], a[64:67], a[236:239], v[100:103]
    v_mfma_f32_16x16x32_bf16 v[104:107], a[68:71], a[232:235], v[104:107]
    v_mfma_f32_16x16x32_bf16 v[108:111], a[68:71], a[236:239], v[108:111]
    v_mfma_f32_16x16x32_bf16 v[112:115], a[72:75], a[232:235], v[112:115]
    v_mfma_f32_16x16x32_bf16 v[116:119], a[72:75], a[236:239], v[116:119]
    v_mfma_f32_16x16x32_bf16 v[120:123], a[76:79], a[232:235], v[120:123]
    v_mfma_f32_16x16x32_bf16 v[124:127], a[76:79], a[236:239], v[124:127]
    v_mfma_f32_16x16x32_bf16 v[96:99], a[96:99], a[248:251], v[96:99]
    v_mfma_f32_16x16x32_bf16 v[100:103], a[96:99], a[252:255], v[100:103]
    v_mfma_f32_16x16x32_bf16 v[104:107], a[100:103], a[248:251], v[104:107]
    v_mfma_f32_16x16x32_bf16 v[108:111], a[100:103], a[252:255], v[108:111]
    v_mfma_f32_16x16x32_bf16 v[112:115], a[104:107], a[248:251], v[112:115]
    v_mfma_f32_16x16x32_bf16 v[116:119], a[104:107], a[252:255], v[116:119]
    v_mfma_f32_16x16x32_bf16 v[120:123], a[108:111], a[248:251], v[120:123]
    v_mfma_f32_16x16x32_bf16 v[124:127], a[108:111], a[252:255], v[124:127]
    s_mov_b32 s44, 1069066811
    s_waitcnt vmcnt(0)
    v_mfma_f32_16x16x32_bf16 v[128:131], v[226:229], v[32:35], v[128:131]
    v_mfma_f32_16x16x32_bf16 v[144:147], v[224:227], v[32:35], v[144:147]
    v_mfma_f32_16x16x32_bf16 v[132:135], v[226:229], v[40:43], v[132:135]
    v_mfma_f32_16x16x32_bf16 v[148:151], v[224:227], v[40:43], v[148:151]
    v_mfma_f32_16x16x32_bf16 v[128:131], v[226:229], v[48:51], v[128:131]
    v_mfma_f32_16x16x32_bf16 v[144:147], v[224:227], v[48:51], v[144:147]
    v_mfma_f32_16x16x32_bf16 v[132:135], v[226:229], v[56:59], v[132:135]
    v_mfma_f32_16x16x32_bf16 v[148:151], v[224:227], v[56:59], v[148:151]
    v_mfma_f32_16x16x32_bf16 v[128:131], v[226:229], v[64:67], v[128:131]
    v_mfma_f32_16x16x32_bf16 v[144:147], v[224:227], v[64:67], v[144:147]
    v_mfma_f32_16x16x32_bf16 v[132:135], v[226:229], v[72:75], v[132:135]
    v_mfma_f32_16x16x32_bf16 v[148:151], v[224:227], v[72:75], v[148:151]
    v_mfma_f32_16x16x32_bf16 v[160:163], v[226:229], v[36:39], v[160:163]
    v_mfma_f32_16x16x32_bf16 v[176:179], v[224:227], v[36:39], v[176:179]
    v_mfma_f32_16x16x32_bf16 v[164:167], v[226:229], v[44:47], v[164:167]
    v_mfma_f32_16x16x32_bf16 v[180:183], v[224:227], v[44:47], v[180:183]
    v_mfma_f32_16x16x32_bf16 v[160:163], v[226:229], v[52:55], v[160:163]
    v_mfma_f32_16x16x32_bf16 v[176:179], v[224:227], v[52:55], v[176:179]
    v_mfma_f32_16x16x32_bf16 v[164:167], v[226:229], v[60:63], v[164:167]
    v_mfma_f32_16x16x32_bf16 v[180:183], v[224:227], v[60:63], v[180:183]
    v_mfma_f32_16x16x32_bf16 v[160:163], v[226:229], v[68:71], v[160:163]
    v_mfma_f32_16x16x32_bf16 v[176:179], v[224:227], v[68:71], v[176:179]
    v_mfma_f32_16x16x32_bf16 v[164:167], v[226:229], v[76:79], v[164:167]
    v_mfma_f32_16x16x32_bf16 v[180:183], v[224:227], v[76:79], v[180:183]
    v_exp_f32_e64 v232, -v128
    v_exp_f32_e64 v233, -v129
    v_exp_f32_e64 v234, -v130
    v_exp_f32_e64 v235, -v131
    v_exp_f32_e64 v236, -v144
    v_exp_f32_e64 v237, -v145
    v_exp_f32_e64 v238, -v146
    v_exp_f32_e64 v239, -v147
    v_lshlrev_b32 v240, 16, v80
    v_and_b32 v241, 0xffff0000, v80
    v_lshlrev_b32 v242, 16, v81
    v_and_b32 v243, 0xffff0000, v81
    v_lshlrev_b32 v244, 16, v82
    v_and_b32 v245, 0xffff0000, v82
    v_lshlrev_b32 v246, 16, v83
    v_and_b32 v247, 0xffff0000, v83
    v_pk_fma_f32 v[232:233], v[232:233], s[44:45], s[44:45] op_sel:[0,0,0] op_sel_hi:[1,0,0]
    v_pk_fma_f32 v[234:235], v[234:235], s[44:45], s[44:45] op_sel:[0,0,0] op_sel_hi:[1,0,0]
    v_pk_fma_f32 v[236:237], v[236:237], s[44:45], s[44:45] op_sel:[0,0,0] op_sel_hi:[1,0,0]
    v_pk_fma_f32 v[238:239], v[238:239], s[44:45], s[44:45] op_sel:[0,0,0] op_sel_hi:[1,0,0]
    v_rcp_f32 v232, v232
    v_rcp_f32 v233, v233
    v_rcp_f32 v234, v234
    v_rcp_f32 v235, v235
    v_rcp_f32 v236, v236
    v_rcp_f32 v237, v237
    v_rcp_f32 v238, v238
    v_rcp_f32 v239, v239
    v_pk_mul_f32 v[128:129], v[128:129], v[96:97] op_sel:[0,0] op_sel_hi:[1,1]
    v_pk_mul_f32 v[130:131], v[130:131], v[98:99] op_sel:[0,0] op_sel_hi:[1,1]
    v_pk_mul_f32 v[144:145], v[144:145], v[104:105] op_sel:[0,0] op_sel_hi:[1,1]
    v_pk_mul_f32 v[146:147], v[146:147], v[106:107] op_sel:[0,0] op_sel_hi:[1,1]
    v_pk_fma_f32 v[240:241], v[128:129], v[232:233], v[240:241] op_sel:[0,0,0] op_sel_hi:[1,1,1]
    v_pk_fma_f32 v[242:243], v[130:131], v[234:235], v[242:243] op_sel:[0,0,0] op_sel_hi:[1,1,1]
    v_pk_fma_f32 v[244:245], v[144:145], v[236:237], v[244:245] op_sel:[0,0,0] op_sel_hi:[1,1,1]
    v_pk_fma_f32 v[246:247], v[146:147], v[238:239], v[246:247] op_sel:[0,0,0] op_sel_hi:[1,1,1]
    v_cvt_pk_bf16_f32 v128, v240, v241
    v_cvt_pk_bf16_f32 v129, v242, v243
    v_cvt_pk_bf16_f32 v130, v244, v245
    v_cvt_pk_bf16_f32 v131, v246, v247
    s_nop 0
    v_permlane16_swap_b32 v128, v130
    v_permlane16_swap_b32 v129, v131
    buffer_store_dwordx4 v[128:131], v8, s[96:99], s32 offen offset:0 sc1
    v_exp_f32_e64 v232, -v132
    v_exp_f32_e64 v233, -v133
    v_exp_f32_e64 v234, -v134
    v_exp_f32_e64 v235, -v135
    v_exp_f32_e64 v236, -v148
    v_exp_f32_e64 v237, -v149
    v_exp_f32_e64 v238, -v150
    v_exp_f32_e64 v239, -v151
    v_lshlrev_b32 v240, 16, v88
    v_and_b32 v241, 0xffff0000, v88
    v_lshlrev_b32 v242, 16, v89
    v_and_b32 v243, 0xffff0000, v89
    v_lshlrev_b32 v244, 16, v90
    v_and_b32 v245, 0xffff0000, v90
    v_lshlrev_b32 v246, 16, v91
    v_and_b32 v247, 0xffff0000, v91
    v_pk_fma_f32 v[232:233], v[232:233], s[44:45], s[44:45] op_sel:[0,0,0] op_sel_hi:[1,0,0]
    v_pk_fma_f32 v[234:235], v[234:235], s[44:45], s[44:45] op_sel:[0,0,0] op_sel_hi:[1,0,0]
    v_pk_fma_f32 v[236:237], v[236:237], s[44:45], s[44:45] op_sel:[0,0,0] op_sel_hi:[1,0,0]
    v_pk_fma_f32 v[238:239], v[238:239], s[44:45], s[44:45] op_sel:[0,0,0] op_sel_hi:[1,0,0]
    v_rcp_f32 v232, v232
    v_rcp_f32 v233, v233
    v_rcp_f32 v234, v234
    v_rcp_f32 v235, v235
    v_rcp_f32 v236, v236
    v_rcp_f32 v237, v237
    v_rcp_f32 v238, v238
    v_rcp_f32 v239, v239
    v_pk_mul_f32 v[132:133], v[132:133], v[100:101] op_sel:[0,0] op_sel_hi:[1,1]
    v_pk_mul_f32 v[134:135], v[134:135], v[102:103] op_sel:[0,0] op_sel_hi:[1,1]
    v_pk_mul_f32 v[148:149], v[148:149], v[108:109] op_sel:[0,0] op_sel_hi:[1,1]
    v_pk_mul_f32 v[150:151], v[150:151], v[110:111] op_sel:[0,0] op_sel_hi:[1,1]
    v_pk_fma_f32 v[240:241], v[132:133], v[232:233], v[240:241] op_sel:[0,0,0] op_sel_hi:[1,1,1]
    v_pk_fma_f32 v[242:243], v[134:135], v[234:235], v[242:243] op_sel:[0,0,0] op_sel_hi:[1,1,1]
    v_pk_fma_f32 v[244:245], v[148:149], v[236:237], v[244:245] op_sel:[0,0,0] op_sel_hi:[1,1,1]
    v_pk_fma_f32 v[246:247], v[150:151], v[238:239], v[246:247] op_sel:[0,0,0] op_sel_hi:[1,1,1]
    v_cvt_pk_bf16_f32 v132, v240, v241
    v_cvt_pk_bf16_f32 v133, v242, v243
    v_cvt_pk_bf16_f32 v134, v244, v245
    v_cvt_pk_bf16_f32 v135, v246, v247
    s_nop 0
    v_permlane16_swap_b32 v132, v134
    v_permlane16_swap_b32 v133, v135
    buffer_store_dwordx4 v[132:135], v8, s[96:99], s33 offen offset:0 sc1
    v_exp_f32_e64 v232, -v160
    v_exp_f32_e64 v233, -v161
    v_exp_f32_e64 v234, -v162
    v_exp_f32_e64 v235, -v163
    v_exp_f32_e64 v236, -v176
    v_exp_f32_e64 v237, -v177
    v_exp_f32_e64 v238, -v178
    v_exp_f32_e64 v239, -v179
    v_lshlrev_b32 v240, 16, v84
    v_and_b32 v241, 0xffff0000, v84
    v_lshlrev_b32 v242, 16, v85
    v_and_b32 v243, 0xffff0000, v85
    v_lshlrev_b32 v244, 16, v86
    v_and_b32 v245, 0xffff0000, v86
    v_lshlrev_b32 v246, 16, v87
    v_and_b32 v247, 0xffff0000, v87
    v_pk_fma_f32 v[232:233], v[232:233], s[44:45], s[44:45] op_sel:[0,0,0] op_sel_hi:[1,0,0]
    v_pk_fma_f32 v[234:235], v[234:235], s[44:45], s[44:45] op_sel:[0,0,0] op_sel_hi:[1,0,0]
    v_pk_fma_f32 v[236:237], v[236:237], s[44:45], s[44:45] op_sel:[0,0,0] op_sel_hi:[1,0,0]
    v_pk_fma_f32 v[238:239], v[238:239], s[44:45], s[44:45] op_sel:[0,0,0] op_sel_hi:[1,0,0]
    v_rcp_f32 v232, v232
    v_rcp_f32 v233, v233
    v_rcp_f32 v234, v234
    v_rcp_f32 v235, v235
    v_rcp_f32 v236, v236
    v_rcp_f32 v237, v237
    v_rcp_f32 v238, v238
    v_rcp_f32 v239, v239
    v_pk_mul_f32 v[160:161], v[160:161], v[112:113] op_sel:[0,0] op_sel_hi:[1,1]
    v_pk_mul_f32 v[162:163], v[162:163], v[114:115] op_sel:[0,0] op_sel_hi:[1,1]
    v_pk_mul_f32 v[176:177], v[176:177], v[120:121] op_sel:[0,0] op_sel_hi:[1,1]
    v_pk_mul_f32 v[178:179], v[178:179], v[122:123] op_sel:[0,0] op_sel_hi:[1,1]
    v_pk_fma_f32 v[240:241], v[160:161], v[232:233], v[240:241] op_sel:[0,0,0] op_sel_hi:[1,1,1]
    v_pk_fma_f32 v[242:243], v[162:163], v[234:235], v[242:243] op_sel:[0,0,0] op_sel_hi:[1,1,1]
    v_pk_fma_f32 v[244:245], v[176:177], v[236:237], v[244:245] op_sel:[0,0,0] op_sel_hi:[1,1,1]
    v_pk_fma_f32 v[246:247], v[178:179], v[238:239], v[246:247] op_sel:[0,0,0] op_sel_hi:[1,1,1]
    v_cvt_pk_bf16_f32 v160, v240, v241
    v_cvt_pk_bf16_f32 v161, v242, v243
    v_cvt_pk_bf16_f32 v162, v244, v245
    v_cvt_pk_bf16_f32 v163, v246, v247
    s_nop 0
    v_permlane16_swap_b32 v160, v162
    v_permlane16_swap_b32 v161, v163
    buffer_store_dwordx4 v[160:163], v8, s[96:99], s32 offen offset:64 sc1
    v_exp_f32_e64 v232, -v164
    v_exp_f32_e64 v233, -v165
    v_exp_f32_e64 v234, -v166
    v_exp_f32_e64 v235, -v167
    v_exp_f32_e64 v236, -v180
    v_exp_f32_e64 v237, -v181
    v_exp_f32_e64 v238, -v182
    v_exp_f32_e64 v239, -v183
    v_lshlrev_b32 v240, 16, v92
    v_and_b32 v241, 0xffff0000, v92
    v_lshlrev_b32 v242, 16, v93
    v_and_b32 v243, 0xffff0000, v93
    v_lshlrev_b32 v244, 16, v94
    v_and_b32 v245, 0xffff0000, v94
    v_lshlrev_b32 v246, 16, v95
    v_and_b32 v247, 0xffff0000, v95
    v_pk_fma_f32 v[232:233], v[232:233], s[44:45], s[44:45] op_sel:[0,0,0] op_sel_hi:[1,0,0]
    v_pk_fma_f32 v[234:235], v[234:235], s[44:45], s[44:45] op_sel:[0,0,0] op_sel_hi:[1,0,0]
    v_pk_fma_f32 v[236:237], v[236:237], s[44:45], s[44:45] op_sel:[0,0,0] op_sel_hi:[1,0,0]
    v_pk_fma_f32 v[238:239], v[238:239], s[44:45], s[44:45] op_sel:[0,0,0] op_sel_hi:[1,0,0]
    v_rcp_f32 v232, v232
    v_rcp_f32 v233, v233
    v_rcp_f32 v234, v234
    v_rcp_f32 v235, v235
    v_rcp_f32 v236, v236
    v_rcp_f32 v237, v237
    v_rcp_f32 v238, v238
    v_rcp_f32 v239, v239
    v_pk_mul_f32 v[164:165], v[164:165], v[116:117] op_sel:[0,0] op_sel_hi:[1,1]
    v_pk_mul_f32 v[166:167], v[166:167], v[118:119] op_sel:[0,0] op_sel_hi:[1,1]
    v_pk_mul_f32 v[180:181], v[180:181], v[124:125] op_sel:[0,0] op_sel_hi:[1,1]
    v_pk_mul_f32 v[182:183], v[182:183], v[126:127] op_sel:[0,0] op_sel_hi:[1,1]
    v_pk_fma_f32 v[240:241], v[164:165], v[232:233], v[240:241] op_sel:[0,0,0] op_sel_hi:[1,1,1]
    v_pk_fma_f32 v[242:243], v[166:167], v[234:235], v[242:243] op_sel:[0,0,0] op_sel_hi:[1,1,1]
    v_pk_fma_f32 v[244:245], v[180:181], v[236:237], v[244:245] op_sel:[0,0,0] op_sel_hi:[1,1,1]
    v_pk_fma_f32 v[246:247], v[182:183], v[238:239], v[246:247] op_sel:[0,0,0] op_sel_hi:[1,1,1]
    v_cvt_pk_bf16_f32 v164, v240, v241
    v_cvt_pk_bf16_f32 v165, v242, v243
    v_cvt_pk_bf16_f32 v166, v244, v245
    v_cvt_pk_bf16_f32 v167, v246, v247
    s_nop 0
    v_permlane16_swap_b32 v164, v166
    v_permlane16_swap_b32 v165, v167
    buffer_store_dwordx4 v[164:167], v8, s[96:99], s33 offen offset:64 sc1
    s_endpgm
P2_Yhook0:
    s_lshl_b32 s40, s23, 5
    s_add_u32 s44, s40, s29
    s_cmp_eq_u32 s44, 12
    s_cbranch_scc0 P2_Yh0_12
    s_mul_i32 s40, s3, 16384
    s_add_u32 s40, s40, s26
    s_sub_u32 s34, 63488, s36
    s_add_u32 s34, s34, s40
    s_add_u32 s35, s27, 131072
    s_mov_b32 s30, 65536
    s_mov_b32 s31, 458752
    s_branch P2_Yb0
P2_Yh0_12:
    s_cmp_eq_u32 s44, 40
    s_cbranch_scc0 P2_Yh1_8
    s_waitcnt vmcnt(14)
    v_readfirstlane_b32 s45, v13
    s_nop 1
    s_cmp_ge_u32 s45, 16
    s_cbranch_scc0 P2_c1_8_slow
P2_c1_8_ok:
    s_add_u32 s40, s25, 10240
    v_mov_b32 v12, s40
    s_mul_i32 s40, s3, 8192
    s_add_u32 s40, s40, s26
    s_sub_u32 s34, 96256, s36
    s_add_u32 s34, s34, s40
    s_add_u32 s35, s27, 393216
    s_mov_b32 s30, 458752
    s_mov_b32 s31, 917504
    s_branch P2_Yb0
P2_Yh1_8:
    s_waitcnt vmcnt(14)
    v_readfirstlane_b32 s45, v13
    s_nop 1
    s_cmp_ge_u32 s45, 16
    s_cbranch_scc0 P2_c0_4_slow
P2_c0_4_ok:
    v_mov_b32 v12, s41
    s_mov_b32 s8, s54
    s_and_b32 s9, s55, 0xffff
    s_mov_b32 s10, 2097152
    s_mov_b32 s11, 0x20000
    s_sub_u32 s34, 112640, s36
    s_add_u32 s34, s34, s26
    s_mov_b32 s35, 0
    s_mov_b32 s30, 65536
    s_mov_b32 s31, 131072
    s_mov_b32 s20, 8192
    s_lshl_b32 s40, s18, 5
    v_and_b32 v14, 31, v1
    v_add_lshl_u32 v14, v14, s40, 7
    v_add_u32 v14, P2_tail-K_pc, v14
    buffer_load_dword v15, v14, s[88:91], 0 offen
    s_branch P2_Yb0
P2_Yhook1:
    s_lshl_b32 s40, s23, 5
    s_add_u32 s44, s40, s29
    s_cmp_eq_u32 s44, 47
    s_cbranch_scc0 P2_Yh1_15
    s_add_u32 s40, s24, 8192
    s_cmp_lg_u32 s18, 0
    s_cbranch_scc1 P2_s1
    v_mov_b32 v16, s40
    v_mov_b32 v17, 1
    s_mov_b64 exec, 1
    global_atomic_add v16, v17, s[16:17] sc1
    s_mov_b64 exec, -1
P2_s1:
    s_branch P2_Yb1
P2_Yh1_15:
    s_cmp_eq_u32 s44, 11
    s_cbranch_scc0 P2_Yh0_11
    s_waitcnt vmcnt(14)
    v_readfirstlane_b32 s45, v13
    s_nop 1
    s_cmp_ge_u32 s45, 16
    s_cbranch_scc0 P2_c0_11_slow
P2_c0_11_ok:
    s_add_u32 s40, s25, 10240
    v_mov_b32 v12, s40
    s_add_u32 s40, s24, 10240
    s_cmp_lg_u32 s18, 0
    s_cbranch_scc1 P2_s0
    v_mov_b32 v16, s40
    v_mov_b32 v17, 1
    s_mov_b64 exec, 1
    global_atomic_add v16, v17, s[16:17] sc1
    s_mov_b64 exec, -1
P2_s0:
    s_branch P2_Yb1
P2_Yh0_11:
    s_waitcnt vmcnt(14)
    v_readfirstlane_b32 s45, v13
    s_nop 1
    s_cmp_ge_u32 s45, 16
    s_cbranch_scc0 P2_c1_11_slow
P2_c1_11_ok:
    s_add_u32 s40, s25, 8192
    v_mov_b32 v12, s40
    s_mul_i32 s40, s3, 16384
    s_add_u32 s40, s40, s26
    s_sub_u32 s34, 30720, s36
    s_add_u32 s34, s34, s40
    s_add_u32 s35, s27, 65536
    s_mov_b32 s30, 262144
    s_mov_b32 s31, 458752
    s_branch P2_Yb1
P2_Yhook2:
    s_branch P2_Yb2
P2_Yhook3:
    s_branch P2_Yb3
P1_w1_slow:
    s_mov_b32 s44, 0
P1_w1_spin:
    s_sleep 3
    global_load_dword v30, v11, s[16:17] sc1
    s_add_u32 s44, s44, 1
    s_waitcnt vmcnt(0)
    v_readfirstlane_b32 s45, v30
    s_nop 1
    s_cmp_ge_u32 s45, 16
    s_cbranch_scc1 P1_w1_ok
    s_cmp_lt_u32 s44, 0x20000
    s_cbranch_scc1 P1_w1_spin
    s_branch P1_w1_ok
P1_stW_slow:
    s_mov_b32 s44, 0
P1_stW_spin:
    s_sleep 3
    global_load_dword v12, v14, s[64:65] sc1
    s_add_u32 s44, s44, 1
    s_waitcnt vmcnt(0)
    v_readfirstlane_b32 s45, v12
    s_nop 1
    s_cmp_ge_u32 s45, 256
    s_cbranch_scc1 P1_stW_ok
    s_cmp_lt_u32 s44, 0x20000
    s_cbranch_scc1 P1_stW_spin
    s_branch P1_stW_ok
P1_stQ_slow:
    s_mov_b32 s44, 0
P1_stQ_spin:
    s_sleep 3
    global_load_dword v12, v14, s[64:65] sc1
    s_add_u32 s44, s44, 1
    s_waitcnt vmcnt(0)
    v_readfirstlane_b32 s45, v12
    s_nop 1
    s_cmp_ge_u32 s45, 256
    s_cbranch_scc1 P1_stQ_ok
    s_cmp_lt_u32 s44, 0x20000
    s_cbranch_scc1 P1_stQ_spin
    s_branch P1_stQ_ok
P1_kv_slow:
    s_mov_b32 s44, 0
P1_kv_spin:
    s_sleep 3
    global_load_dword v30, v0, s[16:17] sc1
    s_add_u32 s44, s44, 1
    s_waitcnt vmcnt(0)
    v_readfirstlane_b32 s45, v30
    s_nop 1
    s_cmp_ge_u32 s45, 8
    s_cbranch_scc1 P1_kv_ok
    s_cmp_lt_u32 s44, 0x20000
    s_cbranch_scc1 P1_kv_spin
    s_branch P1_kv_ok
P1_q2_slow:
    s_mov_b32 s44, 0
P1_q2_spin:
    s_sleep 3
    global_load_dword v12, v11, s[16:17] sc1
    s_add_u32 s44, s44, 1
    s_waitcnt vmcnt(0)
    v_readfirstlane_b32 s45, v12
    s_nop 1
    s_cmp_ge_u32 s45, 16
    s_cbranch_scc1 P1_q2_ok
    s_cmp_lt_u32 s44, 0x20000
    s_cbranch_scc1 P1_q2_spin
    s_branch P1_q2_ok
P2_y_slow:
    s_mov_b32 s44, 0
P2_y_spin:
    s_sleep 3
    global_load_dword v13, v12, s[16:17] sc1
    s_add_u32 s44, s44, 1
    s_waitcnt vmcnt(0)
    v_readfirstlane_b32 s45, v13
    s_nop 1
    s_cmp_ge_u32 s45, 4
    s_cbranch_scc1 P2_y_ok
    s_cmp_lt_u32 s44, 0x20000
    s_cbranch_scc1 P2_y_spin
    s_branch P2_y_ok
P2_c1_8_slow:
    s_mov_b32 s44, 0
P2_c1_8_spin:
    s_sleep 3
    global_load_dword v13, v12, s[16:17] sc1
    s_add_u32 s44, s44, 1
    s_waitcnt vmcnt(0)
    v_readfirstlane_b32 s45, v13
    s_nop 1
    s_cmp_ge_u32 s45, 16
    s_cbranch_scc1 P2_c1_8_ok
    s_cmp_lt_u32 s44, 0x20000
    s_cbranch_scc1 P2_c1_8_spin
    s_branch P2_c1_8_ok
P2_c0_4_slow:
    s_mov_b32 s44, 0
P2_c0_4_spin:
    s_sleep 3
    global_load_dword v13, v12, s[16:17] sc1
    s_add_u32 s44, s44, 1
    s_waitcnt vmcnt(0)
    v_readfirstlane_b32 s45, v13
    s_nop 1
    s_cmp_ge_u32 s45, 16
    s_cbranch_scc1 P2_c0_4_ok
    s_cmp_lt_u32 s44, 0x20000
    s_cbranch_scc1 P2_c0_4_spin
    s_branch P2_c0_4_ok
P2_c0_11_slow:
    s_mov_b32 s44, 0
P2_c0_11_spin:
    s_sleep 3
    global_load_dword v13, v12, s[16:17] sc1
    s_add_u32 s44, s44, 1
    s_waitcnt vmcnt(0)
    v_readfirstlane_b32 s45, v13
    s_nop 1
    s_cmp_ge_u32 s45, 16
    s_cbranch_scc1 P2_c0_11_ok
    s_cmp_lt_u32 s44, 0x20000
    s_cbranch_scc1 P2_c0_11_spin
    s_branch P2_c0_11_ok
P2_c1_11_slow:
    s_mov_b32 s44, 0
P2_c1_11_spin:
    s_sleep 3
    global_load_dword v13, v12, s[16:17] sc1
    s_add_u32 s44, s44, 1
    s_waitcnt vmcnt(0)
    v_readfirstlane_b32 s45, v13
    s_nop 1
    s_cmp_ge_u32 s45, 16
    s_cbranch_scc1 P2_c1_11_ok
    s_cmp_lt_u32 s44, 0x20000
    s_cbranch_scc1 P2_c1_11_spin
    s_branch P2_c1_11_ok
K_done:
    s_endpgm
K_end:
    s_endpgm
.section .rodata,"a"
.p2align 6
.amdhsa_kernel recurrent_scan__linear_kernel_hedgehog__dense_activation_mish__prompt_kernel
  .amdhsa_next_free_vgpr 512
  .amdhsa_next_free_sgpr 102
  .amdhsa_accum_offset 256
  .amdhsa_group_segment_fixed_size 0
  .amdhsa_kernarg_size 88
  .amdhsa_user_sgpr_count 2
  .amdhsa_user_sgpr_kernarg_segment_ptr 1
  .amdhsa_system_sgpr_workgroup_id_x 1
.end_amdhsa_kernel
```
